```python
import torch

def _softmax(x, axis=-1):
    return torch.softmax(x, dim=axis)
def _gelu(x):
    return torch.nn.functional.gelu(x, approximate="tanh")
def _silu(x):
    return torch.nn.functional.silu(x)
def _sigmoid(x):
    return torch.sigmoid(x)
def _layernorm(x, axis=-1, eps=1e-5):
    m = x.mean(dim=axis, keepdim=True)
    v = x.var(dim=axis, keepdim=True, unbiased=False)
    return (x - m) / torch.sqrt(v + eps)
def _scatter_add(tgt, idx, src, axis=0):
    return tgt.clone().index_add_(axis, idx, src)
def _segment_sum(src, seg, n):
    out = torch.zeros((n,) + src.shape[1:], dtype=src.dtype)
    return out.index_add_(0, seg, src)
def _pad(x, pw):
    flat = tuple(v for pair in reversed(pw) for v in pair)
    return torch.nn.functional.pad(x, flat)

kernel_name = 'interleave_layers__grouped_kv_mqa__glu_gated_geglu__prompt'

def setup_inputs():

    _w = (lambda a: (lambda t: t.to(torch.bfloat16) if t.is_floating_point() else t)(torch.as_tensor(a)))
    def _A_setup():
        B, S, D, H = 1, 2048, 640, 32
        Dh = D // H
        return {
            "x": _w((lambda *s: torch.randn(*s, dtype=torch.bfloat16) * 0.05)(B, S, D)),
            "wq": _w((lambda *s: torch.randn(*s, dtype=torch.bfloat16) * 0.05)(D, H * Dh)),
            "wk": _w((lambda *s: torch.randn(*s, dtype=torch.bfloat16) * 0.05)(D, Dh)),
            "wv": _w((lambda *s: torch.randn(*s, dtype=torch.bfloat16) * 0.05)(D, Dh)),
            "wo": _w((lambda *s: torch.randn(*s, dtype=torch.bfloat16) * 0.05)(H * Dh, D)),
        }
    _A_in = _A_setup()

    def _B_setup():
        B, S, Dm, Df = 1, 2048, 640, 1536
        return {
            "x": _w((lambda *s: torch.randn(*s, dtype=torch.bfloat16) * 0.05)(B, S, Dm)),
            "w_gate": _w((lambda *s: torch.randn(*s, dtype=torch.bfloat16) * 0.8)(Dm, Df) * (Dm ** -0.5)),
            "w_up": _w((lambda *s: torch.randn(*s, dtype=torch.bfloat16) * 0.8)(Dm, Df) * (Dm ** -0.5)),
            "w_down": _w((lambda *s: torch.randn(*s, dtype=torch.bfloat16) * 0.8)(Df, Dm) * (Df ** -0.5)),
        }
    _B_in = _B_setup()

    return {
        "A_x": _A_in["x"],
        "A_wq": _A_in["wq"],
        "A_wk": _A_in["wk"],
        "A_wv": _A_in["wv"],
        "A_wo": _A_in["wo"],
        "B_x": _B_in["x"],
        "B_w_gate": _B_in["w_gate"],
        "B_w_up": _B_in["w_up"],
        "B_w_down": _B_in["w_down"],
    }

def reference(A_x, A_wq, A_wk, A_wv, A_wo, B_x, B_w_gate, B_w_up, B_w_down):
    def _A_ref(x, wq, wk, wv, wo):
        B, S, D = x.shape
        H = 32
        Dh = D // H
        q = (lambda x, *d: x.permute(*d))((x @ wq).reshape(B, S, H, Dh), 0, 2, 1, 3)
        k = x @ wk
        v = x @ wv
        scores = torch.einsum("bhqd,bkd->bhqk", q, k) * (Dh ** -0.5)
        p = _softmax(scores, axis=-1)
        o = torch.einsum("bhqk,bkd->bhqd", p, v)
        return (lambda x, *d: x.permute(*d))(o, 0, 2, 1, 3).reshape(B, S, H * Dh) @ wo

    def _B_ref(x, w_gate, w_up, w_down):
        g = torch.einsum("bsd,df->bsf", x, w_gate)
        u = torch.einsum("bsd,df->bsf", x, w_up)
        h = _gelu(g) * u
        return torch.einsum("bsf,fd->bsd", h, w_down)

    x = A_x
    x = x + _A_ref(_layernorm(x, axis=-1), A_wq, A_wk, A_wv, A_wo)
    x = x + _B_ref(_layernorm(x, axis=-1), B_w_gate, B_w_up, B_w_down)
    x = x + _A_ref(_layernorm(x, axis=-1), A_wq, A_wk, A_wv, A_wo)
    x = x + _B_ref(_layernorm(x, axis=-1), B_w_gate, B_w_up, B_w_down)
    return x
```

```asm
; @launch kernel=prep_kernel grid=(242,1,1) block=(256,1,1) lds=49152
; @launch kernel=qkv1_kernel grid=(256,1,1) block=(384,1,1) lds=147456
; @launch kernel=f1_kernel grid=(256,1,1) block=(512,1,1) lds=163840
; @launch kernel=f2_kernel grid=(256,1,1) block=(512,1,1) lds=163840
.amdgcn_target "amdgcn-amd-amdhsa--gfx950"
.text
.globl prep_kernel
.p2align 8
.type prep_kernel,@function
prep_kernel:
    s_cmp_ge_u32 s2, 242
    s_cbranch_scc1 prep_exit
    s_load_dwordx2 s[36:37], s[0:1], 88
    v_lshrrev_b32 v1, 6, v0
    s_nop 0
    v_readfirstlane_b32 s40, v1
    v_and_b32 v0, 63, v0
    v_and_b32 v2, 15, v0
    v_lshrrev_b32 v3, 4, v0
    v_lshlrev_b32 v4, 4, v0
    v_mov_b32 v8, 0x3f803f80
    v_mov_b32 v10, 0
    v_mov_b32 v11, 0
    s_cmp_ge_u32 s2, 64
    s_cbranch_scc1 prep_w
    s_load_dwordx2 s[34:35], s[0:1], 0
    s_and_b32 s3, s2, 7
    s_lshl_b32 s3, s3, 3
    s_lshr_b32 s32, s2, 3
    s_add_u32 s3, s3, s32
    v_lshrrev_b32 v5, 3, v0
    s_lshl_b32 s32, s40, 3
    v_add_u32 v5, s32, v5
    v_bfe_u32 v6, v5, 1, 3
    v_and_b32 v7, 7, v0
    v_xor_b32 v6, v6, v7
    v_lshlrev_b32 v6, 4, v6
    v_mul_u32_u24 v5, 1280, v5
    v_add_u32 v5, v5, v6
    s_mul_i32 s33, s3, 40960
    s_mul_i32 s41, s40, 10240
    s_waitcnt lgkmcnt(0)
    s_mov_b32 s4, s34
    s_mov_b32 s5, s35
    s_mov_b32 s6, 0x280000
    s_mov_b32 s7, 0x20000
    s_add_u32 s16, s36, 0x1100000
    s_addc_u32 s17, s37, 0
    s_mov_b32 s18, 0x280000
    s_mov_b32 s19, 0x20000
    s_add_u32 s24, s36, 0x1080000
    s_addc_u32 s25, s37, 0
    s_mov_b32 s26, 0x68000
    s_mov_b32 s27, 0x20000
    s_add_u32 m0, s41, 0
    s_nop 0
    buffer_load_dwordx4 v5, s[4:7], s33 offen offset:0 lds
    s_add_u32 m0, s41, 896
    s_nop 0
    buffer_load_dwordx4 v5, s[4:7], s33 offen offset:128 lds
    s_add_u32 m0, s41, 1792
    s_nop 0
    buffer_load_dwordx4 v5, s[4:7], s33 offen offset:256 lds
    s_add_u32 m0, s41, 2688
    s_nop 0
    buffer_load_dwordx4 v5, s[4:7], s33 offen offset:384 lds
    s_add_u32 m0, s41, 3584
    s_nop 0
    buffer_load_dwordx4 v5, s[4:7], s33 offen offset:512 lds
    s_add_u32 m0, s41, 4480
    s_nop 0
    buffer_load_dwordx4 v5, s[4:7], s33 offen offset:640 lds
    s_add_u32 m0, s41, 5376
    s_nop 0
    buffer_load_dwordx4 v5, s[4:7], s33 offen offset:768 lds
    s_add_u32 m0, s41, 6272
    s_nop 0
    buffer_load_dwordx4 v5, s[4:7], s33 offen offset:896 lds
    s_add_u32 m0, s41, 7168
    s_nop 0
    buffer_load_dwordx4 v5, s[4:7], s33 offen offset:1024 lds
    s_add_u32 m0, s41, 8064
    s_nop 0
    buffer_load_dwordx4 v5, s[4:7], s33 offen offset:1152 lds
    s_lshl2_add_u32 s42, s2, s40
    s_lshl_b32 s42, s42, 9
    s_add_u32 s42, s42, 294912
    v_lshlrev_b32 v6, 3, v0
    buffer_store_dwordx2 v[10:11], v6, s[24:27], s42 offen
    s_and_b32 s42, s40, 1
    s_lshr_b32 s43, s40, 1
    v_lshrrev_b32 v5, 3, v2
    v_mul_u32_u24 v5, 10240, v5
    v_and_b32 v6, 7, v2
    v_lshl_add_u32 v5, v6, 7, v5
    v_and_b32 v6, 1, v3
    v_lshl_add_u32 v5, v6, 3, v5
    s_mul_i32 s44, s42, 20480
    s_mul_i32 s45, s43, 5120
    s_add_u32 s44, s44, s45
    v_add_u32 v5, s44, v5
    v_lshrrev_b32 v6, 1, v2
    v_lshrrev_b32 v7, 1, v3
    v_xor_b32 v6, v6, v7
    v_xor_b32 v7, 0, v6
    v_lshl_add_u32 v12, v7, 4, v5
    v_xor_b32 v7, 2, v6
    v_lshl_add_u32 v13, v7, 4, v5
    v_xor_b32 v7, 4, v6
    v_lshl_add_u32 v14, v7, 4, v5
    v_xor_b32 v7, 6, v6
    v_lshl_add_u32 v15, v7, 4, v5
    s_waitcnt vmcnt(0)
    s_barrier
    ds_read_b64 v[16:17], v12 offset:0
    ds_read_b64 v[18:19], v13 offset:0
    ds_read_b64 v[20:21], v14 offset:0
    ds_read_b64 v[22:23], v15 offset:0
    ds_read_b64 v[24:25], v12 offset:1024
    ds_read_b64 v[26:27], v13 offset:1024
    ds_read_b64 v[28:29], v14 offset:1024
    ds_read_b64 v[30:31], v15 offset:1024
    ds_read_b64 v[32:33], v12 offset:2048
    ds_read_b64 v[34:35], v13 offset:2048
    ds_read_b64 v[36:37], v14 offset:2048
    ds_read_b64 v[38:39], v15 offset:2048
    ds_read_b64 v[40:41], v12 offset:3072
    ds_read_b64 v[42:43], v13 offset:3072
    s_waitcnt lgkmcnt(0)
    ds_read_b64 v[44:45], v14 offset:3072
    ds_read_b64 v[46:47], v15 offset:3072
    ds_read_b64 v[48:49], v12 offset:4096
    ds_read_b64 v[50:51], v13 offset:4096
    ds_read_b64 v[52:53], v14 offset:4096
    ds_read_b64 v[54:55], v15 offset:4096
    s_mul_i32 s45, s43, 10240
    s_mul_i32 s44, s42, 20480
    s_add_u32 s44, s44, s45
    s_add_u32 s44, s44, s33
    s_waitcnt lgkmcnt(0)
    buffer_store_dwordx4 v[16:19], v4, s[16:19], s44 offen offset:0
    buffer_store_dwordx4 v[20:23], v4, s[16:19], s44 offen offset:1024
    buffer_store_dwordx4 v[24:27], v4, s[16:19], s44 offen offset:2048
    buffer_store_dwordx4 v[28:31], v4, s[16:19], s44 offen offset:3072
    s_add_u32 s44, s44, 4096
    buffer_store_dwordx4 v[32:35], v4, s[16:19], s44 offen offset:0
    buffer_store_dwordx4 v[36:39], v4, s[16:19], s44 offen offset:1024
    buffer_store_dwordx4 v[40:43], v4, s[16:19], s44 offen offset:2048
    buffer_store_dwordx4 v[44:47], v4, s[16:19], s44 offen offset:3072
    s_add_u32 s44, s44, 4096
    buffer_store_dwordx4 v[48:51], v4, s[16:19], s44 offen offset:0
    buffer_store_dwordx4 v[52:55], v4, s[16:19], s44 offen offset:1024
    v_dot2_f32_bf16 v10, v16, v8, v10
    v_dot2_f32_bf16 v11, v16, v16, v11
    v_dot2_f32_bf16 v10, v17, v8, v10
    v_dot2_f32_bf16 v11, v17, v17, v11
    v_dot2_f32_bf16 v10, v18, v8, v10
    v_dot2_f32_bf16 v11, v18, v18, v11
    v_dot2_f32_bf16 v10, v19, v8, v10
    v_dot2_f32_bf16 v11, v19, v19, v11
    v_dot2_f32_bf16 v10, v20, v8, v10
    v_dot2_f32_bf16 v11, v20, v20, v11
    v_dot2_f32_bf16 v10, v21, v8, v10
    v_dot2_f32_bf16 v11, v21, v21, v11
    v_dot2_f32_bf16 v10, v22, v8, v10
    v_dot2_f32_bf16 v11, v22, v22, v11
    v_dot2_f32_bf16 v10, v23, v8, v10
    v_dot2_f32_bf16 v11, v23, v23, v11
    v_dot2_f32_bf16 v10, v24, v8, v10
    v_dot2_f32_bf16 v11, v24, v24, v11
    v_dot2_f32_bf16 v10, v25, v8, v10
    v_dot2_f32_bf16 v11, v25, v25, v11
    v_dot2_f32_bf16 v10, v26, v8, v10
    v_dot2_f32_bf16 v11, v26, v26, v11
    v_dot2_f32_bf16 v10, v27, v8, v10
    v_dot2_f32_bf16 v11, v27, v27, v11
    v_dot2_f32_bf16 v10, v28, v8, v10
    v_dot2_f32_bf16 v11, v28, v28, v11
    v_dot2_f32_bf16 v10, v29, v8, v10
    v_dot2_f32_bf16 v11, v29, v29, v11
    v_dot2_f32_bf16 v10, v30, v8, v10
    v_dot2_f32_bf16 v11, v30, v30, v11
    v_dot2_f32_bf16 v10, v31, v8, v10
    v_dot2_f32_bf16 v11, v31, v31, v11
    v_dot2_f32_bf16 v10, v32, v8, v10
    v_dot2_f32_bf16 v11, v32, v32, v11
    v_dot2_f32_bf16 v10, v33, v8, v10
    v_dot2_f32_bf16 v11, v33, v33, v11
    v_dot2_f32_bf16 v10, v34, v8, v10
    v_dot2_f32_bf16 v11, v34, v34, v11
    v_dot2_f32_bf16 v10, v35, v8, v10
    v_dot2_f32_bf16 v11, v35, v35, v11
    v_dot2_f32_bf16 v10, v36, v8, v10
    v_dot2_f32_bf16 v11, v36, v36, v11
    v_dot2_f32_bf16 v10, v37, v8, v10
    v_dot2_f32_bf16 v11, v37, v37, v11
    v_dot2_f32_bf16 v10, v38, v8, v10
    v_dot2_f32_bf16 v11, v38, v38, v11
    v_dot2_f32_bf16 v10, v39, v8, v10
    v_dot2_f32_bf16 v11, v39, v39, v11
    v_dot2_f32_bf16 v10, v40, v8, v10
    v_dot2_f32_bf16 v11, v40, v40, v11
    v_dot2_f32_bf16 v10, v41, v8, v10
    v_dot2_f32_bf16 v11, v41, v41, v11
    v_dot2_f32_bf16 v10, v42, v8, v10
    v_dot2_f32_bf16 v11, v42, v42, v11
    v_dot2_f32_bf16 v10, v43, v8, v10
    v_dot2_f32_bf16 v11, v43, v43, v11
    v_dot2_f32_bf16 v10, v44, v8, v10
    v_dot2_f32_bf16 v11, v44, v44, v11
    v_dot2_f32_bf16 v10, v45, v8, v10
    v_dot2_f32_bf16 v11, v45, v45, v11
    v_dot2_f32_bf16 v10, v46, v8, v10
    v_dot2_f32_bf16 v11, v46, v46, v11
    v_dot2_f32_bf16 v10, v47, v8, v10
    v_dot2_f32_bf16 v11, v47, v47, v11
    v_dot2_f32_bf16 v10, v48, v8, v10
    v_dot2_f32_bf16 v11, v48, v48, v11
    v_dot2_f32_bf16 v10, v49, v8, v10
    v_dot2_f32_bf16 v11, v49, v49, v11
    v_dot2_f32_bf16 v10, v50, v8, v10
    v_dot2_f32_bf16 v11, v50, v50, v11
    v_dot2_f32_bf16 v10, v51, v8, v10
    v_dot2_f32_bf16 v11, v51, v51, v11
    v_dot2_f32_bf16 v10, v52, v8, v10
    v_dot2_f32_bf16 v11, v52, v52, v11
    v_dot2_f32_bf16 v10, v53, v8, v10
    v_dot2_f32_bf16 v11, v53, v53, v11
    v_dot2_f32_bf16 v10, v54, v8, v10
    v_dot2_f32_bf16 v11, v54, v54, v11
    v_dot2_f32_bf16 v10, v55, v8, v10
    v_dot2_f32_bf16 v11, v55, v55, v11
    v_lshlrev_b32 v5, 6, v2
    v_lshl_add_u32 v5, v3, 3, v5
    s_lshl_b32 s44, s3, 11
    s_lshl_b32 s45, s42, 10
    s_add_u32 s44, s44, s45
    s_lshl_b32 s45, s43, 5
    s_add_u32 s44, s44, s45
    buffer_store_dwordx2 v[10:11], v5, s[24:27], s44 offen offset:0
    s_endpgm
prep_w:
    s_sub_u32 s3, s2, 64
    s_cmp_ge_u32 s3, 176
    s_cbranch_scc1 prep_kv
    s_cmp_ge_u32 s3, 20
    s_cbranch_scc1 prep_n20
    s_load_dwordx2 s[34:35], s[0:1], 8
    s_sub_u32 s8, s3, 0
    s_and_b32 s9, s8, 1
    s_lshr_b32 s8, s8, 1
    s_mov_b32 s10, 1280
    s_mov_b32 s11, 10
    s_mov_b32 s12, 0
    s_mov_b32 s13, 100
    s_mov_b32 s14, 5
    s_mul_i32 s15, s9, 4096
    s_add_u32 s15, s15, 262144
    s_mov_b32 s6, 819200
    s_mov_b32 s52, 0
    s_branch prep_go
prep_n20:
    s_cmp_ge_u32 s3, 40
    s_cbranch_scc1 prep_n40
    s_load_dwordx2 s[34:35], s[0:1], 32
    s_sub_u32 s8, s3, 20
    s_and_b32 s9, s8, 1
    s_lshr_b32 s8, s8, 1
    s_mov_b32 s10, 1280
    s_mov_b32 s11, 10
    s_mov_b32 s12, 819200
    s_mov_b32 s13, 100
    s_mov_b32 s14, 5
    s_mul_i32 s15, s9, 0
    s_add_u32 s15, s15, 0
    s_mov_b32 s6, 819200
    s_mov_b32 s52, 0
    s_branch prep_go
prep_n40:
    s_cmp_ge_u32 s3, 88
    s_cbranch_scc1 prep_n88
    s_load_dwordx2 s[34:35], s[0:1], 48
    s_sub_u32 s8, s3, 40
    s_and_b32 s9, s8, 1
    s_lshr_b32 s8, s8, 1
    s_mov_b32 s10, 3072
    s_mov_b32 s11, 10
    s_mov_b32 s12, 3670016
    s_mov_b32 s13, 240
    s_mov_b32 s14, 12
    s_mul_i32 s15, s9, 6144
    s_add_u32 s15, s15, 270336
    s_mov_b32 s6, 1966080
    s_mov_b32 s52, 1
    s_branch prep_go
prep_n88:
    s_cmp_ge_u32 s3, 136
    s_cbranch_scc1 prep_n136
    s_load_dwordx2 s[34:35], s[0:1], 56
    s_sub_u32 s8, s3, 88
    s_and_b32 s9, s8, 1
    s_lshr_b32 s8, s8, 1
    s_mov_b32 s10, 3072
    s_mov_b32 s11, 10
    s_mov_b32 s12, 3670016
    s_mov_b32 s13, 240
    s_mov_b32 s14, 12
    s_mul_i32 s15, s9, 6144
    s_add_u32 s15, s15, 282624
    s_mov_b32 s6, 1966080
    s_mov_b32 s52, 2
    s_branch prep_go
prep_n136:
    s_load_dwordx2 s[34:35], s[0:1], 64
    s_sub_u32 s8, s3, 136
    s_and_b32 s9, s8, 3
    s_lshr_b32 s8, s8, 2
    s_mov_b32 s10, 1280
    s_mov_b32 s11, 12
    s_mov_b32 s12, 1703936
    s_mov_b32 s13, 240
    s_mov_b32 s14, 5
    s_mul_i32 s15, s9, 0
    s_add_u32 s15, s15, 0
    s_mov_b32 s6, 1966080
    s_mov_b32 s52, 0
prep_go:
    v_lshrrev_b32 v5, 3, v0
    s_lshl_b32 s32, s40, 3
    v_add_u32 v5, s32, v5
    v_mul_lo_u32 v5, v5, s10
    v_and_b32 v6, 7, v0
    v_lshl_add_u32 v5, v6, 4, v5
    s_mul_i32 s42, s9, s11
    s_lshl_b32 s43, s10, 5
    s_mul_i32 s33, s42, s43
    s_lshl_b32 s44, s8, 7
    s_add_u32 s33, s33, s44
    s_lshl_b32 s41, s40, 10
    s_waitcnt lgkmcnt(0)
    s_mov_b32 s4, s34
    s_mov_b32 s5, s35
    s_mov_b32 s7, 0x20000
    s_add_u32 s16, s36, 0x1380000
    s_addc_u32 s17, s37, 0
    s_mov_b32 s18, 0x740000
    s_mov_b32 s19, 0x20000
    s_add_u32 s24, s36, 0x1080000
    s_addc_u32 s25, s37, 0
    s_mov_b32 s26, 0x68000
    s_mov_b32 s27, 0x20000
    s_mov_b32 s44, s11
prep_dl:
    s_mov_b32 m0, s41
    s_nop 0
    buffer_load_dwordx4 v5, s[4:7], s33 offen lds
    s_add_u32 s41, s41, 4096
    s_add_u32 s33, s33, s43
    s_sub_u32 s44, s44, 1
    s_cmp_lg_u32 s44, 0
    s_cbranch_scc1 prep_dl
    s_lshl_b32 s45, s8, 2
    s_add_u32 s45, s45, s40
    s_cmp_lg_u32 s52, 0
    s_cbranch_scc1 prep_m6
    s_mul_i32 s46, s45, 205
    s_lshr_b32 s46, s46, 10
    s_mul_i32 s47, s46, 5
    s_sub_u32 s47, s45, s47
    s_branch prep_m
prep_m6:
    s_mul_i32 s46, s45, 171
    s_lshr_b32 s46, s46, 10
    s_mul_i32 s47, s46, 6
    s_sub_u32 s47, s45, s47
    s_cmp_ge_u32 s47, 3
    s_cselect_b32 s48, 3, 0
    s_add_u32 s47, s47, s48
    s_cmp_eq_u32 s52, 2
    s_cselect_b32 s48, 3, 0
    s_add_u32 s47, s47, s48
prep_m:
    s_mul_i32 s46, s46, s13
    s_mul_i32 s48, s42, s14
    s_add_u32 s46, s46, s48
    s_add_u32 s46, s46, s47
    s_lshl_b32 s46, s46, 10
    s_add_u32 s46, s46, s12
    s_lshl_b32 s47, s14, 10
    s_lshl_b32 s45, s45, 6
    s_add_u32 s45, s45, s15
    v_lshrrev_b32 v5, 2, v0
    v_lshlrev_b32 v5, 7, v5
    v_and_b32 v6, 3, v0
    v_lshl_add_u32 v5, v6, 3, v5
    s_lshl_b32 s44, s40, 5
    v_add_u32 v5, s44, v5
    s_waitcnt vmcnt(0)
    s_barrier
    ds_read_b64_tr_b16 v[16:17], v5 offset:0
    ds_read_b64_tr_b16 v[18:19], v5 offset:2048
    ds_read_b64_tr_b16 v[20:21], v5 offset:4096
    ds_read_b64_tr_b16 v[22:23], v5 offset:6144
    ds_read_b64_tr_b16 v[24:25], v5 offset:8192
    ds_read_b64_tr_b16 v[26:27], v5 offset:10240
    ds_read_b64_tr_b16 v[28:29], v5 offset:12288
    ds_read_b64_tr_b16 v[30:31], v5 offset:14336
    ds_read_b64_tr_b16 v[32:33], v5 offset:16384
    ds_read_b64_tr_b16 v[34:35], v5 offset:18432
    ds_read_b64_tr_b16 v[36:37], v5 offset:20480
    ds_read_b64_tr_b16 v[38:39], v5 offset:22528
    ds_read_b64_tr_b16 v[40:41], v5 offset:24576
    ds_read_b64_tr_b16 v[42:43], v5 offset:26624
    s_waitcnt lgkmcnt(0)
    ds_read_b64_tr_b16 v[44:45], v5 offset:28672
    ds_read_b64_tr_b16 v[46:47], v5 offset:30720
    ds_read_b64_tr_b16 v[48:49], v5 offset:32768
    ds_read_b64_tr_b16 v[50:51], v5 offset:34816
    ds_read_b64_tr_b16 v[52:53], v5 offset:36864
    ds_read_b64_tr_b16 v[54:55], v5 offset:38912
    ds_read_b64_tr_b16 v[56:57], v5 offset:40960
    ds_read_b64_tr_b16 v[58:59], v5 offset:43008
    ds_read_b64_tr_b16 v[60:61], v5 offset:45056
    ds_read_b64_tr_b16 v[62:63], v5 offset:47104
    s_waitcnt lgkmcnt(0)
    buffer_store_dwordx4 v[16:19], v4, s[16:19], s46 offen
    s_add_u32 s46, s46, s47
    buffer_store_dwordx4 v[20:23], v4, s[16:19], s46 offen
    s_add_u32 s46, s46, s47
    buffer_store_dwordx4 v[24:27], v4, s[16:19], s46 offen
    s_add_u32 s46, s46, s47
    buffer_store_dwordx4 v[28:31], v4, s[16:19], s46 offen
    s_add_u32 s46, s46, s47
    buffer_store_dwordx4 v[32:35], v4, s[16:19], s46 offen
    s_add_u32 s46, s46, s47
    buffer_store_dwordx4 v[36:39], v4, s[16:19], s46 offen
    s_add_u32 s46, s46, s47
    buffer_store_dwordx4 v[40:43], v4, s[16:19], s46 offen
    s_add_u32 s46, s46, s47
    buffer_store_dwordx4 v[44:47], v4, s[16:19], s46 offen
    s_add_u32 s46, s46, s47
    buffer_store_dwordx4 v[48:51], v4, s[16:19], s46 offen
    s_add_u32 s46, s46, s47
    buffer_store_dwordx4 v[52:55], v4, s[16:19], s46 offen
    s_add_u32 s46, s46, s47
    s_cmp_eq_u32 s11, 10
    s_cbranch_scc1 prep_p_st
    buffer_store_dwordx4 v[56:59], v4, s[16:19], s46 offen
    s_add_u32 s46, s46, s47
    buffer_store_dwordx4 v[60:63], v4, s[16:19], s46 offen
    s_add_u32 s46, s46, s47
prep_p_st:
    s_cmp_eq_u32 s15, 0
    s_cbranch_scc1 prep_exit
prep_cs:
    v_dot2_f32_bf16 v10, v16, v8, v10
    v_dot2_f32_bf16 v11, v17, v8, v11
    v_dot2_f32_bf16 v10, v18, v8, v10
    v_dot2_f32_bf16 v11, v19, v8, v11
    v_dot2_f32_bf16 v10, v20, v8, v10
    v_dot2_f32_bf16 v11, v21, v8, v11
    v_dot2_f32_bf16 v10, v22, v8, v10
    v_dot2_f32_bf16 v11, v23, v8, v11
    v_dot2_f32_bf16 v10, v24, v8, v10
    v_dot2_f32_bf16 v11, v25, v8, v11
    v_dot2_f32_bf16 v10, v26, v8, v10
    v_dot2_f32_bf16 v11, v27, v8, v11
    v_dot2_f32_bf16 v10, v28, v8, v10
    v_dot2_f32_bf16 v11, v29, v8, v11
    v_dot2_f32_bf16 v10, v30, v8, v10
    v_dot2_f32_bf16 v11, v31, v8, v11
    v_dot2_f32_bf16 v10, v32, v8, v10
    v_dot2_f32_bf16 v11, v33, v8, v11
    v_dot2_f32_bf16 v10, v34, v8, v10
    v_dot2_f32_bf16 v11, v35, v8, v11
    v_dot2_f32_bf16 v10, v36, v8, v10
    v_dot2_f32_bf16 v11, v37, v8, v11
    v_dot2_f32_bf16 v10, v38, v8, v10
    v_dot2_f32_bf16 v11, v39, v8, v11
    v_dot2_f32_bf16 v10, v40, v8, v10
    v_dot2_f32_bf16 v11, v41, v8, v11
    v_dot2_f32_bf16 v10, v42, v8, v10
    v_dot2_f32_bf16 v11, v43, v8, v11
    v_dot2_f32_bf16 v10, v44, v8, v10
    v_dot2_f32_bf16 v11, v45, v8, v11
    v_dot2_f32_bf16 v10, v46, v8, v10
    v_dot2_f32_bf16 v11, v47, v8, v11
    v_dot2_f32_bf16 v10, v48, v8, v10
    v_dot2_f32_bf16 v11, v49, v8, v11
    v_dot2_f32_bf16 v10, v50, v8, v10
    v_dot2_f32_bf16 v11, v51, v8, v11
    v_dot2_f32_bf16 v10, v52, v8, v10
    v_dot2_f32_bf16 v11, v53, v8, v11
    v_dot2_f32_bf16 v10, v54, v8, v10
    v_dot2_f32_bf16 v11, v55, v8, v11
    s_nop 2
    v_add_f32 v10, v10, v11
    v_mov_b32 v11, v10
    s_nop 1
    v_permlane16_swap_b32 v10, v11
    v_add_f32 v10, v10, v11
    v_mov_b32 v11, v10
    s_nop 1
    v_permlane32_swap_b32 v10, v11
    v_add_f32 v10, v10, v11
    v_lshlrev_b32 v5, 2, v0
    v_cmp_gt_u32 vcc, 16, v0
    v_mov_b32 v6, 0x7ff00000
    s_nop 0
    v_cndmask_b32 v5, v6, v5, vcc
    buffer_store_dword v10, v5, s[24:27], s45 offen
prep_exit:
    s_endpgm
prep_kv:
    s_sub_u32 s9, s3, 176
    s_load_dwordx2 s[34:35], s[0:1], 16
    s_load_dwordx2 s[38:39], s[0:1], 24
    s_waitcnt lgkmcnt(0)
    s_cmp_ge_u32 s40, 2
    s_cselect_b32 s34, s38, s34
    s_cselect_b32 s35, s39, s35
    s_mov_b32 s4, s34
    s_mov_b32 s5, s35
    s_mov_b32 s6, 0x6400
    s_mov_b32 s7, 0x20000
    s_add_u32 s16, s36, 0x1380000
    s_addc_u32 s17, s37, 0
    s_mov_b32 s18, 0x740000
    s_mov_b32 s19, 0x20000
    s_add_u32 s24, s36, 0x1080000
    s_addc_u32 s25, s37, 0
    s_mov_b32 s26, 0x68000
    s_mov_b32 s27, 0x20000
    s_mul_i32 s33, s9, 12800
    s_and_b32 s42, s40, 1
    s_mul_i32 s42, s42, 7168
    s_add_u32 s33, s33, s42
    s_mul_i32 s41, s40, 7168
    s_add_u32 m0, s41, 0
    s_add_u32 s44, s33, 0
    buffer_load_dwordx4 v4, s[4:7], s44 offen lds
    s_add_u32 m0, s41, 1024
    s_add_u32 s44, s33, 1024
    buffer_load_dwordx4 v4, s[4:7], s44 offen lds
    s_add_u32 m0, s41, 2048
    s_add_u32 s44, s33, 2048
    buffer_load_dwordx4 v4, s[4:7], s44 offen lds
    s_add_u32 m0, s41, 3072
    s_add_u32 s44, s33, 3072
    buffer_load_dwordx4 v4, s[4:7], s44 offen lds
    s_add_u32 m0, s41, 4096
    s_add_u32 s44, s33, 4096
    buffer_load_dwordx4 v4, s[4:7], s44 offen lds
    s_add_u32 m0, s41, 5120
    s_add_u32 s44, s33, 5120
    buffer_load_dwordx4 v4, s[4:7], s44 offen lds
    s_add_u32 m0, s41, 6144
    s_add_u32 s44, s33, 6144
    buffer_load_dwordx4 v4, s[4:7], s44 offen lds
    v_and_b32 v6, 3, v0
    s_lshl_b32 s44, s40, 2
    v_add_u32 v6, s44, v6
    v_min_u32 v6, 9, v6
    v_lshlrev_b32 v7, 3, v6
    v_add_u32 v9, 14296, v7
    v_cmp_gt_u32 vcc, 5, v6
    s_nop 1
    v_cndmask_b32 v7, v9, v7, vcc
    v_lshrrev_b32 v5, 2, v0
    v_mul_u32_u24 v5, 40, v5
    v_add_u32 v5, v5, v7
    s_mul_i32 s46, s40, 20480
    s_mul_i32 s44, s9, 10240
    s_add_u32 s46, s46, s44
    s_add_u32 s46, s46, 1638400
    s_mov_b32 s47, 1024
    s_lshl_b32 s45, s40, 6
    s_lshl_b32 s44, s9, 12
    s_add_u32 s45, s45, s44
    s_add_u32 s45, s45, 264704
    s_waitcnt vmcnt(0)
    s_barrier
    s_cmp_eq_u32 s40, 3
    s_cbranch_scc1 prep_exit
    ds_read_b64_tr_b16 v[16:17], v5 offset:0
    ds_read_b64_tr_b16 v[18:19], v5 offset:640
    ds_read_b64_tr_b16 v[20:21], v5 offset:1280
    ds_read_b64_tr_b16 v[22:23], v5 offset:1920
    ds_read_b64_tr_b16 v[24:25], v5 offset:2560
    ds_read_b64_tr_b16 v[26:27], v5 offset:3200
    ds_read_b64_tr_b16 v[28:29], v5 offset:3840
    ds_read_b64_tr_b16 v[30:31], v5 offset:4480
    ds_read_b64_tr_b16 v[32:33], v5 offset:5120
    ds_read_b64_tr_b16 v[34:35], v5 offset:5760
    ds_read_b64_tr_b16 v[36:37], v5 offset:6400
    ds_read_b64_tr_b16 v[38:39], v5 offset:7040
    ds_read_b64_tr_b16 v[40:41], v5 offset:7680
    ds_read_b64_tr_b16 v[42:43], v5 offset:8320
    s_waitcnt lgkmcnt(0)
    ds_read_b64_tr_b16 v[44:45], v5 offset:8960
    ds_read_b64_tr_b16 v[46:47], v5 offset:9600
    ds_read_b64_tr_b16 v[48:49], v5 offset:10240
    ds_read_b64_tr_b16 v[50:51], v5 offset:10880
    ds_read_b64_tr_b16 v[52:53], v5 offset:11520
    ds_read_b64_tr_b16 v[54:55], v5 offset:12160
    s_waitcnt lgkmcnt(0)
    buffer_store_dwordx4 v[16:19], v4, s[16:19], s46 offen
    s_add_u32 s46, s46, s47
    buffer_store_dwordx4 v[20:23], v4, s[16:19], s46 offen
    s_add_u32 s46, s46, s47
    buffer_store_dwordx4 v[24:27], v4, s[16:19], s46 offen
    s_add_u32 s46, s46, s47
    buffer_store_dwordx4 v[28:31], v4, s[16:19], s46 offen
    s_add_u32 s46, s46, s47
    buffer_store_dwordx4 v[32:35], v4, s[16:19], s46 offen
    s_add_u32 s46, s46, s47
    buffer_store_dwordx4 v[36:39], v4, s[16:19], s46 offen
    s_add_u32 s46, s46, s47
    buffer_store_dwordx4 v[40:43], v4, s[16:19], s46 offen
    s_add_u32 s46, s46, s47
    buffer_store_dwordx4 v[44:47], v4, s[16:19], s46 offen
    s_add_u32 s46, s46, s47
    buffer_store_dwordx4 v[48:51], v4, s[16:19], s46 offen
    s_add_u32 s46, s46, s47
    buffer_store_dwordx4 v[52:55], v4, s[16:19], s46 offen
    s_add_u32 s46, s46, s47
    s_branch prep_cs
.globl qkv1_kernel
.p2align 8
.type qkv1_kernel,@function
qkv1_kernel:
    s_cmp_ge_u32 s2, 256
    s_cbranch_scc1 f_exit
    s_and_b32 s34, s2, 7
    s_lshr_b32 s35, s2, 3
    s_lshl_b32 s34, s34, 2
    s_lshr_b32 s33, s35, 3
    s_add_u32 s34, s34, s33
    s_lshl_b32 s32, s34, 6
    s_and_b32 s33, s35, 7
    s_load_dwordx2 s[36:37], s[0:1], 88
    v_lshrrev_b32 v1, 6, v0
    s_nop 0
    v_readfirstlane_b32 s40, v1
    v_and_b32 v0, 63, v0
    s_mul_i32 s44, s33, 11
    s_lshr_b32 s44, s44, 5
    s_mul_i32 s44, s44, 3
    s_sub_u32 s44, s33, s44
    s_waitcnt lgkmcnt(0)
    s_add_u32 s4, s36, 0x1100000
    s_addc_u32 s5, s37, 0
    s_mov_b32 s6, 0x280000
    s_mov_b32 s7, 0x20000
    s_add_u32 s8, s36, 0x1380000
    s_addc_u32 s9, s37, 0
    s_mov_b32 s10, 0x740000
    s_mov_b32 s11, 0x20000
    s_mov_b32 s41, 0
    s_add_u32 s24, s36, 0x1080000
    s_addc_u32 s25, s37, 0
    s_mov_b32 s26, 0x68000
    s_mov_b32 s27, 0x20000
    s_mov_b32 s16, s36
    s_mov_b32 s17, s37
    s_mov_b32 s18, 0x280000
    s_mov_b32 s19, 0x20000
    s_add_u32 s28, s36, 0x280000
    s_addc_u32 s29, s37, 0
    s_mov_b32 s30, 0x30000
    s_mov_b32 s31, 0x20000
    s_cmp_ge_u32 s40, 4
    s_cbranch_scc1 qkv_loader
    v_lshlrev_b32 v4, 4, v0
    s_and_b32 s46, s40, 1
    s_lshr_b32 s57, s40, 1
    s_lshr_b32 s42, s32, 4
    s_lshl1_add_u32 s42, s46, s42
    s_mov_b32 s59, s42
    s_add_u32 s42, s42, s57
    s_xor_b32 s58, s42, 1
    s_mul_i32 s43, s42, 20480
    s_mul_i32 s58, s58, 20480
    s_lshl_b32 s46, s57, 10
    s_add_u32 s43, s43, s46
    s_add_u32 s58, s58, s46
    buffer_load_dwordx4 v[104:107], v4, s[4:7], s43 offen offset:0
    buffer_load_dwordx4 v[108:111], v4, s[4:7], s58 offen offset:0
    buffer_load_dwordx4 v[112:115], v4, s[4:7], s43 offen offset:2048
    buffer_load_dwordx4 v[116:119], v4, s[4:7], s58 offen offset:2048
    s_add_u32 s43, s43, 4096
    s_add_u32 s58, s58, 4096
    buffer_load_dwordx4 v[120:123], v4, s[4:7], s43 offen offset:0
    buffer_load_dwordx4 v[124:127], v4, s[4:7], s58 offen offset:0
    buffer_load_dwordx4 v[128:131], v4, s[4:7], s43 offen offset:2048
    buffer_load_dwordx4 v[132:135], v4, s[4:7], s58 offen offset:2048
    v_and_b32 v2, 15, v0
    v_lshrrev_b32 v3, 4, v0
    s_lshl_b32 s46, s42, 4
    v_add_u32 v5, s46, v2
    s_mul_i32 s45, s33, 5
    v_lshlrev_b32 v1, 6, v5
    v_lshl_add_u32 v1, v3, 4, v1
    buffer_load_dwordx4 v[136:139], v1, s[24:27], 0 offen offset:0
    v_lshlrev_b32 v6, 4, v3
    s_lshl_b32 s47, s45, 6
    s_add_u32 s47, s47, 262144
    s_add_u32 s48, s47, 0x1000
    buffer_load_dwordx4 v[140:143], v6, s[24:27], s47 offen offset:0
    buffer_load_dwordx4 v[164:167], v6, s[24:27], s48 offen offset:0
    buffer_load_dwordx4 v[144:147], v6, s[24:27], s47 offen offset:64
    buffer_load_dwordx4 v[168:171], v6, s[24:27], s48 offen offset:64
    buffer_load_dwordx4 v[148:151], v6, s[24:27], s47 offen offset:128
    buffer_load_dwordx4 v[172:175], v6, s[24:27], s48 offen offset:128
    buffer_load_dwordx4 v[152:155], v6, s[24:27], s47 offen offset:192
    buffer_load_dwordx4 v[176:179], v6, s[24:27], s48 offen offset:192
    buffer_load_dwordx4 v[156:159], v6, s[24:27], s47 offen offset:256
    buffer_load_dwordx4 v[180:183], v6, s[24:27], s48 offen offset:256
    s_lshl_b32 s47, s44, 6
    s_add_u32 s47, s47, 264704
    s_add_u32 s48, s47, 0x1000
    buffer_load_dwordx4 v[160:163], v6, s[24:27], s47 offen
    buffer_load_dwordx4 v[184:187], v6, s[24:27], s48 offen
    s_mul_i32 s47, s57, 5120
    s_lshl_b32 s48, s57, 10
    v_add_u32 v188, s47, v4
    s_add_u32 s47, s47, 61440
    v_add_u32 v191, s48, v4
    s_add_u32 s48, s48, 61440
    v_add_u32 v189, s47, v4
    s_add_u32 s47, s47, 61440
    v_add_u32 v192, s48, v4
    s_add_u32 s48, s48, 61440
    v_add_u32 v190, s47, v4
    s_add_u32 s47, s47, 61440
    v_add_u32 v193, s48, v4
    s_add_u32 s48, s48, 61440
    s_barrier
    ds_read_b128 v[56:59], v188 offset:0
    ds_read_b128 v[60:63], v188 offset:1024
    ds_read_b128 v[64:67], v188 offset:2048
    ds_read_b128 v[68:71], v188 offset:3072
    ds_read_b128 v[72:75], v188 offset:4096
    ds_read_b128 v[76:79], v191 offset:10240
    s_waitcnt lgkmcnt(0)
    s_barrier
    ds_read_b128 v[80:83], v188 offset:12288
    ds_read_b128 v[84:87], v188 offset:13312
    s_waitcnt vmcnt(19)
    v_mfma_f32_16x16x32_bf16 v[32:35], v[56:59], v[108:111], 0
    ds_read_b128 v[88:91], v188 offset:14336
    v_mfma_f32_16x16x32_bf16 v[8:11], v[56:59], v[104:107], 0
    ds_read_b128 v[92:95], v188 offset:15360
    v_mfma_f32_16x16x32_bf16 v[36:39], v[60:63], v[108:111], 0
    ds_read_b128 v[96:99], v188 offset:16384
    v_mfma_f32_16x16x32_bf16 v[12:15], v[60:63], v[104:107], 0
    ds_read_b128 v[100:103], v191 offset:22528
    v_mfma_f32_16x16x32_bf16 v[40:43], v[64:67], v[108:111], 0
    v_mfma_f32_16x16x32_bf16 v[16:19], v[64:67], v[104:107], 0
    v_mfma_f32_16x16x32_bf16 v[44:47], v[68:71], v[108:111], 0
    v_mfma_f32_16x16x32_bf16 v[20:23], v[68:71], v[104:107], 0
    v_mfma_f32_16x16x32_bf16 v[48:51], v[72:75], v[108:111], 0
    v_mfma_f32_16x16x32_bf16 v[24:27], v[72:75], v[104:107], 0
    v_mfma_f32_16x16x32_bf16 v[52:55], v[76:79], v[108:111], 0
    v_mfma_f32_16x16x32_bf16 v[28:31], v[76:79], v[104:107], 0
    s_waitcnt lgkmcnt(0)
    s_barrier
    ds_read_b128 v[56:59], v188 offset:24576
    ds_read_b128 v[60:63], v188 offset:25600
    s_waitcnt vmcnt(17)
    v_mfma_f32_16x16x32_bf16 v[32:35], v[80:83], v[116:119], v[32:35]
    ds_read_b128 v[64:67], v188 offset:26624
    v_mfma_f32_16x16x32_bf16 v[8:11], v[80:83], v[112:115], v[8:11]
    ds_read_b128 v[68:71], v188 offset:27648
    v_mfma_f32_16x16x32_bf16 v[36:39], v[84:87], v[116:119], v[36:39]
    ds_read_b128 v[72:75], v188 offset:28672
    v_mfma_f32_16x16x32_bf16 v[12:15], v[84:87], v[112:115], v[12:15]
    ds_read_b128 v[76:79], v191 offset:34816
    v_mfma_f32_16x16x32_bf16 v[40:43], v[88:91], v[116:119], v[40:43]
    s_add_u32 s43, s43, 4096
    s_add_u32 s58, s58, 4096
    buffer_load_dwordx4 v[104:107], v4, s[4:7], s43 offen offset:0
    v_mfma_f32_16x16x32_bf16 v[16:19], v[88:91], v[112:115], v[16:19]
    v_mfma_f32_16x16x32_bf16 v[44:47], v[92:95], v[116:119], v[44:47]
    v_mfma_f32_16x16x32_bf16 v[20:23], v[92:95], v[112:115], v[20:23]
    v_mfma_f32_16x16x32_bf16 v[48:51], v[96:99], v[116:119], v[48:51]
    buffer_load_dwordx4 v[108:111], v4, s[4:7], s58 offen offset:0
    v_mfma_f32_16x16x32_bf16 v[24:27], v[96:99], v[112:115], v[24:27]
    v_mfma_f32_16x16x32_bf16 v[52:55], v[100:103], v[116:119], v[52:55]
    v_mfma_f32_16x16x32_bf16 v[28:31], v[100:103], v[112:115], v[28:31]
    s_waitcnt lgkmcnt(0)
    s_barrier
    ds_read_b128 v[80:83], v188 offset:36864
    ds_read_b128 v[84:87], v188 offset:37888
    s_waitcnt vmcnt(17)
    v_mfma_f32_16x16x32_bf16 v[32:35], v[56:59], v[124:127], v[32:35]
    ds_read_b128 v[88:91], v188 offset:38912
    v_mfma_f32_16x16x32_bf16 v[8:11], v[56:59], v[120:123], v[8:11]
    ds_read_b128 v[92:95], v188 offset:39936
    v_mfma_f32_16x16x32_bf16 v[36:39], v[60:63], v[124:127], v[36:39]
    ds_read_b128 v[96:99], v188 offset:40960
    v_mfma_f32_16x16x32_bf16 v[12:15], v[60:63], v[120:123], v[12:15]
    ds_read_b128 v[100:103], v191 offset:47104
    v_mfma_f32_16x16x32_bf16 v[40:43], v[64:67], v[124:127], v[40:43]
    buffer_load_dwordx4 v[112:115], v4, s[4:7], s43 offen offset:2048
    v_mfma_f32_16x16x32_bf16 v[16:19], v[64:67], v[120:123], v[16:19]
    v_mfma_f32_16x16x32_bf16 v[44:47], v[68:71], v[124:127], v[44:47]
    v_mfma_f32_16x16x32_bf16 v[20:23], v[68:71], v[120:123], v[20:23]
    v_mfma_f32_16x16x32_bf16 v[48:51], v[72:75], v[124:127], v[48:51]
    buffer_load_dwordx4 v[116:119], v4, s[4:7], s58 offen offset:2048
    v_mfma_f32_16x16x32_bf16 v[24:27], v[72:75], v[120:123], v[24:27]
    v_mfma_f32_16x16x32_bf16 v[52:55], v[76:79], v[124:127], v[52:55]
    v_mfma_f32_16x16x32_bf16 v[28:31], v[76:79], v[120:123], v[28:31]
    s_waitcnt lgkmcnt(0)
    s_barrier
    ds_read_b128 v[56:59], v188 offset:49152
    ds_read_b128 v[60:63], v188 offset:50176
    s_waitcnt vmcnt(17)
    v_mfma_f32_16x16x32_bf16 v[32:35], v[80:83], v[132:135], v[32:35]
    ds_read_b128 v[64:67], v188 offset:51200
    v_mfma_f32_16x16x32_bf16 v[8:11], v[80:83], v[128:131], v[8:11]
    ds_read_b128 v[68:71], v188 offset:52224
    v_mfma_f32_16x16x32_bf16 v[36:39], v[84:87], v[132:135], v[36:39]
    ds_read_b128 v[72:75], v188 offset:53248
    v_mfma_f32_16x16x32_bf16 v[12:15], v[84:87], v[128:131], v[12:15]
    ds_read_b128 v[76:79], v191 offset:59392
    v_mfma_f32_16x16x32_bf16 v[40:43], v[88:91], v[132:135], v[40:43]
    s_add_u32 s43, s43, 4096
    s_add_u32 s58, s58, 4096
    buffer_load_dwordx4 v[120:123], v4, s[4:7], s43 offen offset:0
    v_mfma_f32_16x16x32_bf16 v[16:19], v[88:91], v[128:131], v[16:19]
    v_mfma_f32_16x16x32_bf16 v[44:47], v[92:95], v[132:135], v[44:47]
    v_mfma_f32_16x16x32_bf16 v[20:23], v[92:95], v[128:131], v[20:23]
    v_mfma_f32_16x16x32_bf16 v[48:51], v[96:99], v[132:135], v[48:51]
    buffer_load_dwordx4 v[124:127], v4, s[4:7], s58 offen offset:0
    v_mfma_f32_16x16x32_bf16 v[24:27], v[96:99], v[128:131], v[24:27]
    v_mfma_f32_16x16x32_bf16 v[52:55], v[100:103], v[132:135], v[52:55]
    v_mfma_f32_16x16x32_bf16 v[28:31], v[100:103], v[128:131], v[28:31]
    s_waitcnt lgkmcnt(0)
    s_barrier
    ds_read_b128 v[80:83], v189 offset:0
    ds_read_b128 v[84:87], v189 offset:1024
    s_waitcnt vmcnt(4)
    v_mfma_f32_16x16x32_bf16 v[32:35], v[56:59], v[108:111], v[32:35]
    ds_read_b128 v[88:91], v189 offset:2048
    v_mfma_f32_16x16x32_bf16 v[8:11], v[56:59], v[104:107], v[8:11]
    ds_read_b128 v[92:95], v189 offset:3072
    v_mfma_f32_16x16x32_bf16 v[36:39], v[60:63], v[108:111], v[36:39]
    ds_read_b128 v[96:99], v189 offset:4096
    v_mfma_f32_16x16x32_bf16 v[12:15], v[60:63], v[104:107], v[12:15]
    ds_read_b128 v[100:103], v192 offset:10240
    v_mfma_f32_16x16x32_bf16 v[40:43], v[64:67], v[108:111], v[40:43]
    buffer_load_dwordx4 v[128:131], v4, s[4:7], s43 offen offset:2048
    v_mfma_f32_16x16x32_bf16 v[16:19], v[64:67], v[104:107], v[16:19]
    v_mfma_f32_16x16x32_bf16 v[44:47], v[68:71], v[108:111], v[44:47]
    v_mfma_f32_16x16x32_bf16 v[20:23], v[68:71], v[104:107], v[20:23]
    v_mfma_f32_16x16x32_bf16 v[48:51], v[72:75], v[108:111], v[48:51]
    buffer_load_dwordx4 v[132:135], v4, s[4:7], s58 offen offset:2048
    v_mfma_f32_16x16x32_bf16 v[24:27], v[72:75], v[104:107], v[24:27]
    v_mfma_f32_16x16x32_bf16 v[52:55], v[76:79], v[108:111], v[52:55]
    v_mfma_f32_16x16x32_bf16 v[28:31], v[76:79], v[104:107], v[28:31]
    s_waitcnt lgkmcnt(0)
    s_barrier
    ds_read_b128 v[56:59], v189 offset:12288
    ds_read_b128 v[60:63], v189 offset:13312
    s_waitcnt vmcnt(4)
    v_mfma_f32_16x16x32_bf16 v[32:35], v[80:83], v[116:119], v[32:35]
    ds_read_b128 v[64:67], v189 offset:14336
    v_mfma_f32_16x16x32_bf16 v[8:11], v[80:83], v[112:115], v[8:11]
    ds_read_b128 v[68:71], v189 offset:15360
    v_mfma_f32_16x16x32_bf16 v[36:39], v[84:87], v[116:119], v[36:39]
    ds_read_b128 v[72:75], v189 offset:16384
    v_mfma_f32_16x16x32_bf16 v[12:15], v[84:87], v[112:115], v[12:15]
    ds_read_b128 v[76:79], v192 offset:22528
    v_mfma_f32_16x16x32_bf16 v[40:43], v[88:91], v[116:119], v[40:43]
    s_add_u32 s43, s43, 4096
    s_add_u32 s58, s58, 4096
    buffer_load_dwordx4 v[104:107], v4, s[4:7], s43 offen offset:0
    v_mfma_f32_16x16x32_bf16 v[16:19], v[88:91], v[112:115], v[16:19]
    v_mfma_f32_16x16x32_bf16 v[44:47], v[92:95], v[116:119], v[44:47]
    v_mfma_f32_16x16x32_bf16 v[20:23], v[92:95], v[112:115], v[20:23]
    v_mfma_f32_16x16x32_bf16 v[48:51], v[96:99], v[116:119], v[48:51]
    buffer_load_dwordx4 v[108:111], v4, s[4:7], s58 offen offset:0
    v_mfma_f32_16x16x32_bf16 v[24:27], v[96:99], v[112:115], v[24:27]
    v_mfma_f32_16x16x32_bf16 v[52:55], v[100:103], v[116:119], v[52:55]
    v_mfma_f32_16x16x32_bf16 v[28:31], v[100:103], v[112:115], v[28:31]
    s_waitcnt lgkmcnt(0)
    s_barrier
    ds_read_b128 v[80:83], v189 offset:24576
    ds_read_b128 v[84:87], v189 offset:25600
    s_waitcnt vmcnt(4)
    v_mfma_f32_16x16x32_bf16 v[32:35], v[56:59], v[124:127], v[32:35]
    ds_read_b128 v[88:91], v189 offset:26624
    v_mfma_f32_16x16x32_bf16 v[8:11], v[56:59], v[120:123], v[8:11]
    ds_read_b128 v[92:95], v189 offset:27648
    v_mfma_f32_16x16x32_bf16 v[36:39], v[60:63], v[124:127], v[36:39]
    ds_read_b128 v[96:99], v189 offset:28672
    v_mfma_f32_16x16x32_bf16 v[12:15], v[60:63], v[120:123], v[12:15]
    ds_read_b128 v[100:103], v192 offset:34816
    v_mfma_f32_16x16x32_bf16 v[40:43], v[64:67], v[124:127], v[40:43]
    buffer_load_dwordx4 v[112:115], v4, s[4:7], s43 offen offset:2048
    v_mfma_f32_16x16x32_bf16 v[16:19], v[64:67], v[120:123], v[16:19]
    v_mfma_f32_16x16x32_bf16 v[44:47], v[68:71], v[124:127], v[44:47]
    v_mfma_f32_16x16x32_bf16 v[20:23], v[68:71], v[120:123], v[20:23]
    v_mfma_f32_16x16x32_bf16 v[48:51], v[72:75], v[124:127], v[48:51]
    buffer_load_dwordx4 v[116:119], v4, s[4:7], s58 offen offset:2048
    v_mfma_f32_16x16x32_bf16 v[24:27], v[72:75], v[120:123], v[24:27]
    v_mfma_f32_16x16x32_bf16 v[52:55], v[76:79], v[124:127], v[52:55]
    v_mfma_f32_16x16x32_bf16 v[28:31], v[76:79], v[120:123], v[28:31]
    s_waitcnt lgkmcnt(0)
    s_barrier
    ds_read_b128 v[56:59], v189 offset:36864
    ds_read_b128 v[60:63], v189 offset:37888
    s_waitcnt vmcnt(4)
    v_mfma_f32_16x16x32_bf16 v[32:35], v[80:83], v[132:135], v[32:35]
    ds_read_b128 v[64:67], v189 offset:38912
    v_mfma_f32_16x16x32_bf16 v[8:11], v[80:83], v[128:131], v[8:11]
    ds_read_b128 v[68:71], v189 offset:39936
    v_mfma_f32_16x16x32_bf16 v[36:39], v[84:87], v[132:135], v[36:39]
    ds_read_b128 v[72:75], v189 offset:40960
    v_mfma_f32_16x16x32_bf16 v[12:15], v[84:87], v[128:131], v[12:15]
    ds_read_b128 v[76:79], v192 offset:47104
    v_mfma_f32_16x16x32_bf16 v[40:43], v[88:91], v[132:135], v[40:43]
    v_mfma_f32_16x16x32_bf16 v[16:19], v[88:91], v[128:131], v[16:19]
    v_mfma_f32_16x16x32_bf16 v[44:47], v[92:95], v[132:135], v[44:47]
    v_mfma_f32_16x16x32_bf16 v[20:23], v[92:95], v[128:131], v[20:23]
    v_mfma_f32_16x16x32_bf16 v[48:51], v[96:99], v[132:135], v[48:51]
    v_mfma_f32_16x16x32_bf16 v[24:27], v[96:99], v[128:131], v[24:27]
    v_mfma_f32_16x16x32_bf16 v[52:55], v[100:103], v[132:135], v[52:55]
    v_mfma_f32_16x16x32_bf16 v[28:31], v[100:103], v[128:131], v[28:31]
    s_waitcnt lgkmcnt(0)
    s_barrier
    ds_read_b128 v[80:83], v189 offset:49152
    ds_read_b128 v[84:87], v189 offset:50176
    s_waitcnt vmcnt(2)
    v_mfma_f32_16x16x32_bf16 v[32:35], v[56:59], v[108:111], v[32:35]
    ds_read_b128 v[88:91], v189 offset:51200
    v_mfma_f32_16x16x32_bf16 v[8:11], v[56:59], v[104:107], v[8:11]
    ds_read_b128 v[92:95], v189 offset:52224
    v_mfma_f32_16x16x32_bf16 v[36:39], v[60:63], v[108:111], v[36:39]
    ds_read_b128 v[96:99], v189 offset:53248
    v_mfma_f32_16x16x32_bf16 v[12:15], v[60:63], v[104:107], v[12:15]
    ds_read_b128 v[100:103], v192 offset:59392
    v_mfma_f32_16x16x32_bf16 v[40:43], v[64:67], v[108:111], v[40:43]
    v_mfma_f32_16x16x32_bf16 v[16:19], v[64:67], v[104:107], v[16:19]
    v_mfma_f32_16x16x32_bf16 v[44:47], v[68:71], v[108:111], v[44:47]
    v_mfma_f32_16x16x32_bf16 v[20:23], v[68:71], v[104:107], v[20:23]
    v_mfma_f32_16x16x32_bf16 v[48:51], v[72:75], v[108:111], v[48:51]
    v_mfma_f32_16x16x32_bf16 v[24:27], v[72:75], v[104:107], v[24:27]
    v_mfma_f32_16x16x32_bf16 v[52:55], v[76:79], v[108:111], v[52:55]
    v_mfma_f32_16x16x32_bf16 v[28:31], v[76:79], v[104:107], v[28:31]
    s_waitcnt lgkmcnt(0)
    s_waitcnt vmcnt(0)
    v_mfma_f32_16x16x32_bf16 v[32:35], v[80:83], v[116:119], v[32:35]
    v_mfma_f32_16x16x32_bf16 v[36:39], v[84:87], v[116:119], v[36:39]
    v_mfma_f32_16x16x32_bf16 v[40:43], v[88:91], v[116:119], v[40:43]
    v_mfma_f32_16x16x32_bf16 v[44:47], v[92:95], v[116:119], v[44:47]
    v_mfma_f32_16x16x32_bf16 v[48:51], v[96:99], v[116:119], v[48:51]
    v_mfma_f32_16x16x32_bf16 v[52:55], v[100:103], v[116:119], v[52:55]
    v_mfma_f32_16x16x32_bf16 v[8:11], v[80:83], v[112:115], v[8:11]
    v_mfma_f32_16x16x32_bf16 v[12:15], v[84:87], v[112:115], v[12:15]
    v_mfma_f32_16x16x32_bf16 v[16:19], v[88:91], v[112:115], v[16:19]
    v_mfma_f32_16x16x32_bf16 v[20:23], v[92:95], v[112:115], v[20:23]
    v_mfma_f32_16x16x32_bf16 v[24:27], v[96:99], v[112:115], v[24:27]
    v_mfma_f32_16x16x32_bf16 v[28:31], v[100:103], v[112:115], v[28:31]
    s_mul_i32 s47, s40, 6144
    s_add_u32 s47, s47, 122880
    v_add_u32 v6, s47, v4
    s_xor_b32 s47, s40, 2
    s_mul_i32 s47, s47, 6144
    s_add_u32 s47, s47, 122880
    v_add_u32 v7, s47, v4
    ds_write_b128 v6, v[32:35] offset:0
    ds_write_b128 v6, v[36:39] offset:1024
    ds_write_b128 v6, v[40:43] offset:2048
    ds_write_b128 v6, v[44:47] offset:3072
    ds_write_b128 v6, v[48:51] offset:4096
    ds_write_b128 v6, v[52:55] offset:5120
    s_waitcnt lgkmcnt(0)
    s_barrier
    ds_read_b128 v[32:35], v7 offset:0
    ds_read_b128 v[36:39], v7 offset:1024
    ds_read_b128 v[40:43], v7 offset:2048
    ds_read_b128 v[44:47], v7 offset:3072
    ds_read_b128 v[48:51], v7 offset:4096
    ds_read_b128 v[52:55], v7 offset:5120
    s_waitcnt lgkmcnt(5)
    v_pk_add_f32 v[8:9], v[8:9], v[32:33]
    v_pk_add_f32 v[10:11], v[10:11], v[34:35]
    s_waitcnt lgkmcnt(4)
    v_pk_add_f32 v[12:13], v[12:13], v[36:37]
    v_pk_add_f32 v[14:15], v[14:15], v[38:39]
    s_waitcnt lgkmcnt(3)
    v_pk_add_f32 v[16:17], v[16:17], v[40:41]
    v_pk_add_f32 v[18:19], v[18:19], v[42:43]
    s_waitcnt lgkmcnt(2)
    v_pk_add_f32 v[20:21], v[20:21], v[44:45]
    v_pk_add_f32 v[22:23], v[22:23], v[46:47]
    s_waitcnt lgkmcnt(1)
    v_pk_add_f32 v[24:25], v[24:25], v[48:49]
    v_pk_add_f32 v[26:27], v[26:27], v[50:51]
    s_waitcnt lgkmcnt(0)
    v_pk_add_f32 v[28:29], v[28:29], v[52:53]
    v_pk_add_f32 v[30:31], v[30:31], v[54:55]
    v_add_f32 v136, v136, v138
    v_add_f32 v137, v137, v139
    v_mov_b32 v138, v136
    s_nop 1
    v_permlane16_swap_b32 v136, v138
    v_add_f32 v136, v136, v138
    v_mov_b32 v138, v136
    s_nop 1
    v_permlane32_swap_b32 v136, v138
    v_add_f32 v136, v136, v138
    v_mov_b32 v139, v137
    s_nop 1
    v_permlane16_swap_b32 v137, v139
    v_add_f32 v137, v137, v139
    v_mov_b32 v139, v137
    s_nop 1
    v_permlane32_swap_b32 v137, v139
    v_add_f32 v137, v137, v139
    v_mul_f32 v56, 0xbacccccd, v136
    v_mul_f32 v137, 0x3acccccd, v137
    v_fma_f32 v137, -v56, v56, v137
    v_max_f32 v137, 0, v137
    v_add_f32 v137, 0x3727c5ac, v137
    v_rsq_f32 v58, v137
    v_pk_add_f32 v[140:141], v[140:141], v[164:165]
    v_pk_add_f32 v[142:143], v[142:143], v[166:167]
    v_pk_add_f32 v[144:145], v[144:145], v[168:169]
    v_pk_add_f32 v[146:147], v[146:147], v[170:171]
    v_pk_add_f32 v[148:149], v[148:149], v[172:173]
    v_pk_add_f32 v[150:151], v[150:151], v[174:175]
    v_pk_add_f32 v[152:153], v[152:153], v[176:177]
    v_pk_add_f32 v[154:155], v[154:155], v[178:179]
    v_pk_add_f32 v[156:157], v[156:157], v[180:181]
    v_pk_add_f32 v[158:159], v[158:159], v[182:183]
    v_pk_add_f32 v[160:161], v[160:161], v[184:185]
    v_pk_add_f32 v[162:163], v[162:163], v[186:187]
    v_mul_f32 v60, 0x3ea52b5c, v58
    v_mul_u32_u24 v6, 1280, v5
    v_lshl_add_u32 v6, v3, 3, v6
    s_lshl_b32 s47, s45, 5
    v_pk_fma_f32 v[8:9], v[140:141], v[56:57], v[8:9] op_sel_hi:[1,0,1]
    v_pk_fma_f32 v[10:11], v[142:143], v[56:57], v[10:11] op_sel_hi:[1,0,1]
    v_pk_mul_f32 v[8:9], v[8:9], v[60:61] op_sel_hi:[1,0]
    v_pk_mul_f32 v[10:11], v[10:11], v[60:61] op_sel_hi:[1,0]
    v_cvt_pk_bf16_f32 v8, v8, v9
    v_cvt_pk_bf16_f32 v9, v10, v11
    buffer_store_dwordx2 v[8:9], v6, s[16:19], s47 offen offset:0
    v_pk_fma_f32 v[12:13], v[144:145], v[56:57], v[12:13] op_sel_hi:[1,0,1]
    v_pk_fma_f32 v[14:15], v[146:147], v[56:57], v[14:15] op_sel_hi:[1,0,1]
    v_pk_mul_f32 v[12:13], v[12:13], v[60:61] op_sel_hi:[1,0]
    v_pk_mul_f32 v[14:15], v[14:15], v[60:61] op_sel_hi:[1,0]
    v_cvt_pk_bf16_f32 v12, v12, v13
    v_cvt_pk_bf16_f32 v13, v14, v15
    buffer_store_dwordx2 v[12:13], v6, s[16:19], s47 offen offset:32
    v_pk_fma_f32 v[16:17], v[148:149], v[56:57], v[16:17] op_sel_hi:[1,0,1]
    v_pk_fma_f32 v[18:19], v[150:151], v[56:57], v[18:19] op_sel_hi:[1,0,1]
    v_pk_mul_f32 v[16:17], v[16:17], v[60:61] op_sel_hi:[1,0]
    v_pk_mul_f32 v[18:19], v[18:19], v[60:61] op_sel_hi:[1,0]
    v_cvt_pk_bf16_f32 v16, v16, v17
    v_cvt_pk_bf16_f32 v17, v18, v19
    buffer_store_dwordx2 v[16:17], v6, s[16:19], s47 offen offset:64
    v_pk_fma_f32 v[20:21], v[152:153], v[56:57], v[20:21] op_sel_hi:[1,0,1]
    v_pk_fma_f32 v[22:23], v[154:155], v[56:57], v[22:23] op_sel_hi:[1,0,1]
    v_pk_mul_f32 v[20:21], v[20:21], v[60:61] op_sel_hi:[1,0]
    v_pk_mul_f32 v[22:23], v[22:23], v[60:61] op_sel_hi:[1,0]
    v_cvt_pk_bf16_f32 v20, v20, v21
    v_cvt_pk_bf16_f32 v21, v22, v23
    buffer_store_dwordx2 v[20:21], v6, s[16:19], s47 offen offset:96
    v_pk_fma_f32 v[24:25], v[156:157], v[56:57], v[24:25] op_sel_hi:[1,0,1]
    v_pk_fma_f32 v[26:27], v[158:159], v[56:57], v[26:27] op_sel_hi:[1,0,1]
    v_pk_mul_f32 v[24:25], v[24:25], v[60:61] op_sel_hi:[1,0]
    v_pk_mul_f32 v[26:27], v[26:27], v[60:61] op_sel_hi:[1,0]
    v_cvt_pk_bf16_f32 v24, v24, v25
    v_cvt_pk_bf16_f32 v25, v26, v27
    buffer_store_dwordx2 v[24:25], v6, s[16:19], s47 offen offset:128
    v_pk_fma_f32 v[28:29], v[160:161], v[56:57], v[28:29] op_sel_hi:[1,0,1]
    v_pk_fma_f32 v[30:31], v[162:163], v[56:57], v[30:31] op_sel_hi:[1,0,1]
    v_pk_mul_f32 v[28:29], v[28:29], v[58:59] op_sel_hi:[1,0]
    v_pk_mul_f32 v[30:31], v[30:31], v[58:59] op_sel_hi:[1,0]
    v_cvt_pk_bf16_f32 v28, v28, v29
    v_cvt_pk_bf16_f32 v29, v30, v31
    s_and_b32 s47, s40, 1
    s_mul_i32 s47, s47, 3
    s_add_u32 s47, s47, s44
    s_cmp_lg_u32 s47, s33
    s_cbranch_scc1 qkv_end
    s_lshl_b32 s47, s44, 2
    v_add_u32 v3, s47, v3
    v_lshrrev_b32 v6, 5, v5
    v_mul_u32_u24 v6, 3072, v6
    v_mov_b32 v1, 0x7ff00000
    v_and_b32 v7, 31, v5
    v_lshl_add_u32 v62, v7, 4, v6
    v_lshrrev_b32 v63, 1, v3
    v_lshl_add_u32 v62, v63, 9, v62
    v_and_b32 v63, 1, v3
    v_lshl_add_u32 v62, v63, 3, v62
    v_lshl_add_u32 v63, v7, 3, v6
    v_add_u32 v63, 1024, v63
    v_cmp_eq_u32 vcc, 4, v3
    s_nop 1
    v_cndmask_b32 v62, v62, v63, vcc
    v_cmp_gt_u32 vcc, 5, v3
    s_nop 1
    v_cndmask_b32 v62, v1, v62, vcc
    buffer_store_dwordx2 v[28:29], v62, s[28:31], 0 offen
    v_bfe_u32 v7, v5, 4, 1
    v_mul_u32_u24 v7, 896, v7
    v_add_u32 v6, v6, v7
    v_bfe_u32 v7, v5, 2, 1
    v_mul_u32_u24 v7, 448, v7
    v_add_u32 v6, v6, v7
    v_bfe_u32 v7, v5, 3, 1
    v_lshl_add_u32 v6, v7, 3, v6
    v_and_b32 v7, 3, v5
    v_lshl_add_u32 v6, v7, 1, v6
    v_lshl_add_u32 v6, v3, 6, v6
    v_subrev_u32 v7, 5, v3
    v_cmp_gt_u32 vcc, 6, v7
    s_nop 1
    v_cndmask_b32 v6, v1, v6, vcc
    v_cmp_eq_u32 vcc, 10, v3
    v_mov_b32 v7, 0x3f80
    s_nop 0
    v_cndmask_b32 v30, v28, v7, vcc
    v_cndmask_b32 v31, v29, 0, vcc
    buffer_store_short v30, v6, s[28:31], 0 offen offset:960
    buffer_store_short_d16_hi v30, v6, s[28:31], 0 offen offset:976
    buffer_store_short v31, v6, s[28:31], 0 offen offset:992
    buffer_store_short_d16_hi v31, v6, s[28:31], 0 offen offset:1008
qkv_end:
    s_endpgm
qkv_loader:
    v_lshlrev_b32 v4, 4, v0
    s_sub_u32 s42, s40, 4
    s_mul_i32 s43, s33, 102400
    s_add_u32 s43, s43, s41
    s_mul_i32 s46, s42, 5120
    s_add_u32 s43, s43, s46
    s_mul_i32 s45, s44, 20480
    s_add_u32 s45, s45, 1638400
    s_lshl_b32 s47, s42, 10
    s_add_u32 s45, s45, s47
    s_add_u32 s47, s47, 10240
    s_mov_b32 s50, 0
    s_add_u32 m0, s50, s46
    s_nop 0
    buffer_load_dwordx4 v4, s[8:11], s43 offen offset:0 lds
    buffer_load_dwordx4 v4, s[8:11], s43 offen offset:1024 lds
    buffer_load_dwordx4 v4, s[8:11], s43 offen offset:2048 lds
    buffer_load_dwordx4 v4, s[8:11], s43 offen offset:3072 lds
    s_add_u32 m0, m0, 4096
    s_add_u32 s43, s43, 4096
    buffer_load_dwordx4 v4, s[8:11], s43 offen lds
    s_add_u32 s43, s43, 6144
    s_add_u32 m0, s50, s47
    s_nop 0
    buffer_load_dwordx4 v4, s[8:11], s45 offen lds
    s_add_u32 s45, s45, 2048
    s_add_u32 s50, s50, 12288
    s_add_u32 m0, s50, s46
    s_nop 0
    buffer_load_dwordx4 v4, s[8:11], s43 offen offset:0 lds
    buffer_load_dwordx4 v4, s[8:11], s43 offen offset:1024 lds
    buffer_load_dwordx4 v4, s[8:11], s43 offen offset:2048 lds
    buffer_load_dwordx4 v4, s[8:11], s43 offen offset:3072 lds
    s_add_u32 m0, m0, 4096
    s_add_u32 s43, s43, 4096
    buffer_load_dwordx4 v4, s[8:11], s43 offen lds
    s_add_u32 s43, s43, 6144
    s_add_u32 m0, s50, s47
    s_nop 0
    buffer_load_dwordx4 v4, s[8:11], s45 offen lds
    s_add_u32 s45, s45, 2048
    s_add_u32 s50, s50, 12288
    s_add_u32 m0, s50, s46
    s_nop 0
    buffer_load_dwordx4 v4, s[8:11], s43 offen offset:0 lds
    buffer_load_dwordx4 v4, s[8:11], s43 offen offset:1024 lds
    buffer_load_dwordx4 v4, s[8:11], s43 offen offset:2048 lds
    buffer_load_dwordx4 v4, s[8:11], s43 offen offset:3072 lds
    s_add_u32 m0, m0, 4096
    s_add_u32 s43, s43, 4096
    buffer_load_dwordx4 v4, s[8:11], s43 offen lds
    s_add_u32 s43, s43, 6144
    s_add_u32 m0, s50, s47
    s_nop 0
    buffer_load_dwordx4 v4, s[8:11], s45 offen lds
    s_add_u32 s45, s45, 2048
    s_add_u32 s50, s50, 12288
    s_mov_b32 s51, 7
qkv_lloop:
    s_waitcnt vmcnt(12)
    s_barrier
    s_add_u32 m0, s50, s46
    s_nop 0
    buffer_load_dwordx4 v4, s[8:11], s43 offen offset:0 lds
    buffer_load_dwordx4 v4, s[8:11], s43 offen offset:1024 lds
    buffer_load_dwordx4 v4, s[8:11], s43 offen offset:2048 lds
    buffer_load_dwordx4 v4, s[8:11], s43 offen offset:3072 lds
    s_add_u32 m0, m0, 4096
    s_add_u32 s43, s43, 4096
    buffer_load_dwordx4 v4, s[8:11], s43 offen lds
    s_add_u32 s43, s43, 6144
    s_add_u32 m0, s50, s47
    s_nop 0
    buffer_load_dwordx4 v4, s[8:11], s45 offen lds
    s_add_u32 s45, s45, 2048
    s_add_u32 s50, s50, 12288
    s_sub_u32 s51, s51, 1
    s_cmp_lg_u32 s51, 0
    s_cbranch_scc1 qkv_lloop
    s_waitcnt vmcnt(12)
    s_barrier
    s_waitcnt vmcnt(6)
    s_barrier
    s_waitcnt vmcnt(0)
    s_barrier
    s_endpgm
.globl f1_kernel
.p2align 8
.type f1_kernel,@function
f1_kernel:
    s_mov_b32 s69, 17825792
    s_mov_b32 s94, 0
    s_mov_b32 s68, 294912
    s_branch f_common
.globl f2_kernel
.p2align 8
.type f2_kernel,@function
f2_kernel:
    s_mov_b32 s69, 8388608
    s_mov_b32 s94, 1
    s_mov_b32 s68, 360448
f_common:
    s_cmp_ge_u32 s2, 256
    s_cbranch_scc1 f_exit
    s_load_dwordx2 s[36:37], s[0:1], 88
    s_load_dwordx2 s[66:67], s[0:1], 72
    v_lshrrev_b32 v1, 6, v0
    s_nop 0
    v_readfirstlane_b32 s40, v1
    v_and_b32 v0, 63, v0
    s_and_b32 s34, s2, 7
    s_lshl_b32 s34, s34, 5
    s_lshr_b32 s35, s2, 3
    s_add_u32 s34, s34, s35
    s_lshl_b32 s34, s34, 3
    s_add_u32 s34, s34, s40
    s_mul_i32 s35, s34, 1280
    s_mul_i32 s41, s40, 3072
    v_and_b32 v2, 31, v0
    v_lshrrev_b32 v3, 5, v0
    v_mul_u32_u24 v1, 40, v2
    v_lshl_add_u32 v98, v3, 3, v1
    v_lshl_add_u32 v36, v3, 4, v1
    v_lshlrev_b32 v97, 4, v0
    v_lshlrev_b32 v101, 2, v2
    v_mov_b32 v102, 0
    s_waitcnt lgkmcnt(0)
    s_mov_b32 s4, s36
    s_mov_b32 s5, s37
    s_mov_b32 s6, 0x280000
    s_mov_b32 s7, 0x20000
    s_lshl_b32 s8, s94, 18
    s_add_u32 s8, s8, 2621440
    s_add_u32 s8, s36, s8
    s_addc_u32 s9, s37, 0
    s_mov_b32 s10, 196608
    s_mov_b32 s11, 0x20000
    s_add_u32 s16, s36, 0x300000
    s_addc_u32 s17, s37, 0
    s_mov_b32 s18, 0x280000
    s_mov_b32 s19, 0x20000
    s_add_u32 s20, s36, s69
    s_addc_u32 s21, s37, 0
    s_mov_b32 s22, 2621440
    s_mov_b32 s23, 0x20000
    s_add_u32 s24, s36, 0x1080000
    s_addc_u32 s25, s37, 0
    s_mov_b32 s26, 0x68000
    s_mov_b32 s27, 0x20000
    s_mov_b32 s28, s36
    s_mov_b32 s29, s37
    s_mov_b32 s30, 0x1ac0000
    s_mov_b32 s31, 0x20000
    buffer_load_dwordx4 v[4:7], v36, s[4:7], s35 offen
    buffer_load_dwordx2 v[8:9], v1, s[4:7], s35 offen offset:32
    s_mov_b32 s42, s41
    s_mov_b32 m0, s42
    s_nop 0
    buffer_load_dwordx4 v97, s[8:11], s42 offen offset:0 lds
    buffer_load_dwordx4 v97, s[8:11], s42 offen offset:1024 lds
    buffer_load_dwordx4 v97, s[8:11], s42 offen offset:2048 lds
    s_add_u32 s42, s42, 24576
    s_mov_b32 m0, s42
    s_nop 0
    buffer_load_dwordx4 v97, s[8:11], s42 offen offset:0 lds
    buffer_load_dwordx4 v97, s[8:11], s42 offen offset:1024 lds
    buffer_load_dwordx4 v97, s[8:11], s42 offen offset:2048 lds
    s_add_u32 s42, s42, 24576
    v_mov_b32 v94, v97
    v_lshlrev_b32 v95, 3, v2
    v_add_u32 v95, 1024, v95
    v_min_u32 v1, 21, v2
    v_lshlrev_b32 v1, 4, v1
    v_mul_u32_u24 v96, 448, v3
    v_add3_u32 v96, v96, v1, 0
    v_add_u32 v96, 1280, v96
    v_mov_b32 v10, 0
    v_mov_b32 v11, 0
    v_mov_b32 v18, 0
    v_mov_b32 v19, 0
    v_mov_b32 v32, 0
    v_mov_b32 v33, 0
    v_mov_b32 v72, 0
    v_mov_b32 v73, 0
    v_mov_b32 v74, 0
    v_mov_b32 v75, 0
    v_mov_b32 v76, 0
    v_mov_b32 v77, 0
    v_mov_b32 v78, 0
    v_mov_b32 v79, 0
    v_mov_b32 v80, 0
    v_mov_b32 v81, 0
    v_mov_b32 v82, 0
    v_mov_b32 v83, 0
    v_mov_b32 v84, 0
    v_mov_b32 v85, 0
    v_mov_b32 v86, 0
    v_mov_b32 v87, 0
    v_cmp_eq_u32 vcc, 0, v3
    s_mov_b32 s44, 0
    s_cmp_ge_u32 s40, 4
    s_cselect_b32 s61, 60, 0
    s_bitset1_b32 s61, 7
    s_cselect_b32 s62, 2, 32
    s_mov_b32 s45, 0
    s_waitcnt vmcnt(3)
    v_mov_b32 v36, 0
    v_mov_b32 v37, 0
    v_mov_b32 v38, 0
    v_mov_b32 v39, 0
    v_cndmask_b32 v8, 0, v8, vcc
    v_cndmask_b32 v9, 0, v9, vcc
    s_barrier
    ds_read_b128 v[12:15], v94
    ds_read_b64 v[16:17], v95
    s_mov_b32 m0, s42
    s_nop 0
    buffer_load_dwordx4 v97, s[8:11], s42 offen offset:0 lds
    buffer_load_dwordx4 v97, s[8:11], s42 offen offset:1024 lds
    buffer_load_dwordx4 v97, s[8:11], s42 offen offset:2048 lds
    s_add_u32 s42, s42, 24576
    s_mov_b32 s43, s42
    s_and_b32 s33, s2, 7
    s_lshl_b32 s33, s33, 7
    s_add_u32 s33, s33, s68
    s_add_u32 s33, s33, 40960
    s_cmp_lg_u32 s40, 0
    s_cbranch_scc1 attn_nx
    s_getreg_b32 s52, hwreg(HW_REG_XCC_ID, 0, 16)
    s_add_u32 s52, s52, 1
    s_lshr_b32 s53, s2, 3
    s_lshl_b32 s53, s53, 2
    v_mov_b32 v99, s52
    v_mov_b32 v100, s53
    s_mov_b64 exec, 1
    buffer_store_dword v99, v100, s[24:27], s33 offen sc1
    s_mov_b64 exec, -1
attn_nx:
    s_waitcnt lgkmcnt(0)
    v_mfma_f32_32x32x16_bf16 v[40:55], v[12:15], v[4:7], 0
    v_mfma_f32_32x32x16_bf16 v[40:55], v[16:19], v[8:11], v[40:55]
    s_nop 7
    ds_read_b128 v[12:15], v94 offset:3072
    ds_read_b64 v[16:17], v95 offset:3072
    ds_read_b128 v[24:27], v96 offset:896
    ds_read_b128 v[20:23], v96
    s_nop 7
    v_mul_u32_u24 v98, 128, v0
    s_xor_b32 s52, s34, 128
    v_mul_u32_u24 v99, 205, v0
    v_lshrrev_b32 v99, 11, v99
    v_mul_u32_u24 v99, 2620160, v99
    v_add_u32 v99, v99, v98
    s_mul_i32 s53, s52, 1280
    s_add_u32 s53, s53, 3145728
    v_add_u32 v99, s53, v99
    s_mul_i32 s53, s52, 3072
    s_add_u32 s53, s53, 11006208
    v_add_u32 v100, s53, v98
    v_cmp_gt_u32 vcc, 30, v0
    s_nop 1
    v_cndmask_b32 v99, v100, v99, vcc
    s_lshr_b32 s53, s52, 3
    s_lshl_b32 s53, s53, 2
    s_and_b32 s54, s40, 3
    s_add_u32 s53, s53, s54
    s_lshl_b32 s53, s53, 7
    s_lshr_b32 s54, s40, 2
    s_lshl_b32 s54, s54, 17
    s_add_u32 s53, s53, s54
    s_add_u32 s53, s53, 17301504
    v_mov_b32 v100, s53
    v_cmp_gt_u32 vcc, 54, v0
    s_nop 1
    v_cndmask_b32 v1, v100, v99, vcc
    v_add_u32 v88, 49152, v94
    v_add_u32 v89, 49152, v95
    v_add_u32 v90, 49152, v96
    s_lshr_b32 s45, s40, 2
    s_lshr_b32 s54, s2, 3
    s_and_b32 s46, s54, 7
    s_mul_i32 s53, s46, 102400
    s_add_u32 s53, s53, 21266432
    s_mul_i32 s46, s46, 245760
    s_mul_i32 s55, s40, 5120
    s_add_u32 s46, s46, s55
    s_and_b32 s52, s54, 15
    s_mul_i32 s52, s52, 384
    s_cmp_eq_u32 s45, 0
    s_cselect_b32 s46, s52, s46
    v_and_b32 v91, 48, v0
    s_cbranch_scc1 attn_c0
    v_mov_b32 v91, v97
    s_setprio 1
attn_c0:
    s_lshl3_add_u32 s52, s54, s40
    s_lshr_b32 s54, s52, 4
    s_and_b32 s52, s52, 15
    s_mul_i32 s54, s54, 245760
    s_mul_i32 s52, s52, 7680
    s_add_u32 s52, s52, s54
    s_add_u32 s52, s52, 24117248
    s_waitcnt lgkmcnt(2)
    v_mfma_f32_32x32x16_bf16 v[56:71], v[12:15], v[4:7], 0
    v_cvt_pk_bf16_f32 v34, v36, v37
    v_cvt_pk_bf16_f32 v35, v38, v39
    v_exp_f32 v40, v40
    v_exp_f32 v41, v41
    v_exp_f32 v42, v42
    v_exp_f32 v43, v43
    v_mfma_f32_32x32x16_bf16 v[56:71], v[16:19], v[8:11], v[56:71]
    s_mul_i32 s54, s45, 4634624
    s_add_u32 s54, s54, s46
    s_add_u32 s54, s54, 17577984
    buffer_load_dwordx4 v[116:119], v91, s[28:31], s54 offen
    ds_read_b128 v[12:15], v94 offset:6144
    ds_read_b64 v[16:17], v95 offset:6144
    v_cvt_pk_bf16_f32 v28, v40, v41
    v_cvt_pk_bf16_f32 v29, v42, v43
    v_exp_f32 v44, v44
    v_exp_f32 v45, v45
    v_exp_f32 v46, v46
    v_exp_f32 v47, v47
    s_waitcnt lgkmcnt(3)
    v_mfma_f32_32x32x16_bf16 v[72:87], v[24:27], v[32:35], v[72:87]
    ds_read_b128 v[24:27], v96 offset:896
    v_cvt_pk_bf16_f32 v30, v44, v45
    v_cvt_pk_bf16_f32 v31, v46, v47
    v_exp_f32 v48, v48
    v_exp_f32 v49, v49
    v_exp_f32 v50, v50
    v_exp_f32 v51, v51
    s_waitcnt lgkmcnt(3)
    v_mfma_f32_32x32x16_bf16 v[72:87], v[20:23], v[28:31], v[72:87]
    ds_read_b128 v[20:23], v96 offset:3072
    v_cvt_pk_bf16_f32 v32, v48, v49
    v_cvt_pk_bf16_f32 v33, v50, v51
    v_exp_f32 v36, v52
    v_exp_f32 v37, v53
    v_exp_f32 v38, v54
    v_exp_f32 v39, v55
    s_waitcnt lgkmcnt(2)
    v_mfma_f32_32x32x16_bf16 v[40:55], v[12:15], v[4:7], 0
    v_cvt_pk_bf16_f32 v34, v36, v37
    v_cvt_pk_bf16_f32 v35, v38, v39
    v_exp_f32 v56, v56
    v_exp_f32 v57, v57
    v_exp_f32 v58, v58
    v_exp_f32 v59, v59
    v_mfma_f32_32x32x16_bf16 v[40:55], v[16:19], v[8:11], v[40:55]
    s_mul_i32 s54, s45, 4635648
    s_add_u32 s54, s54, s46
    s_add_u32 s54, s54, 17577984
    buffer_load_dwordx4 v[120:123], v91, s[28:31], s54 offen
    ds_read_b128 v[12:15], v94 offset:9216
    ds_read_b64 v[16:17], v95 offset:9216
    v_cvt_pk_bf16_f32 v28, v56, v57
    v_cvt_pk_bf16_f32 v29, v58, v59
    v_exp_f32 v60, v60
    v_exp_f32 v61, v61
    v_exp_f32 v62, v62
    v_exp_f32 v63, v63
    s_waitcnt lgkmcnt(3)
    v_mfma_f32_32x32x16_bf16 v[72:87], v[24:27], v[32:35], v[72:87]
    ds_read_b128 v[24:27], v96 offset:3968
    v_cvt_pk_bf16_f32 v30, v60, v61
    v_cvt_pk_bf16_f32 v31, v62, v63
    v_exp_f32 v64, v64
    v_exp_f32 v65, v65
    v_exp_f32 v66, v66
    v_exp_f32 v67, v67
    s_waitcnt lgkmcnt(3)
    v_mfma_f32_32x32x16_bf16 v[72:87], v[20:23], v[28:31], v[72:87]
    s_bfm_b64 exec, 8, 0
    buffer_load_dword v103, v1, s[28:31], 0 offen
    s_mov_b64 exec, -1
    ds_read_b128 v[20:23], v96 offset:6144
    v_cvt_pk_bf16_f32 v32, v64, v65
    v_cvt_pk_bf16_f32 v33, v66, v67
    v_exp_f32 v36, v68
    v_exp_f32 v37, v69
    v_exp_f32 v38, v70
    v_exp_f32 v39, v71
    s_waitcnt lgkmcnt(2)
    v_mfma_f32_32x32x16_bf16 v[56:71], v[12:15], v[4:7], 0
    v_cvt_pk_bf16_f32 v34, v36, v37
    v_cvt_pk_bf16_f32 v35, v38, v39
    v_exp_f32 v40, v40
    v_exp_f32 v41, v41
    v_exp_f32 v42, v42
    v_exp_f32 v43, v43
    v_mfma_f32_32x32x16_bf16 v[56:71], v[16:19], v[8:11], v[56:71]
    s_mul_i32 s54, s45, 4636672
    s_add_u32 s54, s54, s46
    s_add_u32 s54, s54, 17577984
    buffer_load_dwordx4 v[124:127], v91, s[28:31], s54 offen
    ds_read_b128 v[12:15], v94 offset:12288
    ds_read_b64 v[16:17], v95 offset:12288
    v_cvt_pk_bf16_f32 v28, v40, v41
    v_cvt_pk_bf16_f32 v29, v42, v43
    v_exp_f32 v44, v44
    v_exp_f32 v45, v45
    v_exp_f32 v46, v46
    v_exp_f32 v47, v47
    s_waitcnt lgkmcnt(3)
    v_mfma_f32_32x32x16_bf16 v[72:87], v[24:27], v[32:35], v[72:87]
    ds_read_b128 v[24:27], v96 offset:7040
    v_cvt_pk_bf16_f32 v30, v44, v45
    v_cvt_pk_bf16_f32 v31, v46, v47
    v_exp_f32 v48, v48
    v_exp_f32 v49, v49
    v_exp_f32 v50, v50
    v_exp_f32 v51, v51
    s_waitcnt lgkmcnt(3)
    v_mfma_f32_32x32x16_bf16 v[72:87], v[20:23], v[28:31], v[72:87]
    ds_read_b128 v[20:23], v96 offset:9216
    v_cvt_pk_bf16_f32 v32, v48, v49
    v_cvt_pk_bf16_f32 v33, v50, v51
    v_exp_f32 v36, v52
    v_exp_f32 v37, v53
    v_exp_f32 v38, v54
    v_exp_f32 v39, v55
    s_waitcnt lgkmcnt(2)
    v_mfma_f32_32x32x16_bf16 v[40:55], v[12:15], v[4:7], 0
    v_cvt_pk_bf16_f32 v34, v36, v37
    v_cvt_pk_bf16_f32 v35, v38, v39
    v_exp_f32 v56, v56
    v_exp_f32 v57, v57
    v_exp_f32 v58, v58
    v_exp_f32 v59, v59
    v_mfma_f32_32x32x16_bf16 v[40:55], v[16:19], v[8:11], v[40:55]
    s_mul_i32 s54, s45, 4637696
    s_add_u32 s54, s54, s46
    s_add_u32 s54, s54, 17577984
    buffer_load_dwordx4 v[128:131], v91, s[28:31], s54 offen
    ds_read_b128 v[12:15], v94 offset:15360
    ds_read_b64 v[16:17], v95 offset:15360
    v_cvt_pk_bf16_f32 v28, v56, v57
    v_cvt_pk_bf16_f32 v29, v58, v59
    v_exp_f32 v60, v60
    v_exp_f32 v61, v61
    v_exp_f32 v62, v62
    v_exp_f32 v63, v63
    s_waitcnt lgkmcnt(3)
    v_mfma_f32_32x32x16_bf16 v[72:87], v[24:27], v[32:35], v[72:87]
    ds_read_b128 v[24:27], v96 offset:10112
    v_cvt_pk_bf16_f32 v30, v60, v61
    v_cvt_pk_bf16_f32 v31, v62, v63
    v_exp_f32 v64, v64
    v_exp_f32 v65, v65
    v_exp_f32 v66, v66
    v_exp_f32 v67, v67
    s_waitcnt lgkmcnt(3)
    v_mfma_f32_32x32x16_bf16 v[72:87], v[20:23], v[28:31], v[72:87]
    s_bfm_b64 exec, 8, 8
    buffer_load_dword v103, v1, s[28:31], 0 offen
    s_mov_b64 exec, -1
    ds_read_b128 v[20:23], v96 offset:12288
    v_cvt_pk_bf16_f32 v32, v64, v65
    v_cvt_pk_bf16_f32 v33, v66, v67
    v_exp_f32 v36, v68
    v_exp_f32 v37, v69
    v_exp_f32 v38, v70
    v_exp_f32 v39, v71
    s_waitcnt lgkmcnt(2)
    v_mfma_f32_32x32x16_bf16 v[56:71], v[12:15], v[4:7], 0
    v_cvt_pk_bf16_f32 v34, v36, v37
    v_cvt_pk_bf16_f32 v35, v38, v39
    v_exp_f32 v40, v40
    v_exp_f32 v41, v41
    v_exp_f32 v42, v42
    v_exp_f32 v43, v43
    v_mfma_f32_32x32x16_bf16 v[56:71], v[16:19], v[8:11], v[56:71]
    s_mul_i32 s54, s45, 4638720
    s_add_u32 s54, s54, s46
    s_add_u32 s54, s54, 17577984
    buffer_load_dwordx4 v[132:135], v91, s[28:31], s54 offen
    s_setprio 0
    ds_read_b128 v[12:15], v94 offset:18432
    ds_read_b64 v[16:17], v95 offset:18432
    v_cvt_pk_bf16_f32 v28, v40, v41
    v_cvt_pk_bf16_f32 v29, v42, v43
    v_exp_f32 v44, v44
    v_exp_f32 v45, v45
    v_exp_f32 v46, v46
    v_exp_f32 v47, v47
    s_waitcnt lgkmcnt(3)
    v_mfma_f32_32x32x16_bf16 v[72:87], v[24:27], v[32:35], v[72:87]
    ds_read_b128 v[24:27], v96 offset:13184
    v_cvt_pk_bf16_f32 v30, v44, v45
    v_cvt_pk_bf16_f32 v31, v46, v47
    v_exp_f32 v48, v48
    v_exp_f32 v49, v49
    v_exp_f32 v50, v50
    v_exp_f32 v51, v51
    s_waitcnt lgkmcnt(3)
    v_mfma_f32_32x32x16_bf16 v[72:87], v[20:23], v[28:31], v[72:87]
    ds_read_b128 v[20:23], v96 offset:15360
    v_cvt_pk_bf16_f32 v32, v48, v49
    v_cvt_pk_bf16_f32 v33, v50, v51
    v_exp_f32 v36, v52
    v_exp_f32 v37, v53
    v_exp_f32 v38, v54
    v_exp_f32 v39, v55
    s_waitcnt lgkmcnt(2)
    v_mfma_f32_32x32x16_bf16 v[40:55], v[12:15], v[4:7], 0
    v_cvt_pk_bf16_f32 v34, v36, v37
    v_cvt_pk_bf16_f32 v35, v38, v39
    v_exp_f32 v56, v56
    v_exp_f32 v57, v57
    v_exp_f32 v58, v58
    v_exp_f32 v59, v59
    v_mfma_f32_32x32x16_bf16 v[40:55], v[16:19], v[8:11], v[40:55]
    s_mul_i32 s54, s45, 4655104
    s_add_u32 s54, s54, s46
    s_add_u32 s54, s54, 17577984
    buffer_load_dwordx4 v[136:139], v91, s[28:31], s54 offen
    ds_read_b128 v[12:15], v94 offset:21504
    ds_read_b64 v[16:17], v95 offset:21504
    v_cvt_pk_bf16_f32 v28, v56, v57
    v_cvt_pk_bf16_f32 v29, v58, v59
    v_exp_f32 v60, v60
    v_exp_f32 v61, v61
    v_exp_f32 v62, v62
    v_exp_f32 v63, v63
    s_waitcnt lgkmcnt(3)
    v_mfma_f32_32x32x16_bf16 v[72:87], v[24:27], v[32:35], v[72:87]
    ds_read_b128 v[24:27], v96 offset:16256
    v_cvt_pk_bf16_f32 v30, v60, v61
    v_cvt_pk_bf16_f32 v31, v62, v63
    v_exp_f32 v64, v64
    v_exp_f32 v65, v65
    v_exp_f32 v66, v66
    v_exp_f32 v67, v67
    s_waitcnt lgkmcnt(3)
    v_mfma_f32_32x32x16_bf16 v[72:87], v[20:23], v[28:31], v[72:87]
    s_bfm_b64 exec, 8, 16
    buffer_load_dword v103, v1, s[28:31], 0 offen
    s_mov_b64 exec, -1
    ds_read_b128 v[20:23], v96 offset:18432
    v_cvt_pk_bf16_f32 v32, v64, v65
    v_cvt_pk_bf16_f32 v33, v66, v67
    v_exp_f32 v36, v68
    v_exp_f32 v37, v69
    v_exp_f32 v38, v70
    v_exp_f32 v39, v71
    s_waitcnt lgkmcnt(2)
    v_mfma_f32_32x32x16_bf16 v[56:71], v[12:15], v[4:7], 0
    v_cvt_pk_bf16_f32 v34, v36, v37
    v_cvt_pk_bf16_f32 v35, v38, v39
    v_exp_f32 v40, v40
    v_exp_f32 v41, v41
    v_exp_f32 v42, v42
    v_exp_f32 v43, v43
    v_mfma_f32_32x32x16_bf16 v[56:71], v[16:19], v[8:11], v[56:71]
    s_waitcnt vmcnt(12)
    s_barrier
    s_add_u32 m0, s41, 73728
    s_nop 0
    buffer_load_dwordx4 v97, s[8:11], s42 offen offset:0 lds
    buffer_load_dwordx4 v97, s[8:11], s42 offen offset:1024 lds
    buffer_load_dwordx4 v97, s[8:11], s42 offen offset:2048 lds
    s_add_u32 s42, s42, 24576
    s_cmp_lt_u32 s40, 4
    s_cbranch_scc1 attn_p0
    s_setprio 1
attn_p0:
    ds_read_b128 v[12:15], v94 offset:24576
    ds_read_b64 v[16:17], v95 offset:24576
    v_cvt_pk_bf16_f32 v28, v40, v41
    v_cvt_pk_bf16_f32 v29, v42, v43
    v_exp_f32 v44, v44
    v_exp_f32 v45, v45
    v_exp_f32 v46, v46
    v_exp_f32 v47, v47
    s_waitcnt lgkmcnt(3)
    v_mfma_f32_32x32x16_bf16 v[72:87], v[24:27], v[32:35], v[72:87]
    ds_read_b128 v[24:27], v96 offset:19328
    v_cvt_pk_bf16_f32 v30, v44, v45
    v_cvt_pk_bf16_f32 v31, v46, v47
    v_exp_f32 v48, v48
    v_exp_f32 v49, v49
    v_exp_f32 v50, v50
    v_exp_f32 v51, v51
    s_waitcnt lgkmcnt(3)
    v_mfma_f32_32x32x16_bf16 v[72:87], v[20:23], v[28:31], v[72:87]
    ds_read_b128 v[20:23], v96 offset:21504
    v_cvt_pk_bf16_f32 v32, v48, v49
    v_cvt_pk_bf16_f32 v33, v50, v51
    v_exp_f32 v36, v52
    v_exp_f32 v37, v53
    v_exp_f32 v38, v54
    v_exp_f32 v39, v55
    s_waitcnt lgkmcnt(2)
    v_mfma_f32_32x32x16_bf16 v[40:55], v[12:15], v[4:7], 0
    v_cvt_pk_bf16_f32 v34, v36, v37
    v_cvt_pk_bf16_f32 v35, v38, v39
    v_exp_f32 v56, v56
    v_exp_f32 v57, v57
    v_exp_f32 v58, v58
    v_exp_f32 v59, v59
    v_mfma_f32_32x32x16_bf16 v[40:55], v[16:19], v[8:11], v[40:55]
    s_mul_i32 s54, s45, 4656128
    s_add_u32 s54, s54, s46
    s_add_u32 s54, s54, 17577984
    buffer_load_dwordx4 v[140:143], v91, s[28:31], s54 offen
    ds_read_b128 v[12:15], v94 offset:27648
    ds_read_b64 v[16:17], v95 offset:27648
    v_cvt_pk_bf16_f32 v28, v56, v57
    v_cvt_pk_bf16_f32 v29, v58, v59
    v_exp_f32 v60, v60
    v_exp_f32 v61, v61
    v_exp_f32 v62, v62
    v_exp_f32 v63, v63
    s_waitcnt lgkmcnt(3)
    v_mfma_f32_32x32x16_bf16 v[72:87], v[24:27], v[32:35], v[72:87]
    ds_read_b128 v[24:27], v96 offset:22400
    v_cvt_pk_bf16_f32 v30, v60, v61
    v_cvt_pk_bf16_f32 v31, v62, v63
    v_exp_f32 v64, v64
    v_exp_f32 v65, v65
    v_exp_f32 v66, v66
    v_exp_f32 v67, v67
    s_waitcnt lgkmcnt(3)
    v_mfma_f32_32x32x16_bf16 v[72:87], v[20:23], v[28:31], v[72:87]
    s_bfm_b64 exec, 8, 24
    buffer_load_dword v103, v1, s[28:31], 0 offen
    s_mov_b64 exec, -1
    ds_read_b128 v[20:23], v96 offset:24576
    v_cvt_pk_bf16_f32 v32, v64, v65
    v_cvt_pk_bf16_f32 v33, v66, v67
    v_exp_f32 v36, v68
    v_exp_f32 v37, v69
    v_exp_f32 v38, v70
    v_exp_f32 v39, v71
    s_waitcnt lgkmcnt(2)
    v_mfma_f32_32x32x16_bf16 v[56:71], v[12:15], v[4:7], 0
    v_cvt_pk_bf16_f32 v34, v36, v37
    v_cvt_pk_bf16_f32 v35, v38, v39
    v_exp_f32 v40, v40
    v_exp_f32 v41, v41
    v_exp_f32 v42, v42
    v_exp_f32 v43, v43
    v_mfma_f32_32x32x16_bf16 v[56:71], v[16:19], v[8:11], v[56:71]
    s_mul_i32 s54, s45, 4657152
    s_add_u32 s54, s54, s46
    s_add_u32 s54, s54, 17577984
    buffer_load_dwordx4 v[144:147], v91, s[28:31], s54 offen
    ds_read_b128 v[12:15], v94 offset:30720
    ds_read_b64 v[16:17], v95 offset:30720
    v_cvt_pk_bf16_f32 v28, v40, v41
    v_cvt_pk_bf16_f32 v29, v42, v43
    v_exp_f32 v44, v44
    v_exp_f32 v45, v45
    v_exp_f32 v46, v46
    v_exp_f32 v47, v47
    s_waitcnt lgkmcnt(3)
    v_mfma_f32_32x32x16_bf16 v[72:87], v[24:27], v[32:35], v[72:87]
    ds_read_b128 v[24:27], v96 offset:25472
    v_cvt_pk_bf16_f32 v30, v44, v45
    v_cvt_pk_bf16_f32 v31, v46, v47
    v_exp_f32 v48, v48
    v_exp_f32 v49, v49
    v_exp_f32 v50, v50
    v_exp_f32 v51, v51
    s_waitcnt lgkmcnt(3)
    v_mfma_f32_32x32x16_bf16 v[72:87], v[20:23], v[28:31], v[72:87]
    ds_read_b128 v[20:23], v96 offset:27648
    v_cvt_pk_bf16_f32 v32, v48, v49
    v_cvt_pk_bf16_f32 v33, v50, v51
    v_exp_f32 v36, v52
    v_exp_f32 v37, v53
    v_exp_f32 v38, v54
    v_exp_f32 v39, v55
    s_waitcnt lgkmcnt(2)
    v_mfma_f32_32x32x16_bf16 v[40:55], v[12:15], v[4:7], 0
    v_cvt_pk_bf16_f32 v34, v36, v37
    v_cvt_pk_bf16_f32 v35, v38, v39
    v_exp_f32 v56, v56
    v_exp_f32 v57, v57
    v_exp_f32 v58, v58
    v_exp_f32 v59, v59
    v_mfma_f32_32x32x16_bf16 v[40:55], v[16:19], v[8:11], v[40:55]
    s_mul_i32 s54, s45, 4658176
    s_add_u32 s54, s54, s46
    s_add_u32 s54, s54, 17577984
    buffer_load_dwordx4 v[148:151], v91, s[28:31], s54 offen
    ds_read_b128 v[12:15], v94 offset:33792
    ds_read_b64 v[16:17], v95 offset:33792
    v_cvt_pk_bf16_f32 v28, v56, v57
    v_cvt_pk_bf16_f32 v29, v58, v59
    v_exp_f32 v60, v60
    v_exp_f32 v61, v61
    v_exp_f32 v62, v62
    v_exp_f32 v63, v63
    s_waitcnt lgkmcnt(3)
    v_mfma_f32_32x32x16_bf16 v[72:87], v[24:27], v[32:35], v[72:87]
    ds_read_b128 v[24:27], v96 offset:28544
    v_cvt_pk_bf16_f32 v30, v60, v61
    v_cvt_pk_bf16_f32 v31, v62, v63
    v_exp_f32 v64, v64
    v_exp_f32 v65, v65
    v_exp_f32 v66, v66
    v_exp_f32 v67, v67
    s_waitcnt lgkmcnt(3)
    v_mfma_f32_32x32x16_bf16 v[72:87], v[20:23], v[28:31], v[72:87]
    s_bfm_b64 exec, 8, 32
    buffer_load_dword v103, v1, s[28:31], 0 offen
    s_mov_b64 exec, -1
    ds_read_b128 v[20:23], v96 offset:30720
    v_cvt_pk_bf16_f32 v32, v64, v65
    v_cvt_pk_bf16_f32 v33, v66, v67
    v_exp_f32 v36, v68
    v_exp_f32 v37, v69
    v_exp_f32 v38, v70
    v_exp_f32 v39, v71
    s_waitcnt lgkmcnt(2)
    v_mfma_f32_32x32x16_bf16 v[56:71], v[12:15], v[4:7], 0
    v_cvt_pk_bf16_f32 v34, v36, v37
    v_cvt_pk_bf16_f32 v35, v38, v39
    v_exp_f32 v40, v40
    v_exp_f32 v41, v41
    v_exp_f32 v42, v42
    v_exp_f32 v43, v43
    v_mfma_f32_32x32x16_bf16 v[56:71], v[16:19], v[8:11], v[56:71]
    s_mul_i32 s54, s45, 4659200
    s_add_u32 s54, s54, s46
    s_add_u32 s54, s54, 17577984
    buffer_load_dwordx4 v[152:155], v91, s[28:31], s54 offen
    ds_read_b128 v[12:15], v94 offset:36864
    ds_read_b64 v[16:17], v95 offset:36864
    v_cvt_pk_bf16_f32 v28, v40, v41
    v_cvt_pk_bf16_f32 v29, v42, v43
    v_exp_f32 v44, v44
    v_exp_f32 v45, v45
    v_exp_f32 v46, v46
    v_exp_f32 v47, v47
    s_waitcnt lgkmcnt(3)
    v_mfma_f32_32x32x16_bf16 v[72:87], v[24:27], v[32:35], v[72:87]
    ds_read_b128 v[24:27], v96 offset:31616
    v_cvt_pk_bf16_f32 v30, v44, v45
    v_cvt_pk_bf16_f32 v31, v46, v47
    v_exp_f32 v48, v48
    v_exp_f32 v49, v49
    v_exp_f32 v50, v50
    v_exp_f32 v51, v51
    s_waitcnt lgkmcnt(3)
    v_mfma_f32_32x32x16_bf16 v[72:87], v[20:23], v[28:31], v[72:87]
    ds_read_b128 v[20:23], v96 offset:33792
    v_cvt_pk_bf16_f32 v32, v48, v49
    v_cvt_pk_bf16_f32 v33, v50, v51
    v_exp_f32 v36, v52
    v_exp_f32 v37, v53
    v_exp_f32 v38, v54
    v_exp_f32 v39, v55
    s_waitcnt lgkmcnt(2)
    v_mfma_f32_32x32x16_bf16 v[40:55], v[12:15], v[4:7], 0
    v_cvt_pk_bf16_f32 v34, v36, v37
    v_cvt_pk_bf16_f32 v35, v38, v39
    v_exp_f32 v56, v56
    v_exp_f32 v57, v57
    v_exp_f32 v58, v58
    v_exp_f32 v59, v59
    v_mfma_f32_32x32x16_bf16 v[40:55], v[16:19], v[8:11], v[40:55]
    s_mul_i32 s54, s45, 4675584
    s_add_u32 s54, s54, s46
    s_add_u32 s54, s54, 17577984
    buffer_load_dwordx4 v[156:159], v91, s[28:31], s54 offen
    ds_read_b128 v[12:15], v94 offset:39936
    ds_read_b64 v[16:17], v95 offset:39936
    v_cvt_pk_bf16_f32 v28, v56, v57
    v_cvt_pk_bf16_f32 v29, v58, v59
    v_exp_f32 v60, v60
    v_exp_f32 v61, v61
    v_exp_f32 v62, v62
    v_exp_f32 v63, v63
    s_waitcnt lgkmcnt(3)
    v_mfma_f32_32x32x16_bf16 v[72:87], v[24:27], v[32:35], v[72:87]
    ds_read_b128 v[24:27], v96 offset:34688
    v_cvt_pk_bf16_f32 v30, v60, v61
    v_cvt_pk_bf16_f32 v31, v62, v63
    v_exp_f32 v64, v64
    v_exp_f32 v65, v65
    v_exp_f32 v66, v66
    v_exp_f32 v67, v67
    s_waitcnt lgkmcnt(3)
    v_mfma_f32_32x32x16_bf16 v[72:87], v[20:23], v[28:31], v[72:87]
    s_bfm_b64 exec, 8, 40
    buffer_load_dword v103, v1, s[28:31], 0 offen
    s_mov_b64 exec, -1
    ds_read_b128 v[20:23], v96 offset:36864
    v_cvt_pk_bf16_f32 v32, v64, v65
    v_cvt_pk_bf16_f32 v33, v66, v67
    v_exp_f32 v36, v68
    v_exp_f32 v37, v69
    v_exp_f32 v38, v70
    v_exp_f32 v39, v71
    s_waitcnt lgkmcnt(2)
    v_mfma_f32_32x32x16_bf16 v[56:71], v[12:15], v[4:7], 0
    v_cvt_pk_bf16_f32 v34, v36, v37
    v_cvt_pk_bf16_f32 v35, v38, v39
    v_exp_f32 v40, v40
    v_exp_f32 v41, v41
    v_exp_f32 v42, v42
    v_exp_f32 v43, v43
    v_mfma_f32_32x32x16_bf16 v[56:71], v[16:19], v[8:11], v[56:71]
    s_mul_i32 s54, s45, 4676608
    s_add_u32 s54, s54, s46
    s_add_u32 s54, s54, 17577984
    buffer_load_dwordx4 v[160:163], v91, s[28:31], s54 offen
    s_setprio 0
    ds_read_b128 v[12:15], v94 offset:43008
    ds_read_b64 v[16:17], v95 offset:43008
    v_cvt_pk_bf16_f32 v28, v40, v41
    v_cvt_pk_bf16_f32 v29, v42, v43
    v_exp_f32 v44, v44
    v_exp_f32 v45, v45
    v_exp_f32 v46, v46
    v_exp_f32 v47, v47
    s_waitcnt lgkmcnt(3)
    v_mfma_f32_32x32x16_bf16 v[72:87], v[24:27], v[32:35], v[72:87]
    ds_read_b128 v[24:27], v96 offset:37760
    v_cvt_pk_bf16_f32 v30, v44, v45
    v_cvt_pk_bf16_f32 v31, v46, v47
    v_exp_f32 v48, v48
    v_exp_f32 v49, v49
    v_exp_f32 v50, v50
    v_exp_f32 v51, v51
    s_waitcnt lgkmcnt(3)
    v_mfma_f32_32x32x16_bf16 v[72:87], v[20:23], v[28:31], v[72:87]
    ds_read_b128 v[20:23], v96 offset:39936
    v_cvt_pk_bf16_f32 v32, v48, v49
    v_cvt_pk_bf16_f32 v33, v50, v51
    v_exp_f32 v36, v52
    v_exp_f32 v37, v53
    v_exp_f32 v38, v54
    v_exp_f32 v39, v55
    s_waitcnt lgkmcnt(2)
    v_mfma_f32_32x32x16_bf16 v[40:55], v[12:15], v[4:7], 0
    v_cvt_pk_bf16_f32 v34, v36, v37
    v_cvt_pk_bf16_f32 v35, v38, v39
    v_exp_f32 v56, v56
    v_exp_f32 v57, v57
    v_exp_f32 v58, v58
    v_exp_f32 v59, v59
    v_mfma_f32_32x32x16_bf16 v[40:55], v[16:19], v[8:11], v[40:55]
    s_mul_i32 s54, s45, 4677568
    s_add_u32 s54, s54, s46
    s_add_u32 s54, s54, 17578048
    buffer_load_dwordx4 v[164:167], v91, s[28:31], s54 offen
    ds_read_b128 v[12:15], v94 offset:46080
    ds_read_b64 v[16:17], v95 offset:46080
    v_cvt_pk_bf16_f32 v28, v56, v57
    v_cvt_pk_bf16_f32 v29, v58, v59
    v_exp_f32 v60, v60
    v_exp_f32 v61, v61
    v_exp_f32 v62, v62
    v_exp_f32 v63, v63
    s_waitcnt lgkmcnt(3)
    v_mfma_f32_32x32x16_bf16 v[72:87], v[24:27], v[32:35], v[72:87]
    ds_read_b128 v[24:27], v96 offset:40832
    v_cvt_pk_bf16_f32 v30, v60, v61
    v_cvt_pk_bf16_f32 v31, v62, v63
    v_exp_f32 v64, v64
    v_exp_f32 v65, v65
    v_exp_f32 v66, v66
    v_exp_f32 v67, v67
    s_waitcnt lgkmcnt(3)
    v_mfma_f32_32x32x16_bf16 v[72:87], v[20:23], v[28:31], v[72:87]
    s_bfm_b64 exec, 7, 48
    buffer_load_dword v103, v1, s[28:31], 0 offen
    s_mov_b64 exec, -1
    ds_read_b128 v[20:23], v96 offset:43008
    v_cvt_pk_bf16_f32 v32, v64, v65
    v_cvt_pk_bf16_f32 v33, v66, v67
    v_exp_f32 v36, v68
    v_exp_f32 v37, v69
    v_exp_f32 v38, v70
    v_exp_f32 v39, v71
    s_waitcnt lgkmcnt(2)
    v_mfma_f32_32x32x16_bf16 v[56:71], v[12:15], v[4:7], 0
    v_cvt_pk_bf16_f32 v34, v36, v37
    v_cvt_pk_bf16_f32 v35, v38, v39
    v_exp_f32 v40, v40
    v_exp_f32 v41, v41
    v_exp_f32 v42, v42
    v_exp_f32 v43, v43
    v_mfma_f32_32x32x16_bf16 v[56:71], v[16:19], v[8:11], v[56:71]
    s_waitcnt vmcnt(23)
    s_barrier
    s_add_u32 m0, s41, 0
    s_nop 0
    buffer_load_dwordx4 v97, s[8:11], s42 offen offset:0 lds
    buffer_load_dwordx4 v97, s[8:11], s42 offen offset:1024 lds
    buffer_load_dwordx4 v97, s[8:11], s42 offen offset:2048 lds
    s_add_u32 s42, s42, 24576
    s_cmp_lt_u32 s40, 4
    s_cbranch_scc1 attn_p1
    s_setprio 1
attn_p1:
    ds_read_b128 v[12:15], v88 offset:0
    ds_read_b64 v[16:17], v89 offset:0
    v_cvt_pk_bf16_f32 v28, v40, v41
    v_cvt_pk_bf16_f32 v29, v42, v43
    v_exp_f32 v44, v44
    v_exp_f32 v45, v45
    v_exp_f32 v46, v46
    v_exp_f32 v47, v47
    s_waitcnt lgkmcnt(3)
    v_mfma_f32_32x32x16_bf16 v[72:87], v[24:27], v[32:35], v[72:87]
    ds_read_b128 v[24:27], v96 offset:43904
    v_cvt_pk_bf16_f32 v30, v44, v45
    v_cvt_pk_bf16_f32 v31, v46, v47
    v_exp_f32 v48, v48
    v_exp_f32 v49, v49
    v_exp_f32 v50, v50
    v_exp_f32 v51, v51
    s_waitcnt lgkmcnt(3)
    v_mfma_f32_32x32x16_bf16 v[72:87], v[20:23], v[28:31], v[72:87]
    ds_read_b128 v[20:23], v96 offset:46080
    v_cvt_pk_bf16_f32 v32, v48, v49
    v_cvt_pk_bf16_f32 v33, v50, v51
    v_exp_f32 v36, v52
    v_exp_f32 v37, v53
    v_exp_f32 v38, v54
    v_exp_f32 v39, v55
    s_waitcnt lgkmcnt(2)
    v_mfma_f32_32x32x16_bf16 v[40:55], v[12:15], v[4:7], 0
    v_cvt_pk_bf16_f32 v34, v36, v37
    v_cvt_pk_bf16_f32 v35, v38, v39
    v_exp_f32 v56, v56
    v_exp_f32 v57, v57
    v_exp_f32 v58, v58
    v_exp_f32 v59, v59
    v_mfma_f32_32x32x16_bf16 v[40:55], v[16:19], v[8:11], v[40:55]
    s_mul_i32 s54, s45, 4678528
    s_add_u32 s54, s54, s46
    s_add_u32 s54, s54, 17578112
    buffer_load_dwordx4 v[168:171], v91, s[28:31], s54 offen
    ds_read_b128 v[12:15], v88 offset:3072
    ds_read_b64 v[16:17], v89 offset:3072
    v_cvt_pk_bf16_f32 v28, v56, v57
    v_cvt_pk_bf16_f32 v29, v58, v59
    v_exp_f32 v60, v60
    v_exp_f32 v61, v61
    v_exp_f32 v62, v62
    v_exp_f32 v63, v63
    s_waitcnt lgkmcnt(3)
    v_mfma_f32_32x32x16_bf16 v[72:87], v[24:27], v[32:35], v[72:87]
    ds_read_b128 v[24:27], v96 offset:46976
    v_cvt_pk_bf16_f32 v30, v60, v61
    v_cvt_pk_bf16_f32 v31, v62, v63
    v_exp_f32 v64, v64
    v_exp_f32 v65, v65
    v_exp_f32 v66, v66
    v_exp_f32 v67, v67
    s_waitcnt lgkmcnt(3)
    v_mfma_f32_32x32x16_bf16 v[72:87], v[20:23], v[28:31], v[72:87]
    s_bfm_b64 exec, 8, 0
    buffer_load_dword v103, v98, s[28:31], s52 offen
    s_mov_b64 exec, -1
    ds_read_b128 v[20:23], v90 offset:0
    v_cvt_pk_bf16_f32 v32, v64, v65
    v_cvt_pk_bf16_f32 v33, v66, v67
    v_exp_f32 v36, v68
    v_exp_f32 v37, v69
    v_exp_f32 v38, v70
    v_exp_f32 v39, v71
    s_waitcnt lgkmcnt(2)
    v_mfma_f32_32x32x16_bf16 v[56:71], v[12:15], v[4:7], 0
    v_cvt_pk_bf16_f32 v34, v36, v37
    v_cvt_pk_bf16_f32 v35, v38, v39
    v_exp_f32 v40, v40
    v_exp_f32 v41, v41
    v_exp_f32 v42, v42
    v_exp_f32 v43, v43
    v_mfma_f32_32x32x16_bf16 v[56:71], v[16:19], v[8:11], v[56:71]
    s_mul_i32 s54, s45, 4667392
    s_add_u32 s54, s54, s46
    s_add_u32 s54, s54, 17590272
    buffer_load_dwordx4 v[172:175], v91, s[28:31], s54 offen
    ds_read_b128 v[12:15], v88 offset:6144
    ds_read_b64 v[16:17], v89 offset:6144
    v_cvt_pk_bf16_f32 v28, v40, v41
    v_cvt_pk_bf16_f32 v29, v42, v43
    v_exp_f32 v44, v44
    v_exp_f32 v45, v45
    v_exp_f32 v46, v46
    v_exp_f32 v47, v47
    s_waitcnt lgkmcnt(3)
    v_mfma_f32_32x32x16_bf16 v[72:87], v[24:27], v[32:35], v[72:87]
    ds_read_b128 v[24:27], v90 offset:896
    v_cvt_pk_bf16_f32 v30, v44, v45
    v_cvt_pk_bf16_f32 v31, v46, v47
    v_exp_f32 v48, v48
    v_exp_f32 v49, v49
    v_exp_f32 v50, v50
    v_exp_f32 v51, v51
    s_waitcnt lgkmcnt(3)
    v_mfma_f32_32x32x16_bf16 v[72:87], v[20:23], v[28:31], v[72:87]
    ds_read_b128 v[20:23], v90 offset:3072
    v_cvt_pk_bf16_f32 v32, v48, v49
    v_cvt_pk_bf16_f32 v33, v50, v51
    v_exp_f32 v36, v52
    v_exp_f32 v37, v53
    v_exp_f32 v38, v54
    v_exp_f32 v39, v55
    s_waitcnt lgkmcnt(2)
    v_mfma_f32_32x32x16_bf16 v[40:55], v[12:15], v[4:7], 0
    v_cvt_pk_bf16_f32 v34, v36, v37
    v_cvt_pk_bf16_f32 v35, v38, v39
    v_exp_f32 v56, v56
    v_exp_f32 v57, v57
    v_exp_f32 v58, v58
    v_exp_f32 v59, v59
    v_mfma_f32_32x32x16_bf16 v[40:55], v[16:19], v[8:11], v[40:55]
    s_mul_i32 s54, s45, 4683712
    s_add_u32 s54, s54, s46
    s_add_u32 s54, s54, 17590336
    buffer_load_dwordx4 v[176:179], v91, s[28:31], s54 offen
    ds_read_b128 v[12:15], v88 offset:9216
    ds_read_b64 v[16:17], v89 offset:9216
    v_cvt_pk_bf16_f32 v28, v56, v57
    v_cvt_pk_bf16_f32 v29, v58, v59
    v_exp_f32 v60, v60
    v_exp_f32 v61, v61
    v_exp_f32 v62, v62
    v_exp_f32 v63, v63
    s_waitcnt lgkmcnt(3)
    v_mfma_f32_32x32x16_bf16 v[72:87], v[24:27], v[32:35], v[72:87]
    ds_read_b128 v[24:27], v90 offset:3968
    v_cvt_pk_bf16_f32 v30, v60, v61
    v_cvt_pk_bf16_f32 v31, v62, v63
    v_exp_f32 v64, v64
    v_exp_f32 v65, v65
    v_exp_f32 v66, v66
    v_exp_f32 v67, v67
    s_waitcnt lgkmcnt(3)
    v_mfma_f32_32x32x16_bf16 v[72:87], v[20:23], v[28:31], v[72:87]
    s_bfm_b64 exec, 8, 8
    buffer_load_dword v103, v98, s[28:31], s52 offen
    s_mov_b64 exec, -1
    ds_read_b128 v[20:23], v90 offset:6144
    v_cvt_pk_bf16_f32 v32, v64, v65
    v_cvt_pk_bf16_f32 v33, v66, v67
    v_exp_f32 v36, v68
    v_exp_f32 v37, v69
    v_exp_f32 v38, v70
    v_exp_f32 v39, v71
    s_waitcnt lgkmcnt(2)
    v_mfma_f32_32x32x16_bf16 v[56:71], v[12:15], v[4:7], 0
    v_cvt_pk_bf16_f32 v34, v36, v37
    v_cvt_pk_bf16_f32 v35, v38, v39
    v_exp_f32 v40, v40
    v_exp_f32 v41, v41
    v_exp_f32 v42, v42
    v_exp_f32 v43, v43
    v_mfma_f32_32x32x16_bf16 v[56:71], v[16:19], v[8:11], v[56:71]
    s_mul_i32 s54, s45, 4684672
    s_add_u32 s54, s54, s46
    s_add_u32 s54, s54, 17590400
    buffer_load_dwordx4 v[180:183], v91, s[28:31], s54 offen
    ds_read_b128 v[12:15], v88 offset:12288
    ds_read_b64 v[16:17], v89 offset:12288
    v_cvt_pk_bf16_f32 v28, v40, v41
    v_cvt_pk_bf16_f32 v29, v42, v43
    v_exp_f32 v44, v44
    v_exp_f32 v45, v45
    v_exp_f32 v46, v46
    v_exp_f32 v47, v47
    s_waitcnt lgkmcnt(3)
    v_mfma_f32_32x32x16_bf16 v[72:87], v[24:27], v[32:35], v[72:87]
    ds_read_b128 v[24:27], v90 offset:7040
    v_cvt_pk_bf16_f32 v30, v44, v45
    v_cvt_pk_bf16_f32 v31, v46, v47
    v_exp_f32 v48, v48
    v_exp_f32 v49, v49
    v_exp_f32 v50, v50
    v_exp_f32 v51, v51
    s_waitcnt lgkmcnt(3)
    v_mfma_f32_32x32x16_bf16 v[72:87], v[20:23], v[28:31], v[72:87]
    ds_read_b128 v[20:23], v90 offset:9216
    v_cvt_pk_bf16_f32 v32, v48, v49
    v_cvt_pk_bf16_f32 v33, v50, v51
    v_exp_f32 v36, v52
    v_exp_f32 v37, v53
    v_exp_f32 v38, v54
    v_exp_f32 v39, v55
    s_waitcnt lgkmcnt(2)
    v_mfma_f32_32x32x16_bf16 v[40:55], v[12:15], v[4:7], 0
    v_cvt_pk_bf16_f32 v34, v36, v37
    v_cvt_pk_bf16_f32 v35, v38, v39
    v_exp_f32 v56, v56
    v_exp_f32 v57, v57
    v_exp_f32 v58, v58
    v_exp_f32 v59, v59
    v_mfma_f32_32x32x16_bf16 v[40:55], v[16:19], v[8:11], v[40:55]
    s_mul_i32 s54, s45, 4697920
    s_add_u32 s54, s54, s46
    s_add_u32 s54, s54, 17578176
    buffer_load_dwordx4 v[184:187], v91, s[28:31], s54 offen
    ds_read_b128 v[12:15], v88 offset:15360
    ds_read_b64 v[16:17], v89 offset:15360
    v_cvt_pk_bf16_f32 v28, v56, v57
    v_cvt_pk_bf16_f32 v29, v58, v59
    v_exp_f32 v60, v60
    v_exp_f32 v61, v61
    v_exp_f32 v62, v62
    v_exp_f32 v63, v63
    s_waitcnt lgkmcnt(3)
    v_mfma_f32_32x32x16_bf16 v[72:87], v[24:27], v[32:35], v[72:87]
    ds_read_b128 v[24:27], v90 offset:10112
    v_cvt_pk_bf16_f32 v30, v60, v61
    v_cvt_pk_bf16_f32 v31, v62, v63
    v_exp_f32 v64, v64
    v_exp_f32 v65, v65
    v_exp_f32 v66, v66
    v_exp_f32 v67, v67
    s_waitcnt lgkmcnt(3)
    v_mfma_f32_32x32x16_bf16 v[72:87], v[20:23], v[28:31], v[72:87]
    s_bfm_b64 exec, 8, 16
    buffer_load_dword v103, v98, s[28:31], s52 offen
    s_mov_b64 exec, -1
    ds_read_b128 v[20:23], v90 offset:12288
    v_cvt_pk_bf16_f32 v32, v64, v65
    v_cvt_pk_bf16_f32 v33, v66, v67
    v_exp_f32 v36, v68
    v_exp_f32 v37, v69
    v_exp_f32 v38, v70
    v_exp_f32 v39, v71
    s_waitcnt lgkmcnt(2)
    v_mfma_f32_32x32x16_bf16 v[56:71], v[12:15], v[4:7], 0
    v_cvt_pk_bf16_f32 v34, v36, v37
    v_cvt_pk_bf16_f32 v35, v38, v39
    v_exp_f32 v40, v40
    v_exp_f32 v41, v41
    v_exp_f32 v42, v42
    v_exp_f32 v43, v43
    v_mfma_f32_32x32x16_bf16 v[56:71], v[16:19], v[8:11], v[56:71]
    s_mul_i32 s54, s45, 4698880
    s_add_u32 s54, s54, s46
    s_add_u32 s54, s54, 17578240
    buffer_load_dwordx4 v[188:191], v91, s[28:31], s54 offen
    s_setprio 0
    ds_read_b128 v[12:15], v88 offset:18432
    ds_read_b64 v[16:17], v89 offset:18432
    v_cvt_pk_bf16_f32 v28, v40, v41
    v_cvt_pk_bf16_f32 v29, v42, v43
    v_exp_f32 v44, v44
    v_exp_f32 v45, v45
    v_exp_f32 v46, v46
    v_exp_f32 v47, v47
    s_waitcnt lgkmcnt(3)
    v_mfma_f32_32x32x16_bf16 v[72:87], v[24:27], v[32:35], v[72:87]
    ds_read_b128 v[24:27], v90 offset:13184
    v_cvt_pk_bf16_f32 v30, v44, v45
    v_cvt_pk_bf16_f32 v31, v46, v47
    v_exp_f32 v48, v48
    v_exp_f32 v49, v49
    v_exp_f32 v50, v50
    v_exp_f32 v51, v51
    s_waitcnt lgkmcnt(3)
    v_mfma_f32_32x32x16_bf16 v[72:87], v[20:23], v[28:31], v[72:87]
    ds_read_b128 v[20:23], v90 offset:15360
    v_cvt_pk_bf16_f32 v32, v48, v49
    v_cvt_pk_bf16_f32 v33, v50, v51
    v_exp_f32 v36, v52
    v_exp_f32 v37, v53
    v_exp_f32 v38, v54
    v_exp_f32 v39, v55
    s_waitcnt lgkmcnt(2)
    v_mfma_f32_32x32x16_bf16 v[40:55], v[12:15], v[4:7], 0
    v_cvt_pk_bf16_f32 v34, v36, v37
    v_cvt_pk_bf16_f32 v35, v38, v39
    v_exp_f32 v56, v56
    v_exp_f32 v57, v57
    v_exp_f32 v58, v58
    v_exp_f32 v59, v59
    v_mfma_f32_32x32x16_bf16 v[40:55], v[16:19], v[8:11], v[40:55]
    s_mul_i32 s54, s45, 4699840
    s_add_u32 s54, s54, s46
    s_add_u32 s54, s54, 17578304
    buffer_load_dwordx4 v[192:195], v91, s[28:31], s54 offen
    ds_read_b128 v[12:15], v88 offset:21504
    ds_read_b64 v[16:17], v89 offset:21504
    v_cvt_pk_bf16_f32 v28, v56, v57
    v_cvt_pk_bf16_f32 v29, v58, v59
    v_exp_f32 v60, v60
    v_exp_f32 v61, v61
    v_exp_f32 v62, v62
    v_exp_f32 v63, v63
    s_waitcnt lgkmcnt(3)
    v_mfma_f32_32x32x16_bf16 v[72:87], v[24:27], v[32:35], v[72:87]
    ds_read_b128 v[24:27], v90 offset:16256
    v_cvt_pk_bf16_f32 v30, v60, v61
    v_cvt_pk_bf16_f32 v31, v62, v63
    v_exp_f32 v64, v64
    v_exp_f32 v65, v65
    v_exp_f32 v66, v66
    v_exp_f32 v67, v67
    s_waitcnt lgkmcnt(3)
    v_mfma_f32_32x32x16_bf16 v[72:87], v[20:23], v[28:31], v[72:87]
    s_bfm_b64 exec, 8, 24
    buffer_load_dword v103, v98, s[28:31], s52 offen
    s_mov_b64 exec, -1
    ds_read_b128 v[20:23], v90 offset:18432
    v_cvt_pk_bf16_f32 v32, v64, v65
    v_cvt_pk_bf16_f32 v33, v66, v67
    v_exp_f32 v36, v68
    v_exp_f32 v37, v69
    v_exp_f32 v38, v70
    v_exp_f32 v39, v71
    s_waitcnt lgkmcnt(2)
    v_mfma_f32_32x32x16_bf16 v[56:71], v[12:15], v[4:7], 0
    v_cvt_pk_bf16_f32 v34, v36, v37
    v_cvt_pk_bf16_f32 v35, v38, v39
    v_exp_f32 v40, v40
    v_exp_f32 v41, v41
    v_exp_f32 v42, v42
    v_exp_f32 v43, v43
    v_mfma_f32_32x32x16_bf16 v[56:71], v[16:19], v[8:11], v[56:71]
    s_waitcnt vmcnt(25)
    s_barrier
    s_add_u32 m0, s41, 24576
    s_nop 0
    buffer_load_dwordx4 v97, s[8:11], s42 offen offset:0 lds
    buffer_load_dwordx4 v97, s[8:11], s42 offen offset:1024 lds
    buffer_load_dwordx4 v97, s[8:11], s42 offen offset:2048 lds
    s_add_u32 s42, s42, 24576
    s_cmp_lt_u32 s40, 4
    s_cbranch_scc1 attn_p2
    s_setprio 1
attn_p2:
    ds_read_b128 v[12:15], v88 offset:24576
    ds_read_b64 v[16:17], v89 offset:24576
    v_cvt_pk_bf16_f32 v28, v40, v41
    v_cvt_pk_bf16_f32 v29, v42, v43
    v_exp_f32 v44, v44
    v_exp_f32 v45, v45
    v_exp_f32 v46, v46
    v_exp_f32 v47, v47
    s_waitcnt lgkmcnt(3)
    v_mfma_f32_32x32x16_bf16 v[72:87], v[24:27], v[32:35], v[72:87]
    ds_read_b128 v[24:27], v90 offset:19328
    v_cvt_pk_bf16_f32 v30, v44, v45
    v_cvt_pk_bf16_f32 v31, v46, v47
    v_exp_f32 v48, v48
    v_exp_f32 v49, v49
    v_exp_f32 v50, v50
    v_exp_f32 v51, v51
    s_waitcnt lgkmcnt(3)
    v_mfma_f32_32x32x16_bf16 v[72:87], v[20:23], v[28:31], v[72:87]
    ds_read_b128 v[20:23], v90 offset:21504
    v_cvt_pk_bf16_f32 v32, v48, v49
    v_cvt_pk_bf16_f32 v33, v50, v51
    v_exp_f32 v36, v52
    v_exp_f32 v37, v53
    v_exp_f32 v38, v54
    v_exp_f32 v39, v55
    s_waitcnt lgkmcnt(2)
    v_mfma_f32_32x32x16_bf16 v[40:55], v[12:15], v[4:7], 0
    v_cvt_pk_bf16_f32 v34, v36, v37
    v_cvt_pk_bf16_f32 v35, v38, v39
    v_exp_f32 v56, v56
    v_exp_f32 v57, v57
    v_exp_f32 v58, v58
    v_exp_f32 v59, v59
    v_mfma_f32_32x32x16_bf16 v[40:55], v[16:19], v[8:11], v[40:55]
    s_mul_i32 s54, s45, 4724544
    s_add_u32 s54, s54, s46
    s_add_u32 s54, s54, 17590464
    buffer_load_dwordx4 v[196:199], v91, s[28:31], s54 offen
    ds_read_b128 v[12:15], v88 offset:27648
    ds_read_b64 v[16:17], v89 offset:27648
    v_cvt_pk_bf16_f32 v28, v56, v57
    v_cvt_pk_bf16_f32 v29, v58, v59
    v_exp_f32 v60, v60
    v_exp_f32 v61, v61
    v_exp_f32 v62, v62
    v_exp_f32 v63, v63
    s_waitcnt lgkmcnt(3)
    v_mfma_f32_32x32x16_bf16 v[72:87], v[24:27], v[32:35], v[72:87]
    ds_read_b128 v[24:27], v90 offset:22400
    v_cvt_pk_bf16_f32 v30, v60, v61
    v_cvt_pk_bf16_f32 v31, v62, v63
    v_exp_f32 v64, v64
    v_exp_f32 v65, v65
    v_exp_f32 v66, v66
    v_exp_f32 v67, v67
    s_waitcnt lgkmcnt(3)
    v_mfma_f32_32x32x16_bf16 v[72:87], v[20:23], v[28:31], v[72:87]
    s_bfm_b64 exec, 8, 32
    buffer_load_dword v103, v98, s[28:31], s52 offen
    s_mov_b64 exec, -1
    ds_read_b128 v[20:23], v90 offset:24576
    v_cvt_pk_bf16_f32 v32, v64, v65
    v_cvt_pk_bf16_f32 v33, v66, v67
    v_exp_f32 v36, v68
    v_exp_f32 v37, v69
    v_exp_f32 v38, v70
    v_exp_f32 v39, v71
    s_waitcnt lgkmcnt(2)
    v_mfma_f32_32x32x16_bf16 v[56:71], v[12:15], v[4:7], 0
    v_cvt_pk_bf16_f32 v34, v36, v37
    v_cvt_pk_bf16_f32 v35, v38, v39
    v_exp_f32 v40, v40
    v_exp_f32 v41, v41
    v_exp_f32 v42, v42
    v_exp_f32 v43, v43
    v_mfma_f32_32x32x16_bf16 v[56:71], v[16:19], v[8:11], v[56:71]
    s_mul_i32 s54, s45, 4725504
    s_add_u32 s54, s54, s46
    s_add_u32 s54, s54, 17590528
    buffer_load_dwordx4 v[200:203], v91, s[28:31], s54 offen
    ds_read_b128 v[12:15], v88 offset:30720
    ds_read_b64 v[16:17], v89 offset:30720
    v_cvt_pk_bf16_f32 v28, v40, v41
    v_cvt_pk_bf16_f32 v29, v42, v43
    v_exp_f32 v44, v44
    v_exp_f32 v45, v45
    v_exp_f32 v46, v46
    v_exp_f32 v47, v47
    s_waitcnt lgkmcnt(3)
    v_mfma_f32_32x32x16_bf16 v[72:87], v[24:27], v[32:35], v[72:87]
    ds_read_b128 v[24:27], v90 offset:25472
    v_cvt_pk_bf16_f32 v30, v44, v45
    v_cvt_pk_bf16_f32 v31, v46, v47
    v_exp_f32 v48, v48
    v_exp_f32 v49, v49
    v_exp_f32 v50, v50
    v_exp_f32 v51, v51
    s_waitcnt lgkmcnt(3)
    v_mfma_f32_32x32x16_bf16 v[72:87], v[20:23], v[28:31], v[72:87]
    ds_read_b128 v[20:23], v90 offset:27648
    v_cvt_pk_bf16_f32 v32, v48, v49
    v_cvt_pk_bf16_f32 v33, v50, v51
    v_exp_f32 v36, v52
    v_exp_f32 v37, v53
    v_exp_f32 v38, v54
    v_exp_f32 v39, v55
    s_waitcnt lgkmcnt(2)
    v_mfma_f32_32x32x16_bf16 v[40:55], v[12:15], v[4:7], 0
    v_cvt_pk_bf16_f32 v34, v36, v37
    v_cvt_pk_bf16_f32 v35, v38, v39
    v_exp_f32 v56, v56
    v_exp_f32 v57, v57
    v_exp_f32 v58, v58
    v_exp_f32 v59, v59
    v_mfma_f32_32x32x16_bf16 v[40:55], v[16:19], v[8:11], v[40:55]
    s_mul_i32 s54, s45, 4726464
    s_add_u32 s54, s54, s46
    s_add_u32 s54, s54, 17590592
    buffer_load_dwordx4 v[204:207], v91, s[28:31], s54 offen
    ds_read_b128 v[12:15], v88 offset:33792
    ds_read_b64 v[16:17], v89 offset:33792
    v_cvt_pk_bf16_f32 v28, v56, v57
    v_cvt_pk_bf16_f32 v29, v58, v59
    v_exp_f32 v60, v60
    v_exp_f32 v61, v61
    v_exp_f32 v62, v62
    v_exp_f32 v63, v63
    s_waitcnt lgkmcnt(3)
    v_mfma_f32_32x32x16_bf16 v[72:87], v[24:27], v[32:35], v[72:87]
    ds_read_b128 v[24:27], v90 offset:28544
    v_cvt_pk_bf16_f32 v30, v60, v61
    v_cvt_pk_bf16_f32 v31, v62, v63
    v_exp_f32 v64, v64
    v_exp_f32 v65, v65
    v_exp_f32 v66, v66
    v_exp_f32 v67, v67
    s_waitcnt lgkmcnt(3)
    v_mfma_f32_32x32x16_bf16 v[72:87], v[20:23], v[28:31], v[72:87]
    s_bfm_b64 exec, 8, 40
    buffer_load_dword v103, v98, s[28:31], s52 offen
    s_mov_b64 exec, -1
    ds_read_b128 v[20:23], v90 offset:30720
    v_cvt_pk_bf16_f32 v32, v64, v65
    v_cvt_pk_bf16_f32 v33, v66, v67
    v_exp_f32 v36, v68
    v_exp_f32 v37, v69
    v_exp_f32 v38, v70
    v_exp_f32 v39, v71
    s_waitcnt lgkmcnt(2)
    v_mfma_f32_32x32x16_bf16 v[56:71], v[12:15], v[4:7], 0
    v_cvt_pk_bf16_f32 v34, v36, v37
    v_cvt_pk_bf16_f32 v35, v38, v39
    v_exp_f32 v40, v40
    v_exp_f32 v41, v41
    v_exp_f32 v42, v42
    v_exp_f32 v43, v43
    v_mfma_f32_32x32x16_bf16 v[56:71], v[16:19], v[8:11], v[56:71]
    s_mul_i32 s54, s45, 4746240
    s_add_u32 s54, s54, s46
    s_add_u32 s54, s54, 17571840
    buffer_load_dwordx4 v[208:211], v91, s[28:31], s54 offen
    ds_read_b128 v[12:15], v88 offset:36864
    ds_read_b64 v[16:17], v89 offset:36864
    v_cvt_pk_bf16_f32 v28, v40, v41
    v_cvt_pk_bf16_f32 v29, v42, v43
    v_exp_f32 v44, v44
    v_exp_f32 v45, v45
    v_exp_f32 v46, v46
    v_exp_f32 v47, v47
    s_waitcnt lgkmcnt(3)
    v_mfma_f32_32x32x16_bf16 v[72:87], v[24:27], v[32:35], v[72:87]
    ds_read_b128 v[24:27], v90 offset:31616
    v_cvt_pk_bf16_f32 v30, v44, v45
    v_cvt_pk_bf16_f32 v31, v46, v47
    v_exp_f32 v48, v48
    v_exp_f32 v49, v49
    v_exp_f32 v50, v50
    v_exp_f32 v51, v51
    s_waitcnt lgkmcnt(3)
    v_mfma_f32_32x32x16_bf16 v[72:87], v[20:23], v[28:31], v[72:87]
    ds_read_b128 v[20:23], v90 offset:33792
    v_cvt_pk_bf16_f32 v32, v48, v49
    v_cvt_pk_bf16_f32 v33, v50, v51
    v_exp_f32 v36, v52
    v_exp_f32 v37, v53
    v_exp_f32 v38, v54
    v_exp_f32 v39, v55
    s_waitcnt lgkmcnt(2)
    v_mfma_f32_32x32x16_bf16 v[40:55], v[12:15], v[4:7], 0
    v_cvt_pk_bf16_f32 v34, v36, v37
    v_cvt_pk_bf16_f32 v35, v38, v39
    v_exp_f32 v56, v56
    v_exp_f32 v57, v57
    v_exp_f32 v58, v58
    v_exp_f32 v59, v59
    v_mfma_f32_32x32x16_bf16 v[40:55], v[16:19], v[8:11], v[40:55]
    s_mul_i32 s54, s45, 4747200
    s_add_u32 s54, s54, s46
    s_add_u32 s54, s54, 17571904
    buffer_load_dwordx4 v[212:215], v91, s[28:31], s54 offen
    ds_read_b128 v[12:15], v88 offset:39936
    ds_read_b64 v[16:17], v89 offset:39936
    v_cvt_pk_bf16_f32 v28, v56, v57
    v_cvt_pk_bf16_f32 v29, v58, v59
    v_exp_f32 v60, v60
    v_exp_f32 v61, v61
    v_exp_f32 v62, v62
    v_exp_f32 v63, v63
    s_waitcnt lgkmcnt(3)
    v_mfma_f32_32x32x16_bf16 v[72:87], v[24:27], v[32:35], v[72:87]
    ds_read_b128 v[24:27], v90 offset:34688
    v_cvt_pk_bf16_f32 v30, v60, v61
    v_cvt_pk_bf16_f32 v31, v62, v63
    v_exp_f32 v64, v64
    v_exp_f32 v65, v65
    v_exp_f32 v66, v66
    v_exp_f32 v67, v67
    s_waitcnt lgkmcnt(3)
    v_mfma_f32_32x32x16_bf16 v[72:87], v[20:23], v[28:31], v[72:87]
    s_bfm_b64 exec, 8, 48
    buffer_load_dword v103, v98, s[28:31], s52 offen
    s_mov_b64 exec, -1
    ds_read_b128 v[20:23], v90 offset:36864
    v_cvt_pk_bf16_f32 v32, v64, v65
    v_cvt_pk_bf16_f32 v33, v66, v67
    v_exp_f32 v36, v68
    v_exp_f32 v37, v69
    v_exp_f32 v38, v70
    v_exp_f32 v39, v71
    s_waitcnt lgkmcnt(2)
    v_mfma_f32_32x32x16_bf16 v[56:71], v[12:15], v[4:7], 0
    v_cvt_pk_bf16_f32 v34, v36, v37
    v_cvt_pk_bf16_f32 v35, v38, v39
    v_exp_f32 v40, v40
    v_exp_f32 v41, v41
    v_exp_f32 v42, v42
    v_exp_f32 v43, v43
    v_mfma_f32_32x32x16_bf16 v[56:71], v[16:19], v[8:11], v[56:71]
    s_mul_i32 s54, s45, 4763520
    s_add_u32 s54, s54, s46
    s_add_u32 s54, s54, 17571968
    buffer_load_dwordx4 v[216:219], v91, s[28:31], s54 offen
    s_setprio 0
    ds_read_b128 v[12:15], v88 offset:43008
    ds_read_b64 v[16:17], v89 offset:43008
    v_cvt_pk_bf16_f32 v28, v40, v41
    v_cvt_pk_bf16_f32 v29, v42, v43
    v_exp_f32 v44, v44
    v_exp_f32 v45, v45
    v_exp_f32 v46, v46
    v_exp_f32 v47, v47
    s_waitcnt lgkmcnt(3)
    v_mfma_f32_32x32x16_bf16 v[72:87], v[24:27], v[32:35], v[72:87]
    ds_read_b128 v[24:27], v90 offset:37760
    v_cvt_pk_bf16_f32 v30, v44, v45
    v_cvt_pk_bf16_f32 v31, v46, v47
    v_exp_f32 v48, v48
    v_exp_f32 v49, v49
    v_exp_f32 v50, v50
    v_exp_f32 v51, v51
    s_waitcnt lgkmcnt(3)
    v_mfma_f32_32x32x16_bf16 v[72:87], v[20:23], v[28:31], v[72:87]
    ds_read_b128 v[20:23], v90 offset:39936
    v_cvt_pk_bf16_f32 v32, v48, v49
    v_cvt_pk_bf16_f32 v33, v50, v51
    v_exp_f32 v36, v52
    v_exp_f32 v37, v53
    v_exp_f32 v38, v54
    v_exp_f32 v39, v55
    s_waitcnt lgkmcnt(2)
    v_mfma_f32_32x32x16_bf16 v[40:55], v[12:15], v[4:7], 0
    v_cvt_pk_bf16_f32 v34, v36, v37
    v_cvt_pk_bf16_f32 v35, v38, v39
    v_exp_f32 v56, v56
    v_exp_f32 v57, v57
    v_exp_f32 v58, v58
    v_exp_f32 v59, v59
    v_mfma_f32_32x32x16_bf16 v[40:55], v[16:19], v[8:11], v[40:55]
    s_mul_i32 s54, s45, 4752384
    s_add_u32 s54, s54, s46
    s_add_u32 s54, s54, 17584128
    buffer_load_dwordx4 v[220:223], v91, s[28:31], s54 offen
    ds_read_b128 v[12:15], v88 offset:46080
    ds_read_b64 v[16:17], v89 offset:46080
    v_cvt_pk_bf16_f32 v28, v56, v57
    v_cvt_pk_bf16_f32 v29, v58, v59
    v_exp_f32 v60, v60
    v_exp_f32 v61, v61
    v_exp_f32 v62, v62
    v_exp_f32 v63, v63
    s_waitcnt lgkmcnt(3)
    v_mfma_f32_32x32x16_bf16 v[72:87], v[24:27], v[32:35], v[72:87]
    ds_read_b128 v[24:27], v90 offset:40832
    v_cvt_pk_bf16_f32 v30, v60, v61
    v_cvt_pk_bf16_f32 v31, v62, v63
    v_exp_f32 v64, v64
    v_exp_f32 v65, v65
    v_exp_f32 v66, v66
    v_exp_f32 v67, v67
    s_waitcnt lgkmcnt(3)
    v_mfma_f32_32x32x16_bf16 v[72:87], v[20:23], v[28:31], v[72:87]
    s_bfm_b64 exec, 4, 56
    buffer_load_dword v103, v98, s[28:31], s52 offen
    s_mov_b64 exec, -1
    ds_read_b128 v[20:23], v90 offset:43008
    v_cvt_pk_bf16_f32 v32, v64, v65
    v_cvt_pk_bf16_f32 v33, v66, v67
    v_exp_f32 v36, v68
    v_exp_f32 v37, v69
    v_exp_f32 v38, v70
    v_exp_f32 v39, v71
    s_waitcnt lgkmcnt(2)
    v_mfma_f32_32x32x16_bf16 v[56:71], v[12:15], v[4:7], 0
    v_cvt_pk_bf16_f32 v34, v36, v37
    v_cvt_pk_bf16_f32 v35, v38, v39
    v_exp_f32 v40, v40
    v_exp_f32 v41, v41
    v_exp_f32 v42, v42
    v_exp_f32 v43, v43
    v_mfma_f32_32x32x16_bf16 v[56:71], v[16:19], v[8:11], v[56:71]
    s_waitcnt vmcnt(25)
    s_barrier
    s_add_u32 m0, s41, 49152
    s_nop 0
    buffer_load_dwordx4 v97, s[8:11], s42 offen offset:0 lds
    buffer_load_dwordx4 v97, s[8:11], s42 offen offset:1024 lds
    buffer_load_dwordx4 v97, s[8:11], s42 offen offset:2048 lds
    s_add_u32 s42, s42, 24576
    s_cmp_lt_u32 s40, 4
    s_cbranch_scc1 attn_p3
    s_setprio 1
attn_p3:
    ds_read_b128 v[12:15], v94 offset:0
    ds_read_b64 v[16:17], v95 offset:0
    v_cvt_pk_bf16_f32 v28, v40, v41
    v_cvt_pk_bf16_f32 v29, v42, v43
    v_exp_f32 v44, v44
    v_exp_f32 v45, v45
    v_exp_f32 v46, v46
    v_exp_f32 v47, v47
    s_waitcnt lgkmcnt(3)
    v_mfma_f32_32x32x16_bf16 v[72:87], v[24:27], v[32:35], v[72:87]
    ds_read_b128 v[24:27], v90 offset:43904
    v_cvt_pk_bf16_f32 v30, v44, v45
    v_cvt_pk_bf16_f32 v31, v46, v47
    v_exp_f32 v48, v48
    v_exp_f32 v49, v49
    v_exp_f32 v50, v50
    v_exp_f32 v51, v51
    s_waitcnt lgkmcnt(3)
    v_mfma_f32_32x32x16_bf16 v[72:87], v[20:23], v[28:31], v[72:87]
    ds_read_b128 v[20:23], v90 offset:46080
    v_cvt_pk_bf16_f32 v32, v48, v49
    v_cvt_pk_bf16_f32 v33, v50, v51
    v_exp_f32 v36, v52
    v_exp_f32 v37, v53
    v_exp_f32 v38, v54
    v_exp_f32 v39, v55
    s_waitcnt lgkmcnt(2)
    v_mfma_f32_32x32x16_bf16 v[40:55], v[12:15], v[4:7], 0
    v_cvt_pk_bf16_f32 v34, v36, v37
    v_cvt_pk_bf16_f32 v35, v38, v39
    v_exp_f32 v56, v56
    v_exp_f32 v57, v57
    v_exp_f32 v58, v58
    v_exp_f32 v59, v59
    v_mfma_f32_32x32x16_bf16 v[40:55], v[16:19], v[8:11], v[40:55]
    s_mul_i32 s54, s45, 4753344
    s_add_u32 s54, s54, s46
    s_add_u32 s54, s54, 17584192
    buffer_load_dwordx4 v[224:227], v91, s[28:31], s54 offen
    ds_read_b128 v[12:15], v94 offset:3072
    ds_read_b64 v[16:17], v95 offset:3072
    v_cvt_pk_bf16_f32 v28, v56, v57
    v_cvt_pk_bf16_f32 v29, v58, v59
    v_exp_f32 v60, v60
    v_exp_f32 v61, v61
    v_exp_f32 v62, v62
    v_exp_f32 v63, v63
    s_waitcnt lgkmcnt(3)
    v_mfma_f32_32x32x16_bf16 v[72:87], v[24:27], v[32:35], v[72:87]
    ds_read_b128 v[24:27], v90 offset:46976
    v_cvt_pk_bf16_f32 v30, v60, v61
    v_cvt_pk_bf16_f32 v31, v62, v63
    v_exp_f32 v64, v64
    v_exp_f32 v65, v65
    v_exp_f32 v66, v66
    v_exp_f32 v67, v67
    s_waitcnt lgkmcnt(3)
    v_mfma_f32_32x32x16_bf16 v[72:87], v[20:23], v[28:31], v[72:87]
    s_mul_i32 s54, s40, 5120
    s_add_u32 m0, s54, 122880
    s_add_u32 s54, s54, s53
    s_add_u32 s54, s54, 0
    buffer_load_dwordx4 v97, s[28:31], s54 offen lds
    ds_read_b128 v[20:23], v96 offset:0
    v_cvt_pk_bf16_f32 v32, v64, v65
    v_cvt_pk_bf16_f32 v33, v66, v67
    v_exp_f32 v36, v68
    v_exp_f32 v37, v69
    v_exp_f32 v38, v70
    v_exp_f32 v39, v71
    s_waitcnt lgkmcnt(2)
    v_mfma_f32_32x32x16_bf16 v[56:71], v[12:15], v[4:7], 0
    v_cvt_pk_bf16_f32 v34, v36, v37
    v_cvt_pk_bf16_f32 v35, v38, v39
    v_exp_f32 v40, v40
    v_exp_f32 v41, v41
    v_exp_f32 v42, v42
    v_exp_f32 v43, v43
    v_mfma_f32_32x32x16_bf16 v[56:71], v[16:19], v[8:11], v[56:71]
    s_mul_i32 s54, s45, 4754304
    s_add_u32 s54, s54, s46
    s_add_u32 s54, s54, 17584256
    buffer_load_dwordx4 v[228:231], v91, s[28:31], s54 offen
    ds_read_b128 v[12:15], v94 offset:6144
    ds_read_b64 v[16:17], v95 offset:6144
    v_cvt_pk_bf16_f32 v28, v40, v41
    v_cvt_pk_bf16_f32 v29, v42, v43
    v_exp_f32 v44, v44
    v_exp_f32 v45, v45
    v_exp_f32 v46, v46
    v_exp_f32 v47, v47
    s_waitcnt lgkmcnt(3)
    v_mfma_f32_32x32x16_bf16 v[72:87], v[24:27], v[32:35], v[72:87]
    ds_read_b128 v[24:27], v96 offset:896
    v_cvt_pk_bf16_f32 v30, v44, v45
    v_cvt_pk_bf16_f32 v31, v46, v47
    v_exp_f32 v48, v48
    v_exp_f32 v49, v49
    v_exp_f32 v50, v50
    v_exp_f32 v51, v51
    s_waitcnt lgkmcnt(3)
    v_mfma_f32_32x32x16_bf16 v[72:87], v[20:23], v[28:31], v[72:87]
    ds_read_b128 v[20:23], v96 offset:3072
    v_cvt_pk_bf16_f32 v32, v48, v49
    v_cvt_pk_bf16_f32 v33, v50, v51
    v_exp_f32 v36, v52
    v_exp_f32 v37, v53
    v_exp_f32 v38, v54
    v_exp_f32 v39, v55
    s_waitcnt lgkmcnt(2)
    v_mfma_f32_32x32x16_bf16 v[40:55], v[12:15], v[4:7], 0
    v_cvt_pk_bf16_f32 v34, v36, v37
    v_cvt_pk_bf16_f32 v35, v38, v39
    v_exp_f32 v56, v56
    v_exp_f32 v57, v57
    v_exp_f32 v58, v58
    v_exp_f32 v59, v59
    v_mfma_f32_32x32x16_bf16 v[40:55], v[16:19], v[8:11], v[40:55]
    s_mul_i32 s54, s45, 4767552
    s_add_u32 s54, s54, s46
    s_add_u32 s54, s54, 17572032
    buffer_load_dwordx4 v[232:235], v91, s[28:31], s54 offen
    ds_read_b128 v[12:15], v94 offset:9216
    ds_read_b64 v[16:17], v95 offset:9216
    v_cvt_pk_bf16_f32 v28, v56, v57
    v_cvt_pk_bf16_f32 v29, v58, v59
    v_exp_f32 v60, v60
    v_exp_f32 v61, v61
    v_exp_f32 v62, v62
    v_exp_f32 v63, v63
    s_waitcnt lgkmcnt(3)
    v_mfma_f32_32x32x16_bf16 v[72:87], v[24:27], v[32:35], v[72:87]
    ds_read_b128 v[24:27], v96 offset:3968
    v_cvt_pk_bf16_f32 v30, v60, v61
    v_cvt_pk_bf16_f32 v31, v62, v63
    v_exp_f32 v64, v64
    v_exp_f32 v65, v65
    v_exp_f32 v66, v66
    v_exp_f32 v67, v67
    s_waitcnt lgkmcnt(3)
    v_mfma_f32_32x32x16_bf16 v[72:87], v[20:23], v[28:31], v[72:87]
    s_mul_i32 s54, s40, 5120
    s_add_u32 m0, s54, 123904
    s_add_u32 s54, s54, s53
    s_add_u32 s54, s54, 1024
    buffer_load_dwordx4 v97, s[28:31], s54 offen lds
    ds_read_b128 v[20:23], v96 offset:6144
    v_cvt_pk_bf16_f32 v32, v64, v65
    v_cvt_pk_bf16_f32 v33, v66, v67
    v_exp_f32 v36, v68
    v_exp_f32 v37, v69
    v_exp_f32 v38, v70
    v_exp_f32 v39, v71
    s_waitcnt lgkmcnt(2)
    v_mfma_f32_32x32x16_bf16 v[56:71], v[12:15], v[4:7], 0
    v_cvt_pk_bf16_f32 v34, v36, v37
    v_cvt_pk_bf16_f32 v35, v38, v39
    v_exp_f32 v40, v40
    v_exp_f32 v41, v41
    v_exp_f32 v42, v42
    v_exp_f32 v43, v43
    v_mfma_f32_32x32x16_bf16 v[56:71], v[16:19], v[8:11], v[56:71]
    s_mul_i32 s54, s45, 4783872
    s_add_u32 s54, s54, s46
    s_add_u32 s54, s54, 17572096
    buffer_load_dwordx4 v[236:239], v91, s[28:31], s54 offen
    ds_read_b128 v[12:15], v94 offset:12288
    ds_read_b64 v[16:17], v95 offset:12288
    v_cvt_pk_bf16_f32 v28, v40, v41
    v_cvt_pk_bf16_f32 v29, v42, v43
    v_exp_f32 v44, v44
    v_exp_f32 v45, v45
    v_exp_f32 v46, v46
    v_exp_f32 v47, v47
    s_waitcnt lgkmcnt(3)
    v_mfma_f32_32x32x16_bf16 v[72:87], v[24:27], v[32:35], v[72:87]
    ds_read_b128 v[24:27], v96 offset:7040
    v_cvt_pk_bf16_f32 v30, v44, v45
    v_cvt_pk_bf16_f32 v31, v46, v47
    v_exp_f32 v48, v48
    v_exp_f32 v49, v49
    v_exp_f32 v50, v50
    v_exp_f32 v51, v51
    s_waitcnt lgkmcnt(3)
    v_mfma_f32_32x32x16_bf16 v[72:87], v[20:23], v[28:31], v[72:87]
    ds_read_b128 v[20:23], v96 offset:9216
    v_cvt_pk_bf16_f32 v32, v48, v49
    v_cvt_pk_bf16_f32 v33, v50, v51
    v_exp_f32 v36, v52
    v_exp_f32 v37, v53
    v_exp_f32 v38, v54
    v_exp_f32 v39, v55
    s_waitcnt lgkmcnt(2)
    v_mfma_f32_32x32x16_bf16 v[40:55], v[12:15], v[4:7], 0
    v_cvt_pk_bf16_f32 v34, v36, v37
    v_cvt_pk_bf16_f32 v35, v38, v39
    v_exp_f32 v56, v56
    v_exp_f32 v57, v57
    v_exp_f32 v58, v58
    v_exp_f32 v59, v59
    v_mfma_f32_32x32x16_bf16 v[40:55], v[16:19], v[8:11], v[40:55]
    s_mul_i32 s54, s45, 4784832
    s_add_u32 s54, s54, s46
    s_add_u32 s54, s54, 17572160
    buffer_load_dwordx4 v[240:243], v91, s[28:31], s54 offen
    ds_read_b128 v[12:15], v94 offset:15360
    ds_read_b64 v[16:17], v95 offset:15360
    v_cvt_pk_bf16_f32 v28, v56, v57
    v_cvt_pk_bf16_f32 v29, v58, v59
    v_exp_f32 v60, v60
    v_exp_f32 v61, v61
    v_exp_f32 v62, v62
    v_exp_f32 v63, v63
    s_waitcnt lgkmcnt(3)
    v_mfma_f32_32x32x16_bf16 v[72:87], v[24:27], v[32:35], v[72:87]
    ds_read_b128 v[24:27], v96 offset:10112
    v_cvt_pk_bf16_f32 v30, v60, v61
    v_cvt_pk_bf16_f32 v31, v62, v63
    v_exp_f32 v64, v64
    v_exp_f32 v65, v65
    v_exp_f32 v66, v66
    v_exp_f32 v67, v67
    s_waitcnt lgkmcnt(3)
    v_mfma_f32_32x32x16_bf16 v[72:87], v[20:23], v[28:31], v[72:87]
    s_mul_i32 s54, s40, 5120
    s_add_u32 m0, s54, 124928
    s_add_u32 s54, s54, s53
    s_add_u32 s54, s54, 2048
    buffer_load_dwordx4 v97, s[28:31], s54 offen lds
    ds_read_b128 v[20:23], v96 offset:12288
    v_cvt_pk_bf16_f32 v32, v64, v65
    v_cvt_pk_bf16_f32 v33, v66, v67
    v_exp_f32 v36, v68
    v_exp_f32 v37, v69
    v_exp_f32 v38, v70
    v_exp_f32 v39, v71
    s_waitcnt lgkmcnt(2)
    v_mfma_f32_32x32x16_bf16 v[56:71], v[12:15], v[4:7], 0
    v_cvt_pk_bf16_f32 v34, v36, v37
    v_cvt_pk_bf16_f32 v35, v38, v39
    v_exp_f32 v40, v40
    v_exp_f32 v41, v41
    v_exp_f32 v42, v42
    v_exp_f32 v43, v43
    v_mfma_f32_32x32x16_bf16 v[56:71], v[16:19], v[8:11], v[56:71]
    s_mul_i32 s54, s45, 4773696
    s_add_u32 s54, s54, s46
    s_add_u32 s54, s54, 17584320
    buffer_load_dwordx4 v[244:247], v91, s[28:31], s54 offen
    s_setprio 0
    ds_read_b128 v[12:15], v94 offset:18432
    ds_read_b64 v[16:17], v95 offset:18432
    v_cvt_pk_bf16_f32 v28, v40, v41
    v_cvt_pk_bf16_f32 v29, v42, v43
    v_exp_f32 v44, v44
    v_exp_f32 v45, v45
    v_exp_f32 v46, v46
    v_exp_f32 v47, v47
    s_waitcnt lgkmcnt(3)
    v_mfma_f32_32x32x16_bf16 v[72:87], v[24:27], v[32:35], v[72:87]
    ds_read_b128 v[24:27], v96 offset:13184
    v_cvt_pk_bf16_f32 v30, v44, v45
    v_cvt_pk_bf16_f32 v31, v46, v47
    v_exp_f32 v48, v48
    v_exp_f32 v49, v49
    v_exp_f32 v50, v50
    v_exp_f32 v51, v51
    s_waitcnt lgkmcnt(3)
    v_mfma_f32_32x32x16_bf16 v[72:87], v[20:23], v[28:31], v[72:87]
    ds_read_b128 v[20:23], v96 offset:15360
    v_cvt_pk_bf16_f32 v32, v48, v49
    v_cvt_pk_bf16_f32 v33, v50, v51
    v_exp_f32 v36, v52
    v_exp_f32 v37, v53
    v_exp_f32 v38, v54
    v_exp_f32 v39, v55
    s_waitcnt lgkmcnt(2)
    v_mfma_f32_32x32x16_bf16 v[40:55], v[12:15], v[4:7], 0
    v_cvt_pk_bf16_f32 v34, v36, v37
    v_cvt_pk_bf16_f32 v35, v38, v39
    v_exp_f32 v56, v56
    v_exp_f32 v57, v57
    v_exp_f32 v58, v58
    v_exp_f32 v59, v59
    v_mfma_f32_32x32x16_bf16 v[40:55], v[16:19], v[8:11], v[40:55]
    s_mul_i32 s54, s45, 4774656
    s_add_u32 s54, s54, s46
    s_add_u32 s54, s54, 17584384
    buffer_load_dwordx4 v[248:251], v91, s[28:31], s54 offen
    ds_read_b128 v[12:15], v94 offset:21504
    ds_read_b64 v[16:17], v95 offset:21504
    v_cvt_pk_bf16_f32 v28, v56, v57
    v_cvt_pk_bf16_f32 v29, v58, v59
    v_exp_f32 v60, v60
    v_exp_f32 v61, v61
    v_exp_f32 v62, v62
    v_exp_f32 v63, v63
    s_waitcnt lgkmcnt(3)
    v_mfma_f32_32x32x16_bf16 v[72:87], v[24:27], v[32:35], v[72:87]
    ds_read_b128 v[24:27], v96 offset:16256
    v_cvt_pk_bf16_f32 v30, v60, v61
    v_cvt_pk_bf16_f32 v31, v62, v63
    v_exp_f32 v64, v64
    v_exp_f32 v65, v65
    v_exp_f32 v66, v66
    v_exp_f32 v67, v67
    s_waitcnt lgkmcnt(3)
    v_mfma_f32_32x32x16_bf16 v[72:87], v[20:23], v[28:31], v[72:87]
    s_mul_i32 s54, s40, 5120
    s_add_u32 m0, s54, 125952
    s_add_u32 s54, s54, s53
    s_add_u32 s54, s54, 3072
    buffer_load_dwordx4 v97, s[28:31], s54 offen lds
    ds_read_b128 v[20:23], v96 offset:18432
    v_cvt_pk_bf16_f32 v32, v64, v65
    v_cvt_pk_bf16_f32 v33, v66, v67
    v_exp_f32 v36, v68
    v_exp_f32 v37, v69
    v_exp_f32 v38, v70
    v_exp_f32 v39, v71
    s_waitcnt lgkmcnt(2)
    v_mfma_f32_32x32x16_bf16 v[56:71], v[12:15], v[4:7], 0
    v_cvt_pk_bf16_f32 v34, v36, v37
    v_cvt_pk_bf16_f32 v35, v38, v39
    v_exp_f32 v40, v40
    v_exp_f32 v41, v41
    v_exp_f32 v42, v42
    v_exp_f32 v43, v43
    v_mfma_f32_32x32x16_bf16 v[56:71], v[16:19], v[8:11], v[56:71]
    s_waitcnt vmcnt(25)
    s_barrier
    s_add_u32 m0, s41, 73728
    s_nop 0
    buffer_load_dwordx4 v97, s[8:11], s42 offen offset:0 lds
    buffer_load_dwordx4 v97, s[8:11], s42 offen offset:1024 lds
    buffer_load_dwordx4 v97, s[8:11], s42 offen offset:2048 lds
    s_add_u32 s42, s42, 24576
    s_cmp_lt_u32 s40, 4
    s_cbranch_scc1 attn_p4
    s_setprio 1
attn_p4:
    ds_read_b128 v[12:15], v94 offset:24576
    ds_read_b64 v[16:17], v95 offset:24576
    v_cvt_pk_bf16_f32 v28, v40, v41
    v_cvt_pk_bf16_f32 v29, v42, v43
    v_exp_f32 v44, v44
    v_exp_f32 v45, v45
    v_exp_f32 v46, v46
    v_exp_f32 v47, v47
    s_waitcnt lgkmcnt(3)
    v_mfma_f32_32x32x16_bf16 v[72:87], v[24:27], v[32:35], v[72:87]
    ds_read_b128 v[24:27], v96 offset:19328
    v_cvt_pk_bf16_f32 v30, v44, v45
    v_cvt_pk_bf16_f32 v31, v46, v47
    v_exp_f32 v48, v48
    v_exp_f32 v49, v49
    v_exp_f32 v50, v50
    v_exp_f32 v51, v51
    s_waitcnt lgkmcnt(3)
    v_mfma_f32_32x32x16_bf16 v[72:87], v[20:23], v[28:31], v[72:87]
    ds_read_b128 v[20:23], v96 offset:21504
    v_cvt_pk_bf16_f32 v32, v48, v49
    v_cvt_pk_bf16_f32 v33, v50, v51
    v_exp_f32 v36, v52
    v_exp_f32 v37, v53
    v_exp_f32 v38, v54
    v_exp_f32 v39, v55
    s_waitcnt lgkmcnt(2)
    v_mfma_f32_32x32x16_bf16 v[40:55], v[12:15], v[4:7], 0
    v_cvt_pk_bf16_f32 v34, v36, v37
    v_cvt_pk_bf16_f32 v35, v38, v39
    v_exp_f32 v56, v56
    v_exp_f32 v57, v57
    v_exp_f32 v58, v58
    v_exp_f32 v59, v59
    v_mfma_f32_32x32x16_bf16 v[40:55], v[16:19], v[8:11], v[40:55]
    s_mul_i32 s54, s45, 4775616
    s_add_u32 s54, s54, s46
    s_add_u32 s54, s54, 17584448
    buffer_load_dwordx4 v[252:255], v91, s[28:31], s54 offen
    ds_read_b128 v[12:15], v94 offset:27648
    ds_read_b64 v[16:17], v95 offset:27648
    v_cvt_pk_bf16_f32 v28, v56, v57
    v_cvt_pk_bf16_f32 v29, v58, v59
    v_exp_f32 v60, v60
    v_exp_f32 v61, v61
    v_exp_f32 v62, v62
    v_exp_f32 v63, v63
    s_waitcnt lgkmcnt(3)
    v_mfma_f32_32x32x16_bf16 v[72:87], v[24:27], v[32:35], v[72:87]
    ds_read_b128 v[24:27], v96 offset:22400
    v_cvt_pk_bf16_f32 v30, v60, v61
    v_cvt_pk_bf16_f32 v31, v62, v63
    v_exp_f32 v64, v64
    v_exp_f32 v65, v65
    v_exp_f32 v66, v66
    v_exp_f32 v67, v67
    s_waitcnt lgkmcnt(3)
    v_mfma_f32_32x32x16_bf16 v[72:87], v[20:23], v[28:31], v[72:87]
    s_mul_i32 s54, s40, 5120
    s_add_u32 m0, s54, 126976
    s_add_u32 s54, s54, s53
    s_add_u32 s54, s54, 4096
    buffer_load_dwordx4 v97, s[28:31], s54 offen lds
    ds_read_b128 v[20:23], v96 offset:24576
    v_cvt_pk_bf16_f32 v32, v64, v65
    v_cvt_pk_bf16_f32 v33, v66, v67
    v_exp_f32 v36, v68
    v_exp_f32 v37, v69
    v_exp_f32 v38, v70
    v_exp_f32 v39, v71
    s_waitcnt lgkmcnt(2)
    v_mfma_f32_32x32x16_bf16 v[56:71], v[12:15], v[4:7], 0
    v_cvt_pk_bf16_f32 v34, v36, v37
    v_cvt_pk_bf16_f32 v35, v38, v39
    v_exp_f32 v40, v40
    v_exp_f32 v41, v41
    v_exp_f32 v42, v42
    v_exp_f32 v43, v43
    v_mfma_f32_32x32x16_bf16 v[56:71], v[16:19], v[8:11], v[56:71]
    ds_read_b128 v[12:15], v94 offset:30720
    ds_read_b64 v[16:17], v95 offset:30720
    v_cvt_pk_bf16_f32 v28, v40, v41
    v_cvt_pk_bf16_f32 v29, v42, v43
    v_exp_f32 v44, v44
    v_exp_f32 v45, v45
    v_exp_f32 v46, v46
    v_exp_f32 v47, v47
    s_waitcnt lgkmcnt(3)
    v_mfma_f32_32x32x16_bf16 v[72:87], v[24:27], v[32:35], v[72:87]
    ds_read_b128 v[24:27], v96 offset:25472
    v_cvt_pk_bf16_f32 v30, v44, v45
    v_cvt_pk_bf16_f32 v31, v46, v47
    v_exp_f32 v48, v48
    v_exp_f32 v49, v49
    v_exp_f32 v50, v50
    v_exp_f32 v51, v51
    s_waitcnt lgkmcnt(3)
    v_mfma_f32_32x32x16_bf16 v[72:87], v[20:23], v[28:31], v[72:87]
    ds_read_b128 v[20:23], v96 offset:27648
    v_cvt_pk_bf16_f32 v32, v48, v49
    v_cvt_pk_bf16_f32 v33, v50, v51
    v_exp_f32 v36, v52
    v_exp_f32 v37, v53
    v_exp_f32 v38, v54
    v_exp_f32 v39, v55
    s_waitcnt lgkmcnt(2)
    v_mfma_f32_32x32x16_bf16 v[40:55], v[12:15], v[4:7], 0
    v_cvt_pk_bf16_f32 v34, v36, v37
    v_cvt_pk_bf16_f32 v35, v38, v39
    v_exp_f32 v56, v56
    v_exp_f32 v57, v57
    v_exp_f32 v58, v58
    v_exp_f32 v59, v59
    v_mfma_f32_32x32x16_bf16 v[40:55], v[16:19], v[8:11], v[40:55]
    ds_read_b128 v[12:15], v94 offset:33792
    ds_read_b64 v[16:17], v95 offset:33792
    v_cvt_pk_bf16_f32 v28, v56, v57
    v_cvt_pk_bf16_f32 v29, v58, v59
    v_exp_f32 v60, v60
    v_exp_f32 v61, v61
    v_exp_f32 v62, v62
    v_exp_f32 v63, v63
    s_waitcnt lgkmcnt(3)
    v_mfma_f32_32x32x16_bf16 v[72:87], v[24:27], v[32:35], v[72:87]
    ds_read_b128 v[24:27], v96 offset:28544
    v_cvt_pk_bf16_f32 v30, v60, v61
    v_cvt_pk_bf16_f32 v31, v62, v63
    v_exp_f32 v64, v64
    v_exp_f32 v65, v65
    v_exp_f32 v66, v66
    v_exp_f32 v67, v67
    s_waitcnt lgkmcnt(3)
    v_mfma_f32_32x32x16_bf16 v[72:87], v[20:23], v[28:31], v[72:87]
    s_bfm_b64 exec, 10, 0
    buffer_load_dword v103, v98, s[20:23], s35 offen
    s_mov_b64 exec, -1
    ds_read_b128 v[20:23], v96 offset:30720
    v_cvt_pk_bf16_f32 v32, v64, v65
    v_cvt_pk_bf16_f32 v33, v66, v67
    v_exp_f32 v36, v68
    v_exp_f32 v37, v69
    v_exp_f32 v38, v70
    v_exp_f32 v39, v71
    s_waitcnt lgkmcnt(2)
    v_mfma_f32_32x32x16_bf16 v[56:71], v[12:15], v[4:7], 0
    v_cvt_pk_bf16_f32 v34, v36, v37
    v_cvt_pk_bf16_f32 v35, v38, v39
    v_exp_f32 v40, v40
    v_exp_f32 v41, v41
    v_exp_f32 v42, v42
    v_exp_f32 v43, v43
    v_mfma_f32_32x32x16_bf16 v[56:71], v[16:19], v[8:11], v[56:71]
    ds_read_b128 v[12:15], v94 offset:36864
    ds_read_b64 v[16:17], v95 offset:36864
    v_cvt_pk_bf16_f32 v28, v40, v41
    v_cvt_pk_bf16_f32 v29, v42, v43
    v_exp_f32 v44, v44
    v_exp_f32 v45, v45
    v_exp_f32 v46, v46
    v_exp_f32 v47, v47
    s_waitcnt lgkmcnt(3)
    v_mfma_f32_32x32x16_bf16 v[72:87], v[24:27], v[32:35], v[72:87]
    ds_read_b128 v[24:27], v96 offset:31616
    v_cvt_pk_bf16_f32 v30, v44, v45
    v_cvt_pk_bf16_f32 v31, v46, v47
    v_exp_f32 v48, v48
    v_exp_f32 v49, v49
    v_exp_f32 v50, v50
    v_exp_f32 v51, v51
    s_waitcnt lgkmcnt(3)
    v_mfma_f32_32x32x16_bf16 v[72:87], v[20:23], v[28:31], v[72:87]
    ds_read_b128 v[20:23], v96 offset:33792
    v_cvt_pk_bf16_f32 v32, v48, v49
    v_cvt_pk_bf16_f32 v33, v50, v51
    v_exp_f32 v36, v52
    v_exp_f32 v37, v53
    v_exp_f32 v38, v54
    v_exp_f32 v39, v55
    s_waitcnt lgkmcnt(2)
    v_mfma_f32_32x32x16_bf16 v[40:55], v[12:15], v[4:7], 0
    v_cvt_pk_bf16_f32 v34, v36, v37
    v_cvt_pk_bf16_f32 v35, v38, v39
    v_exp_f32 v56, v56
    v_exp_f32 v57, v57
    v_exp_f32 v58, v58
    v_exp_f32 v59, v59
    v_mfma_f32_32x32x16_bf16 v[40:55], v[16:19], v[8:11], v[40:55]
    ds_read_b128 v[12:15], v94 offset:39936
    ds_read_b64 v[16:17], v95 offset:39936
    v_cvt_pk_bf16_f32 v28, v56, v57
    v_cvt_pk_bf16_f32 v29, v58, v59
    v_exp_f32 v60, v60
    v_exp_f32 v61, v61
    v_exp_f32 v62, v62
    v_exp_f32 v63, v63
    s_waitcnt lgkmcnt(3)
    v_mfma_f32_32x32x16_bf16 v[72:87], v[24:27], v[32:35], v[72:87]
    ds_read_b128 v[24:27], v96 offset:34688
    v_cvt_pk_bf16_f32 v30, v60, v61
    v_cvt_pk_bf16_f32 v31, v62, v63
    v_exp_f32 v64, v64
    v_exp_f32 v65, v65
    v_exp_f32 v66, v66
    v_exp_f32 v67, v67
    s_waitcnt lgkmcnt(3)
    v_mfma_f32_32x32x16_bf16 v[72:87], v[20:23], v[28:31], v[72:87]
    s_bfm_b64 exec, 32, 0
    buffer_load_dword v102, v101, s[24:27], s33 offen sc1
    s_mov_b64 exec, -1
    ds_read_b128 v[20:23], v96 offset:36864
    v_cvt_pk_bf16_f32 v32, v64, v65
    v_cvt_pk_bf16_f32 v33, v66, v67
    v_exp_f32 v36, v68
    v_exp_f32 v37, v69
    v_exp_f32 v38, v70
    v_exp_f32 v39, v71
    s_waitcnt lgkmcnt(2)
    v_mfma_f32_32x32x16_bf16 v[56:71], v[12:15], v[4:7], 0
    v_cvt_pk_bf16_f32 v34, v36, v37
    v_cvt_pk_bf16_f32 v35, v38, v39
    v_exp_f32 v40, v40
    v_exp_f32 v41, v41
    v_exp_f32 v42, v42
    v_exp_f32 v43, v43
    v_mfma_f32_32x32x16_bf16 v[56:71], v[16:19], v[8:11], v[56:71]
    s_setprio 0
    ds_read_b128 v[12:15], v94 offset:43008
    ds_read_b64 v[16:17], v95 offset:43008
    v_cvt_pk_bf16_f32 v28, v40, v41
    v_cvt_pk_bf16_f32 v29, v42, v43
    v_exp_f32 v44, v44
    v_exp_f32 v45, v45
    v_exp_f32 v46, v46
    v_exp_f32 v47, v47
    s_waitcnt lgkmcnt(3)
    v_mfma_f32_32x32x16_bf16 v[72:87], v[24:27], v[32:35], v[72:87]
    ds_read_b128 v[24:27], v96 offset:37760
    v_cvt_pk_bf16_f32 v30, v44, v45
    v_cvt_pk_bf16_f32 v31, v46, v47
    v_exp_f32 v48, v48
    v_exp_f32 v49, v49
    v_exp_f32 v50, v50
    v_exp_f32 v51, v51
    s_waitcnt lgkmcnt(3)
    v_mfma_f32_32x32x16_bf16 v[72:87], v[20:23], v[28:31], v[72:87]
    ds_read_b128 v[20:23], v96 offset:39936
    v_cvt_pk_bf16_f32 v32, v48, v49
    v_cvt_pk_bf16_f32 v33, v50, v51
    v_exp_f32 v36, v52
    v_exp_f32 v37, v53
    v_exp_f32 v38, v54
    v_exp_f32 v39, v55
    s_waitcnt lgkmcnt(2)
    v_mfma_f32_32x32x16_bf16 v[40:55], v[12:15], v[4:7], 0
    v_cvt_pk_bf16_f32 v34, v36, v37
    v_cvt_pk_bf16_f32 v35, v38, v39
    v_exp_f32 v56, v56
    v_exp_f32 v57, v57
    v_exp_f32 v58, v58
    v_exp_f32 v59, v59
    v_mfma_f32_32x32x16_bf16 v[40:55], v[16:19], v[8:11], v[40:55]
    ds_read_b128 v[12:15], v94 offset:46080
    ds_read_b64 v[16:17], v95 offset:46080
    v_cvt_pk_bf16_f32 v28, v56, v57
    v_cvt_pk_bf16_f32 v29, v58, v59
    v_exp_f32 v60, v60
    v_exp_f32 v61, v61
    v_exp_f32 v62, v62
    v_exp_f32 v63, v63
    s_waitcnt lgkmcnt(3)
    v_mfma_f32_32x32x16_bf16 v[72:87], v[24:27], v[32:35], v[72:87]
    ds_read_b128 v[24:27], v96 offset:40832
    v_cvt_pk_bf16_f32 v30, v60, v61
    v_cvt_pk_bf16_f32 v31, v62, v63
    v_exp_f32 v64, v64
    v_exp_f32 v65, v65
    v_exp_f32 v66, v66
    v_exp_f32 v67, v67
    s_waitcnt lgkmcnt(3)
    v_mfma_f32_32x32x16_bf16 v[72:87], v[20:23], v[28:31], v[72:87]
    ds_read_b128 v[20:23], v96 offset:43008
    v_cvt_pk_bf16_f32 v32, v64, v65
    v_cvt_pk_bf16_f32 v33, v66, v67
    v_exp_f32 v36, v68
    v_exp_f32 v37, v69
    v_exp_f32 v38, v70
    v_exp_f32 v39, v71
    s_waitcnt lgkmcnt(2)
    v_mfma_f32_32x32x16_bf16 v[56:71], v[12:15], v[4:7], 0
    v_cvt_pk_bf16_f32 v34, v36, v37
    v_cvt_pk_bf16_f32 v35, v38, v39
    v_exp_f32 v40, v40
    v_exp_f32 v41, v41
    v_exp_f32 v42, v42
    v_exp_f32 v43, v43
    v_mfma_f32_32x32x16_bf16 v[56:71], v[16:19], v[8:11], v[56:71]
    s_waitcnt vmcnt(18)
    s_barrier
    s_cmp_lt_u32 s40, 4
    s_cbranch_scc1 attn_p5
    s_setprio 1
attn_p5:
    ds_read_b128 v[12:15], v88 offset:0
    ds_read_b64 v[16:17], v89 offset:0
    v_cvt_pk_bf16_f32 v28, v40, v41
    v_cvt_pk_bf16_f32 v29, v42, v43
    v_exp_f32 v44, v44
    v_exp_f32 v45, v45
    v_exp_f32 v46, v46
    v_exp_f32 v47, v47
    s_waitcnt lgkmcnt(3)
    v_mfma_f32_32x32x16_bf16 v[72:87], v[24:27], v[32:35], v[72:87]
    ds_read_b128 v[24:27], v96 offset:43904
    v_cvt_pk_bf16_f32 v30, v44, v45
    v_cvt_pk_bf16_f32 v31, v46, v47
    v_exp_f32 v48, v48
    v_exp_f32 v49, v49
    v_exp_f32 v50, v50
    v_exp_f32 v51, v51
    s_waitcnt lgkmcnt(3)
    v_mfma_f32_32x32x16_bf16 v[72:87], v[20:23], v[28:31], v[72:87]
    ds_read_b128 v[20:23], v96 offset:46080
    v_cvt_pk_bf16_f32 v32, v48, v49
    v_cvt_pk_bf16_f32 v33, v50, v51
    v_exp_f32 v36, v52
    v_exp_f32 v37, v53
    v_exp_f32 v38, v54
    v_exp_f32 v39, v55
    s_waitcnt lgkmcnt(2)
    v_mfma_f32_32x32x16_bf16 v[40:55], v[12:15], v[4:7], 0
    v_cvt_pk_bf16_f32 v34, v36, v37
    v_cvt_pk_bf16_f32 v35, v38, v39
    v_exp_f32 v56, v56
    v_exp_f32 v57, v57
    v_exp_f32 v58, v58
    v_exp_f32 v59, v59
    v_mfma_f32_32x32x16_bf16 v[40:55], v[16:19], v[8:11], v[40:55]
    ds_read_b128 v[12:15], v88 offset:3072
    ds_read_b64 v[16:17], v89 offset:3072
    v_cvt_pk_bf16_f32 v28, v56, v57
    v_cvt_pk_bf16_f32 v29, v58, v59
    v_exp_f32 v60, v60
    v_exp_f32 v61, v61
    v_exp_f32 v62, v62
    v_exp_f32 v63, v63
    s_waitcnt lgkmcnt(3)
    v_mfma_f32_32x32x16_bf16 v[72:87], v[24:27], v[32:35], v[72:87]
    ds_read_b128 v[24:27], v96 offset:46976
    v_cvt_pk_bf16_f32 v30, v60, v61
    v_cvt_pk_bf16_f32 v31, v62, v63
    v_exp_f32 v64, v64
    v_exp_f32 v65, v65
    v_exp_f32 v66, v66
    v_exp_f32 v67, v67
    s_waitcnt lgkmcnt(3)
    v_mfma_f32_32x32x16_bf16 v[72:87], v[20:23], v[28:31], v[72:87]
    ds_read_b128 v[20:23], v90 offset:0
    v_cvt_pk_bf16_f32 v32, v64, v65
    v_cvt_pk_bf16_f32 v33, v66, v67
    v_exp_f32 v36, v68
    v_exp_f32 v37, v69
    v_exp_f32 v38, v70
    v_exp_f32 v39, v71
    s_waitcnt lgkmcnt(2)
    v_mfma_f32_32x32x16_bf16 v[56:71], v[12:15], v[4:7], 0
    v_cvt_pk_bf16_f32 v34, v36, v37
    v_cvt_pk_bf16_f32 v35, v38, v39
    v_exp_f32 v40, v40
    v_exp_f32 v41, v41
    v_exp_f32 v42, v42
    v_exp_f32 v43, v43
    v_mfma_f32_32x32x16_bf16 v[56:71], v[16:19], v[8:11], v[56:71]
    ds_read_b128 v[12:15], v88 offset:6144
    ds_read_b64 v[16:17], v89 offset:6144
    v_cvt_pk_bf16_f32 v28, v40, v41
    v_cvt_pk_bf16_f32 v29, v42, v43
    v_exp_f32 v44, v44
    v_exp_f32 v45, v45
    v_exp_f32 v46, v46
    v_exp_f32 v47, v47
    s_waitcnt lgkmcnt(3)
    v_mfma_f32_32x32x16_bf16 v[72:87], v[24:27], v[32:35], v[72:87]
    ds_read_b128 v[24:27], v90 offset:896
    v_cvt_pk_bf16_f32 v30, v44, v45
    v_cvt_pk_bf16_f32 v31, v46, v47
    v_exp_f32 v48, v48
    v_exp_f32 v49, v49
    v_exp_f32 v50, v50
    v_exp_f32 v51, v51
    s_waitcnt lgkmcnt(3)
    v_mfma_f32_32x32x16_bf16 v[72:87], v[20:23], v[28:31], v[72:87]
    ds_read_b128 v[20:23], v90 offset:3072
    v_cvt_pk_bf16_f32 v32, v48, v49
    v_cvt_pk_bf16_f32 v33, v50, v51
    v_exp_f32 v36, v52
    v_exp_f32 v37, v53
    v_exp_f32 v38, v54
    v_exp_f32 v39, v55
    s_waitcnt lgkmcnt(2)
    v_mfma_f32_32x32x16_bf16 v[40:55], v[12:15], v[4:7], 0
    v_cvt_pk_bf16_f32 v34, v36, v37
    v_cvt_pk_bf16_f32 v35, v38, v39
    v_exp_f32 v56, v56
    v_exp_f32 v57, v57
    v_exp_f32 v58, v58
    v_exp_f32 v59, v59
    v_mfma_f32_32x32x16_bf16 v[40:55], v[16:19], v[8:11], v[40:55]
    ds_read_b128 v[12:15], v88 offset:9216
    ds_read_b64 v[16:17], v89 offset:9216
    v_cvt_pk_bf16_f32 v28, v56, v57
    v_cvt_pk_bf16_f32 v29, v58, v59
    v_exp_f32 v60, v60
    v_exp_f32 v61, v61
    v_exp_f32 v62, v62
    v_exp_f32 v63, v63
    s_waitcnt lgkmcnt(3)
    v_mfma_f32_32x32x16_bf16 v[72:87], v[24:27], v[32:35], v[72:87]
    ds_read_b128 v[24:27], v90 offset:3968
    v_cvt_pk_bf16_f32 v30, v60, v61
    v_cvt_pk_bf16_f32 v31, v62, v63
    v_exp_f32 v64, v64
    v_exp_f32 v65, v65
    v_exp_f32 v66, v66
    v_exp_f32 v67, v67
    s_waitcnt lgkmcnt(3)
    v_mfma_f32_32x32x16_bf16 v[72:87], v[20:23], v[28:31], v[72:87]
    ds_read_b128 v[20:23], v90 offset:6144
    v_cvt_pk_bf16_f32 v32, v64, v65
    v_cvt_pk_bf16_f32 v33, v66, v67
    v_exp_f32 v36, v68
    v_exp_f32 v37, v69
    v_exp_f32 v38, v70
    v_exp_f32 v39, v71
    s_waitcnt lgkmcnt(2)
    v_mfma_f32_32x32x16_bf16 v[56:71], v[12:15], v[4:7], 0
    v_cvt_pk_bf16_f32 v34, v36, v37
    v_cvt_pk_bf16_f32 v35, v38, v39
    v_exp_f32 v40, v40
    v_exp_f32 v41, v41
    v_exp_f32 v42, v42
    v_exp_f32 v43, v43
    v_mfma_f32_32x32x16_bf16 v[56:71], v[16:19], v[8:11], v[56:71]
    ds_read_b128 v[12:15], v88 offset:12288
    ds_read_b64 v[16:17], v89 offset:12288
    v_cvt_pk_bf16_f32 v28, v40, v41
    v_cvt_pk_bf16_f32 v29, v42, v43
    v_exp_f32 v44, v44
    v_exp_f32 v45, v45
    v_exp_f32 v46, v46
    v_exp_f32 v47, v47
    s_waitcnt lgkmcnt(3)
    v_mfma_f32_32x32x16_bf16 v[72:87], v[24:27], v[32:35], v[72:87]
    ds_read_b128 v[24:27], v90 offset:7040
    v_cvt_pk_bf16_f32 v30, v44, v45
    v_cvt_pk_bf16_f32 v31, v46, v47
    v_exp_f32 v48, v48
    v_exp_f32 v49, v49
    v_exp_f32 v50, v50
    v_exp_f32 v51, v51
    s_waitcnt lgkmcnt(3)
    v_mfma_f32_32x32x16_bf16 v[72:87], v[20:23], v[28:31], v[72:87]
    ds_read_b128 v[20:23], v90 offset:9216
    v_cvt_pk_bf16_f32 v32, v48, v49
    v_cvt_pk_bf16_f32 v33, v50, v51
    v_exp_f32 v36, v52
    v_exp_f32 v37, v53
    v_exp_f32 v38, v54
    v_exp_f32 v39, v55
    s_waitcnt lgkmcnt(2)
    v_mfma_f32_32x32x16_bf16 v[40:55], v[12:15], v[4:7], 0
    v_cvt_pk_bf16_f32 v34, v36, v37
    v_cvt_pk_bf16_f32 v35, v38, v39
    v_exp_f32 v56, v56
    v_exp_f32 v57, v57
    v_exp_f32 v58, v58
    v_exp_f32 v59, v59
    v_mfma_f32_32x32x16_bf16 v[40:55], v[16:19], v[8:11], v[40:55]
    ds_read_b128 v[12:15], v88 offset:15360
    ds_read_b64 v[16:17], v89 offset:15360
    v_cvt_pk_bf16_f32 v28, v56, v57
    v_cvt_pk_bf16_f32 v29, v58, v59
    v_exp_f32 v60, v60
    v_exp_f32 v61, v61
    v_exp_f32 v62, v62
    v_exp_f32 v63, v63
    s_waitcnt lgkmcnt(3)
    v_mfma_f32_32x32x16_bf16 v[72:87], v[24:27], v[32:35], v[72:87]
    ds_read_b128 v[24:27], v90 offset:10112
    v_cvt_pk_bf16_f32 v30, v60, v61
    v_cvt_pk_bf16_f32 v31, v62, v63
    v_exp_f32 v64, v64
    v_exp_f32 v65, v65
    v_exp_f32 v66, v66
    v_exp_f32 v67, v67
    s_waitcnt lgkmcnt(3)
    v_mfma_f32_32x32x16_bf16 v[72:87], v[20:23], v[28:31], v[72:87]
    ds_read_b128 v[20:23], v90 offset:12288
    v_cvt_pk_bf16_f32 v32, v64, v65
    v_cvt_pk_bf16_f32 v33, v66, v67
    v_exp_f32 v36, v68
    v_exp_f32 v37, v69
    v_exp_f32 v38, v70
    v_exp_f32 v39, v71
    s_waitcnt lgkmcnt(2)
    v_mfma_f32_32x32x16_bf16 v[56:71], v[12:15], v[4:7], 0
    v_cvt_pk_bf16_f32 v34, v36, v37
    v_cvt_pk_bf16_f32 v35, v38, v39
    v_exp_f32 v40, v40
    v_exp_f32 v41, v41
    v_exp_f32 v42, v42
    v_exp_f32 v43, v43
    v_mfma_f32_32x32x16_bf16 v[56:71], v[16:19], v[8:11], v[56:71]
    s_setprio 0
    ds_read_b128 v[12:15], v88 offset:18432
    ds_read_b64 v[16:17], v89 offset:18432
    v_cvt_pk_bf16_f32 v28, v40, v41
    v_cvt_pk_bf16_f32 v29, v42, v43
    v_exp_f32 v44, v44
    v_exp_f32 v45, v45
    v_exp_f32 v46, v46
    v_exp_f32 v47, v47
    s_waitcnt lgkmcnt(3)
    v_mfma_f32_32x32x16_bf16 v[72:87], v[24:27], v[32:35], v[72:87]
    ds_read_b128 v[24:27], v90 offset:13184
    v_cvt_pk_bf16_f32 v30, v44, v45
    v_cvt_pk_bf16_f32 v31, v46, v47
    v_exp_f32 v48, v48
    v_exp_f32 v49, v49
    v_exp_f32 v50, v50
    v_exp_f32 v51, v51
    s_waitcnt lgkmcnt(3)
    v_mfma_f32_32x32x16_bf16 v[72:87], v[20:23], v[28:31], v[72:87]
    ds_read_b128 v[20:23], v90 offset:15360
    v_cvt_pk_bf16_f32 v32, v48, v49
    v_cvt_pk_bf16_f32 v33, v50, v51
    v_exp_f32 v36, v52
    v_exp_f32 v37, v53
    v_exp_f32 v38, v54
    v_exp_f32 v39, v55
    s_waitcnt lgkmcnt(2)
    v_mfma_f32_32x32x16_bf16 v[40:55], v[12:15], v[4:7], 0
    v_cvt_pk_bf16_f32 v34, v36, v37
    v_cvt_pk_bf16_f32 v35, v38, v39
    v_exp_f32 v56, v56
    v_exp_f32 v57, v57
    v_exp_f32 v58, v58
    v_exp_f32 v59, v59
    v_mfma_f32_32x32x16_bf16 v[40:55], v[16:19], v[8:11], v[40:55]
    ds_read_b128 v[12:15], v88 offset:21504
    ds_read_b64 v[16:17], v89 offset:21504
    v_cvt_pk_bf16_f32 v28, v56, v57
    v_cvt_pk_bf16_f32 v29, v58, v59
    v_exp_f32 v60, v60
    v_exp_f32 v61, v61
    v_exp_f32 v62, v62
    v_exp_f32 v63, v63
    s_waitcnt lgkmcnt(3)
    v_mfma_f32_32x32x16_bf16 v[72:87], v[24:27], v[32:35], v[72:87]
    ds_read_b128 v[24:27], v90 offset:16256
    v_cvt_pk_bf16_f32 v30, v60, v61
    v_cvt_pk_bf16_f32 v31, v62, v63
    v_exp_f32 v64, v64
    v_exp_f32 v65, v65
    v_exp_f32 v66, v66
    v_exp_f32 v67, v67
    s_waitcnt lgkmcnt(3)
    v_mfma_f32_32x32x16_bf16 v[72:87], v[20:23], v[28:31], v[72:87]
    ds_read_b128 v[20:23], v90 offset:18432
    v_cvt_pk_bf16_f32 v32, v64, v65
    v_cvt_pk_bf16_f32 v33, v66, v67
    v_exp_f32 v36, v68
    v_exp_f32 v37, v69
    v_exp_f32 v38, v70
    v_exp_f32 v39, v71
    s_waitcnt lgkmcnt(2)
    v_mfma_f32_32x32x16_bf16 v[56:71], v[12:15], v[4:7], 0
    v_cvt_pk_bf16_f32 v34, v36, v37
    v_cvt_pk_bf16_f32 v35, v38, v39
    v_exp_f32 v40, v40
    v_exp_f32 v41, v41
    v_exp_f32 v42, v42
    v_exp_f32 v43, v43
    v_mfma_f32_32x32x16_bf16 v[56:71], v[16:19], v[8:11], v[56:71]
    s_waitcnt vmcnt(4)
    s_barrier
    s_cmp_lt_u32 s40, 4
    s_cbranch_scc1 attn_p6
    s_setprio 1
attn_p6:
    s_mul_i32 s54, s40, 6144
    s_add_u32 m0, s54, 0
    s_add_u32 s54, s54, s53
    s_add_u32 s54, s54, 40960
    buffer_load_dwordx4 v97, s[28:31], s54 offen lds
    ds_read_b128 v[12:15], v88 offset:24576
    ds_read_b64 v[16:17], v89 offset:24576
    v_cvt_pk_bf16_f32 v28, v40, v41
    v_cvt_pk_bf16_f32 v29, v42, v43
    v_exp_f32 v44, v44
    v_exp_f32 v45, v45
    v_exp_f32 v46, v46
    v_exp_f32 v47, v47
    s_waitcnt lgkmcnt(3)
    v_mfma_f32_32x32x16_bf16 v[72:87], v[24:27], v[32:35], v[72:87]
    ds_read_b128 v[24:27], v90 offset:19328
    v_cvt_pk_bf16_f32 v30, v44, v45
    v_cvt_pk_bf16_f32 v31, v46, v47
    v_exp_f32 v48, v48
    v_exp_f32 v49, v49
    v_exp_f32 v50, v50
    v_exp_f32 v51, v51
    s_waitcnt lgkmcnt(3)
    v_mfma_f32_32x32x16_bf16 v[72:87], v[20:23], v[28:31], v[72:87]
    ds_read_b128 v[20:23], v90 offset:21504
    v_cvt_pk_bf16_f32 v32, v48, v49
    v_cvt_pk_bf16_f32 v33, v50, v51
    v_exp_f32 v36, v52
    v_exp_f32 v37, v53
    v_exp_f32 v38, v54
    v_exp_f32 v39, v55
    s_waitcnt lgkmcnt(2)
    v_mfma_f32_32x32x16_bf16 v[40:55], v[12:15], v[4:7], 0
    v_cvt_pk_bf16_f32 v34, v36, v37
    v_cvt_pk_bf16_f32 v35, v38, v39
    v_exp_f32 v56, v56
    v_exp_f32 v57, v57
    v_exp_f32 v58, v58
    v_exp_f32 v59, v59
    v_mfma_f32_32x32x16_bf16 v[40:55], v[16:19], v[8:11], v[40:55]
    s_mul_i32 s54, s40, 6144
    s_add_u32 m0, s54, 1024
    s_add_u32 s54, s54, s53
    s_add_u32 s54, s54, 41984
    buffer_load_dwordx4 v97, s[28:31], s54 offen lds
    ds_read_b128 v[12:15], v88 offset:27648
    ds_read_b64 v[16:17], v89 offset:27648
    v_cvt_pk_bf16_f32 v28, v56, v57
    v_cvt_pk_bf16_f32 v29, v58, v59
    v_exp_f32 v60, v60
    v_exp_f32 v61, v61
    v_exp_f32 v62, v62
    v_exp_f32 v63, v63
    s_waitcnt lgkmcnt(3)
    v_mfma_f32_32x32x16_bf16 v[72:87], v[24:27], v[32:35], v[72:87]
    ds_read_b128 v[24:27], v90 offset:22400
    v_cvt_pk_bf16_f32 v30, v60, v61
    v_cvt_pk_bf16_f32 v31, v62, v63
    v_exp_f32 v64, v64
    v_exp_f32 v65, v65
    v_exp_f32 v66, v66
    v_exp_f32 v67, v67
    s_waitcnt lgkmcnt(3)
    v_mfma_f32_32x32x16_bf16 v[72:87], v[20:23], v[28:31], v[72:87]
    ds_read_b128 v[20:23], v90 offset:24576
    v_cvt_pk_bf16_f32 v32, v64, v65
    v_cvt_pk_bf16_f32 v33, v66, v67
    v_exp_f32 v36, v68
    v_exp_f32 v37, v69
    v_exp_f32 v38, v70
    v_exp_f32 v39, v71
    s_waitcnt lgkmcnt(2)
    v_mfma_f32_32x32x16_bf16 v[56:71], v[12:15], v[4:7], 0
    v_cvt_pk_bf16_f32 v34, v36, v37
    v_cvt_pk_bf16_f32 v35, v38, v39
    v_exp_f32 v40, v40
    v_exp_f32 v41, v41
    v_exp_f32 v42, v42
    v_exp_f32 v43, v43
    v_mfma_f32_32x32x16_bf16 v[56:71], v[16:19], v[8:11], v[56:71]
    s_mul_i32 s54, s40, 6144
    s_add_u32 m0, s54, 2048
    s_add_u32 s54, s54, s53
    s_add_u32 s54, s54, 43008
    buffer_load_dwordx4 v97, s[28:31], s54 offen lds
    ds_read_b128 v[12:15], v88 offset:30720
    ds_read_b64 v[16:17], v89 offset:30720
    v_cvt_pk_bf16_f32 v28, v40, v41
    v_cvt_pk_bf16_f32 v29, v42, v43
    v_exp_f32 v44, v44
    v_exp_f32 v45, v45
    v_exp_f32 v46, v46
    v_exp_f32 v47, v47
    s_waitcnt lgkmcnt(3)
    v_mfma_f32_32x32x16_bf16 v[72:87], v[24:27], v[32:35], v[72:87]
    ds_read_b128 v[24:27], v90 offset:25472
    v_cvt_pk_bf16_f32 v30, v44, v45
    v_cvt_pk_bf16_f32 v31, v46, v47
    v_exp_f32 v48, v48
    v_exp_f32 v49, v49
    v_exp_f32 v50, v50
    v_exp_f32 v51, v51
    s_waitcnt lgkmcnt(3)
    v_mfma_f32_32x32x16_bf16 v[72:87], v[20:23], v[28:31], v[72:87]
    ds_read_b128 v[20:23], v90 offset:27648
    v_cvt_pk_bf16_f32 v32, v48, v49
    v_cvt_pk_bf16_f32 v33, v50, v51
    v_exp_f32 v36, v52
    v_exp_f32 v37, v53
    v_exp_f32 v38, v54
    v_exp_f32 v39, v55
    s_waitcnt lgkmcnt(2)
    v_mfma_f32_32x32x16_bf16 v[40:55], v[12:15], v[4:7], 0
    v_cvt_pk_bf16_f32 v34, v36, v37
    v_cvt_pk_bf16_f32 v35, v38, v39
    v_exp_f32 v56, v56
    v_exp_f32 v57, v57
    v_exp_f32 v58, v58
    v_exp_f32 v59, v59
    v_mfma_f32_32x32x16_bf16 v[40:55], v[16:19], v[8:11], v[40:55]
    s_mul_i32 s54, s40, 6144
    s_add_u32 m0, s54, 3072
    s_add_u32 s54, s54, s53
    s_add_u32 s54, s54, 44032
    buffer_load_dwordx4 v97, s[28:31], s54 offen lds
    ds_read_b128 v[12:15], v88 offset:33792
    ds_read_b64 v[16:17], v89 offset:33792
    v_cvt_pk_bf16_f32 v28, v56, v57
    v_cvt_pk_bf16_f32 v29, v58, v59
    v_exp_f32 v60, v60
    v_exp_f32 v61, v61
    v_exp_f32 v62, v62
    v_exp_f32 v63, v63
    s_waitcnt lgkmcnt(3)
    v_mfma_f32_32x32x16_bf16 v[72:87], v[24:27], v[32:35], v[72:87]
    ds_read_b128 v[24:27], v90 offset:28544
    v_cvt_pk_bf16_f32 v30, v60, v61
    v_cvt_pk_bf16_f32 v31, v62, v63
    v_exp_f32 v64, v64
    v_exp_f32 v65, v65
    v_exp_f32 v66, v66
    v_exp_f32 v67, v67
    s_waitcnt lgkmcnt(3)
    v_mfma_f32_32x32x16_bf16 v[72:87], v[20:23], v[28:31], v[72:87]
    ds_read_b128 v[20:23], v90 offset:30720
    v_cvt_pk_bf16_f32 v32, v64, v65
    v_cvt_pk_bf16_f32 v33, v66, v67
    v_exp_f32 v36, v68
    v_exp_f32 v37, v69
    v_exp_f32 v38, v70
    v_exp_f32 v39, v71
    s_waitcnt lgkmcnt(2)
    v_mfma_f32_32x32x16_bf16 v[56:71], v[12:15], v[4:7], 0
    v_cvt_pk_bf16_f32 v34, v36, v37
    v_cvt_pk_bf16_f32 v35, v38, v39
    v_exp_f32 v40, v40
    v_exp_f32 v41, v41
    v_exp_f32 v42, v42
    v_exp_f32 v43, v43
    v_mfma_f32_32x32x16_bf16 v[56:71], v[16:19], v[8:11], v[56:71]
    s_mul_i32 s54, s40, 6144
    s_add_u32 m0, s54, 4096
    s_add_u32 s54, s54, s53
    s_add_u32 s54, s54, 45056
    buffer_load_dwordx4 v97, s[28:31], s54 offen lds
    ds_read_b128 v[12:15], v88 offset:36864
    ds_read_b64 v[16:17], v89 offset:36864
    v_cvt_pk_bf16_f32 v28, v40, v41
    v_cvt_pk_bf16_f32 v29, v42, v43
    v_exp_f32 v44, v44
    v_exp_f32 v45, v45
    v_exp_f32 v46, v46
    v_exp_f32 v47, v47
    s_waitcnt lgkmcnt(3)
    v_mfma_f32_32x32x16_bf16 v[72:87], v[24:27], v[32:35], v[72:87]
    ds_read_b128 v[24:27], v90 offset:31616
    v_cvt_pk_bf16_f32 v30, v44, v45
    v_cvt_pk_bf16_f32 v31, v46, v47
    v_exp_f32 v48, v48
    v_exp_f32 v49, v49
    v_exp_f32 v50, v50
    v_exp_f32 v51, v51
    s_waitcnt lgkmcnt(3)
    v_mfma_f32_32x32x16_bf16 v[72:87], v[20:23], v[28:31], v[72:87]
    ds_read_b128 v[20:23], v90 offset:33792
    v_cvt_pk_bf16_f32 v32, v48, v49
    v_cvt_pk_bf16_f32 v33, v50, v51
    v_exp_f32 v36, v52
    v_exp_f32 v37, v53
    v_exp_f32 v38, v54
    v_exp_f32 v39, v55
    s_waitcnt lgkmcnt(2)
    v_mfma_f32_32x32x16_bf16 v[40:55], v[12:15], v[4:7], 0
    v_cvt_pk_bf16_f32 v34, v36, v37
    v_cvt_pk_bf16_f32 v35, v38, v39
    v_exp_f32 v56, v56
    v_exp_f32 v57, v57
    v_exp_f32 v58, v58
    v_exp_f32 v59, v59
    v_mfma_f32_32x32x16_bf16 v[40:55], v[16:19], v[8:11], v[40:55]
    s_mul_i32 s54, s40, 6144
    s_add_u32 m0, s54, 5120
    s_add_u32 s54, s54, s53
    s_add_u32 s54, s54, 46080
    buffer_load_dwordx4 v97, s[28:31], s54 offen lds
    ds_read_b128 v[12:15], v88 offset:39936
    ds_read_b64 v[16:17], v89 offset:39936
    v_cvt_pk_bf16_f32 v28, v56, v57
    v_cvt_pk_bf16_f32 v29, v58, v59
    v_exp_f32 v60, v60
    v_exp_f32 v61, v61
    v_exp_f32 v62, v62
    v_exp_f32 v63, v63
    s_waitcnt lgkmcnt(3)
    v_mfma_f32_32x32x16_bf16 v[72:87], v[24:27], v[32:35], v[72:87]
    ds_read_b128 v[24:27], v90 offset:34688
    v_cvt_pk_bf16_f32 v30, v60, v61
    v_cvt_pk_bf16_f32 v31, v62, v63
    v_exp_f32 v64, v64
    v_exp_f32 v65, v65
    v_exp_f32 v66, v66
    v_exp_f32 v67, v67
    s_waitcnt lgkmcnt(3)
    v_mfma_f32_32x32x16_bf16 v[72:87], v[20:23], v[28:31], v[72:87]
    ds_read_b128 v[20:23], v90 offset:36864
    v_cvt_pk_bf16_f32 v32, v64, v65
    v_cvt_pk_bf16_f32 v33, v66, v67
    v_exp_f32 v36, v68
    v_exp_f32 v37, v69
    v_exp_f32 v38, v70
    v_exp_f32 v39, v71
    s_waitcnt lgkmcnt(2)
    v_mfma_f32_32x32x16_bf16 v[56:71], v[12:15], v[4:7], 0
    v_cvt_pk_bf16_f32 v34, v36, v37
    v_cvt_pk_bf16_f32 v35, v38, v39
    v_exp_f32 v40, v40
    v_exp_f32 v41, v41
    v_exp_f32 v42, v42
    v_exp_f32 v43, v43
    v_mfma_f32_32x32x16_bf16 v[56:71], v[16:19], v[8:11], v[56:71]
    s_setprio 0
    ds_read_b128 v[12:15], v88 offset:43008
    ds_read_b64 v[16:17], v89 offset:43008
    v_cvt_pk_bf16_f32 v28, v40, v41
    v_cvt_pk_bf16_f32 v29, v42, v43
    v_exp_f32 v44, v44
    v_exp_f32 v45, v45
    v_exp_f32 v46, v46
    v_exp_f32 v47, v47
    s_waitcnt lgkmcnt(3)
    v_mfma_f32_32x32x16_bf16 v[72:87], v[24:27], v[32:35], v[72:87]
    ds_read_b128 v[24:27], v90 offset:37760
    v_cvt_pk_bf16_f32 v30, v44, v45
    v_cvt_pk_bf16_f32 v31, v46, v47
    v_exp_f32 v48, v48
    v_exp_f32 v49, v49
    v_exp_f32 v50, v50
    v_exp_f32 v51, v51
    s_waitcnt lgkmcnt(3)
    v_mfma_f32_32x32x16_bf16 v[72:87], v[20:23], v[28:31], v[72:87]
    ds_read_b128 v[20:23], v90 offset:39936
    v_cvt_pk_bf16_f32 v32, v48, v49
    v_cvt_pk_bf16_f32 v33, v50, v51
    v_exp_f32 v36, v52
    v_exp_f32 v37, v53
    v_exp_f32 v38, v54
    v_exp_f32 v39, v55
    s_waitcnt lgkmcnt(2)
    v_mfma_f32_32x32x16_bf16 v[40:55], v[12:15], v[4:7], 0
    v_cvt_pk_bf16_f32 v34, v36, v37
    v_cvt_pk_bf16_f32 v35, v38, v39
    v_exp_f32 v56, v56
    v_exp_f32 v57, v57
    v_exp_f32 v58, v58
    v_exp_f32 v59, v59
    v_mfma_f32_32x32x16_bf16 v[40:55], v[16:19], v[8:11], v[40:55]
    ds_read_b128 v[12:15], v88 offset:46080
    ds_read_b64 v[16:17], v89 offset:46080
    v_cvt_pk_bf16_f32 v28, v56, v57
    v_cvt_pk_bf16_f32 v29, v58, v59
    v_exp_f32 v60, v60
    v_exp_f32 v61, v61
    v_exp_f32 v62, v62
    v_exp_f32 v63, v63
    s_waitcnt lgkmcnt(3)
    v_mfma_f32_32x32x16_bf16 v[72:87], v[24:27], v[32:35], v[72:87]
    ds_read_b128 v[24:27], v90 offset:40832
    v_cvt_pk_bf16_f32 v30, v60, v61
    v_cvt_pk_bf16_f32 v31, v62, v63
    v_exp_f32 v64, v64
    v_exp_f32 v65, v65
    v_exp_f32 v66, v66
    v_exp_f32 v67, v67
    s_waitcnt lgkmcnt(3)
    v_mfma_f32_32x32x16_bf16 v[72:87], v[20:23], v[28:31], v[72:87]
    ds_read_b128 v[20:23], v90 offset:43008
    v_cvt_pk_bf16_f32 v32, v64, v65
    v_cvt_pk_bf16_f32 v33, v66, v67
    v_exp_f32 v36, v68
    v_exp_f32 v37, v69
    v_exp_f32 v38, v70
    v_exp_f32 v39, v71
    s_waitcnt lgkmcnt(2)
    v_mfma_f32_32x32x16_bf16 v[56:71], v[12:15], v[4:7], 0
    v_cvt_pk_bf16_f32 v34, v36, v37
    v_cvt_pk_bf16_f32 v35, v38, v39
    v_exp_f32 v40, v40
    v_exp_f32 v41, v41
    v_exp_f32 v42, v42
    v_exp_f32 v43, v43
    v_mfma_f32_32x32x16_bf16 v[56:71], v[16:19], v[8:11], v[56:71]
    s_barrier
    s_cmp_lt_u32 s40, 4
    s_cbranch_scc1 attn_p7
    s_setprio 1
attn_p7:
    s_mul_i32 s54, s40, 1536
    s_add_u32 m0, s54, 49152
    s_add_u32 s54, s54, s53
    s_add_u32 s54, s54, 90112
    s_bfm_b64 exec, 48, 0
    buffer_load_dwordx4 v97, s[28:31], s54 offen lds
    s_mov_b64 exec, -1
    ds_read_b128 v[12:15], v94 offset:0
    ds_read_b64 v[16:17], v95 offset:0
    v_cvt_pk_bf16_f32 v28, v40, v41
    v_cvt_pk_bf16_f32 v29, v42, v43
    v_exp_f32 v44, v44
    v_exp_f32 v45, v45
    v_exp_f32 v46, v46
    v_exp_f32 v47, v47
    s_waitcnt lgkmcnt(3)
    v_mfma_f32_32x32x16_bf16 v[72:87], v[24:27], v[32:35], v[72:87]
    ds_read_b128 v[24:27], v90 offset:43904
    v_cvt_pk_bf16_f32 v30, v44, v45
    v_cvt_pk_bf16_f32 v31, v46, v47
    v_exp_f32 v48, v48
    v_exp_f32 v49, v49
    v_exp_f32 v50, v50
    v_exp_f32 v51, v51
    s_waitcnt lgkmcnt(3)
    v_mfma_f32_32x32x16_bf16 v[72:87], v[20:23], v[28:31], v[72:87]
    s_mul_i32 s54, s40, 1536
    s_add_u32 m0, s54, 49920
    s_add_u32 s54, s54, s53
    s_add_u32 s54, s54, 90880
    s_bfm_b64 exec, 48, 0
    buffer_load_dwordx4 v97, s[28:31], s54 offen lds
    s_mov_b64 exec, -1
    ds_read_b128 v[20:23], v90 offset:46080
    v_cvt_pk_bf16_f32 v32, v48, v49
    v_cvt_pk_bf16_f32 v33, v50, v51
    v_exp_f32 v36, v52
    v_exp_f32 v37, v53
    v_exp_f32 v38, v54
    v_exp_f32 v39, v55
    s_waitcnt lgkmcnt(2)
    v_mfma_f32_32x32x16_bf16 v[40:55], v[12:15], v[4:7], 0
    v_cvt_pk_bf16_f32 v34, v36, v37
    v_cvt_pk_bf16_f32 v35, v38, v39
    v_exp_f32 v56, v56
    v_exp_f32 v57, v57
    v_exp_f32 v58, v58
    v_exp_f32 v59, v59
    v_mfma_f32_32x32x16_bf16 v[40:55], v[16:19], v[8:11], v[40:55]
    ds_read_b128 v[12:15], v94 offset:3072
    ds_read_b64 v[16:17], v95 offset:3072
    v_cvt_pk_bf16_f32 v28, v56, v57
    v_cvt_pk_bf16_f32 v29, v58, v59
    v_exp_f32 v60, v60
    v_exp_f32 v61, v61
    v_exp_f32 v62, v62
    v_exp_f32 v63, v63
    s_waitcnt lgkmcnt(3)
    v_mfma_f32_32x32x16_bf16 v[72:87], v[24:27], v[32:35], v[72:87]
    ds_read_b128 v[24:27], v90 offset:46976
    v_cvt_pk_bf16_f32 v30, v60, v61
    v_cvt_pk_bf16_f32 v31, v62, v63
    v_exp_f32 v64, v64
    v_exp_f32 v65, v65
    v_exp_f32 v66, v66
    v_exp_f32 v67, v67
    s_waitcnt lgkmcnt(3)
    v_mfma_f32_32x32x16_bf16 v[72:87], v[20:23], v[28:31], v[72:87]
    ds_read_b128 v[20:23], v96 offset:0
    v_cvt_pk_bf16_f32 v32, v64, v65
    v_cvt_pk_bf16_f32 v33, v66, v67
    v_exp_f32 v36, v68
    v_exp_f32 v37, v69
    v_exp_f32 v38, v70
    v_exp_f32 v39, v71
    v_cvt_pk_bf16_f32 v34, v36, v37
    v_cvt_pk_bf16_f32 v35, v38, v39
    s_waitcnt lgkmcnt(0)
    s_nop 0
    v_mfma_f32_32x32x16_bf16 v[72:87], v[24:27], v[32:35], v[72:87]
    s_mov_b32 s47, 0
attn_fin:
    s_nop 15
    v_mov_b32 v36, v80
    v_mov_b32 v37, v80
    s_nop 1
    v_permlane32_swap_b32 v36, v37
    v_rcp_f32 v38, v37
    v_max3_f32 v36, |v72|, |v73|, |v74|
    v_max3_f32 v36, |v75|, |v76|, v36
    v_max3_f32 v36, |v77|, |v78|, v36
    v_max3_f32 v36, |v79|, |v80|, v36
    v_max3_f32 v36, |v81|, |v82|, v36
    v_max_f32 v36, |v83|, v36
    s_cmp_lg_u32 s47, 0
    s_cbranch_scc1 attn_store
    v_mov_b32 v39, 0x21800000
    v_cmp_ge_f32 s[48:49], v37, v39
    v_mov_b32 v39, 0x5d800000
    v_cmp_le_f32 s[50:51], v37, v39
    v_mov_b32 v39, 0x7b800000
    v_cmp_le_f32 s[52:53], v36, v39
    v_cmp_o_f32 s[54:55], v72, v73
    v_cmp_o_f32 s[56:57], v74, v75
    v_cmp_o_f32 s[58:59], v76, v77
    v_cmp_o_f32 s[60:61], v78, v79
    v_cmp_o_f32 s[62:63], v80, v81
    v_cmp_o_f32 s[64:65], v82, v83
    s_and_b64 s[48:49], s[48:49], s[50:51]
    s_and_b64 s[48:49], s[48:49], s[52:53]
    s_and_b64 s[48:49], s[48:49], s[54:55]
    s_and_b64 s[48:49], s[48:49], s[56:57]
    s_and_b64 s[48:49], s[48:49], s[58:59]
    s_and_b64 s[48:49], s[48:49], s[60:61]
    s_and_b64 s[48:49], s[48:49], s[62:63]
    s_and_b64 s[48:49], s[48:49], s[64:65]
    s_not_b64 s[48:49], s[48:49]
    s_cbranch_scc1 attn_slow
attn_store:
    s_waitcnt vmcnt(0)
    v_cmp_eq_u32 vcc, 0, v102
    s_nop 1
    s_cmp_eq_u32 vcc_lo, 0
    s_cbranch_scc1 attn_xok
    s_mov_b32 s95, 0x100000
pl_1:
    buffer_load_dword v102, v101, s[24:27], s33 offen sc1
    s_sub_u32 s95, s95, 1
    s_cbranch_scc1 attn_xok
    s_waitcnt vmcnt(0)
    v_cmp_eq_u32 vcc, 0, v102
    s_nop 1
    s_cmp_lg_u64 vcc, 0
    s_cbranch_scc1 pl_1
attn_xok:
    s_waitcnt vmcnt(0)
    v_readfirstlane_b32 s65, v102
    s_nop 1
    v_cmp_ne_u32 vcc, s65, v102
    s_nop 1
    s_cmp_lg_u32 vcc_lo, 0
    s_cselect_b32 s65, 1, 0
    v_mul_f32 v72, v72, v38
    v_mul_f32 v73, v73, v38
    v_mul_f32 v74, v74, v38
    v_mul_f32 v75, v75, v38
    v_mul_f32 v76, v76, v38
    v_mul_f32 v77, v77, v38
    v_mul_f32 v78, v78, v38
    v_mul_f32 v79, v79, v38
    v_mul_f32 v80, v80, v38
    v_mul_f32 v81, v81, v38
    v_mul_f32 v82, v82, v38
    v_mul_f32 v83, v83, v38
    v_cvt_pk_bf16_f32 v72, v72, v73
    v_cvt_pk_bf16_f32 v73, v74, v75
    v_cvt_pk_bf16_f32 v74, v76, v77
    v_cvt_pk_bf16_f32 v75, v78, v79
    v_cvt_pk_bf16_f32 v76, v80, v81
    v_cvt_pk_bf16_f32 v77, v82, v83
    v_mul_u32_u24 v1, 5, v2
    s_lshl_b32 s44, s40, 4
    s_add_u32 s44, s44, 98304
    v_add3_u32 v36, v1, v3, 0
    v_lshrrev_b32 v37, 3, v36
    v_and_b32 v38, 3, v36
    v_lshl_add_u32 v37, v37, 2, v38
    v_mul_u32_u24 v37, 144, v37
    v_bfe_u32 v36, v36, 2, 1
    v_lshl_add_u32 v37, v36, 3, v37
    v_add_u32 v37, s44, v37
    ds_write_b64 v37, v[72:73]
    v_add3_u32 v36, v1, v3, 2
    v_lshrrev_b32 v37, 3, v36
    v_and_b32 v38, 3, v36
    v_lshl_add_u32 v37, v37, 2, v38
    v_mul_u32_u24 v37, 144, v37
    v_bfe_u32 v36, v36, 2, 1
    v_lshl_add_u32 v37, v36, 3, v37
    v_add_u32 v37, s44, v37
    ds_write_b64 v37, v[74:75]
    v_add_u32 v36, 4, v1
    v_lshrrev_b32 v37, 3, v36
    v_and_b32 v38, 3, v36
    v_lshl_add_u32 v37, v37, 2, v38
    v_mul_u32_u24 v37, 144, v37
    v_bfe_u32 v36, v36, 2, 1
    v_lshl_add_u32 v37, v36, 3, v37
    v_add_u32 v37, s44, v37
    s_mov_b64 exec, 0xffffffff
    ds_write_b64 v37, v[76:77]
    s_mov_b64 exec, -1
    v_lshrrev_b32 v1, 3, v0
    s_lshl_b32 s44, s40, 3
    v_add_u32 v1, s44, v1
    v_and_b32 v2, 7, v0
    v_lshlrev_b32 v2, 4, v2
    v_mul_u32_u24 v36, 144, v1
    v_add_u32 v36, v36, v2
    v_add_u32 v36, 98304, v36
    v_lshl_add_u32 v37, v1, 8, v2
    s_lshr_b32 s44, s34, 4
    s_mul_i32 s44, s44, 20480
    s_and_b32 s45, s34, 8
    s_lshl_b32 s45, s45, 4
    s_add_u32 s44, s44, s45
    s_setprio 0
    s_waitcnt vmcnt(0) lgkmcnt(0)
    s_barrier
    ds_read_b128 v[72:75], v36
    s_cmp_ge_u32 s40, 2
    s_cbranch_scc1 attn_st1
    ds_read_b128 v[76:79], v36 offset:9216
    s_add_u32 s45, s44, 16384
    s_waitcnt lgkmcnt(0)
    buffer_store_dwordx4 v[76:79], v37, s[16:19], s45 offen
attn_st1:
    s_waitcnt lgkmcnt(0)
    buffer_store_dwordx4 v[72:75], v37, s[16:19], s44 offen
    s_lshr_b32 s44, s34, 4
    s_and_b32 s45, s34, 15
    s_lshl_b32 s48, s44, 7
    s_add_u32 s48, s48, s68
    s_lshl2_add_u32 s48, s45, s48
    v_mov_b32 v36, 1
    v_mov_b32 v37, 0
    s_mov_b64 exec, 1
    s_cmp_eq_u32 s65, 0
    s_cbranch_scc1 sg_2
    s_waitcnt vmcnt(0)
    buffer_wbl2 sc1
    s_waitcnt vmcnt(0)
    buffer_store_dword v36, v37, s[24:27], s48 offen sc1
    s_branch sd_3
sg_2:
    s_waitcnt vmcnt(0)
    buffer_store_dword v36, v37, s[24:27], s48 offen
sd_3:
    s_mov_b64 exec, -1
    s_barrier
    s_branch f_oproj
attn_slow:
    v_mov_b32 v88, 0xff800000
    s_mov_b32 s44, 0
attn_s1:
    buffer_load_dwordx4 v[12:15], v94, s[8:11], s44 offen
    buffer_load_dwordx2 v[16:17], v95, s[8:11], s44 offen
    s_waitcnt vmcnt(0)
    v_mfma_f32_32x32x16_bf16 v[40:55], v[12:15], v[4:7], 0
    v_mfma_f32_32x32x16_bf16 v[40:55], v[16:19], v[8:11], v[40:55]
    s_nop 11
    v_max3_f32 v88, v40, v41, v88
    v_max3_f32 v88, v42, v43, v88
    v_max3_f32 v88, v44, v45, v88
    v_max3_f32 v88, v46, v47, v88
    v_max3_f32 v88, v48, v49, v88
    v_max3_f32 v88, v50, v51, v88
    v_max3_f32 v88, v52, v53, v88
    v_max3_f32 v88, v54, v55, v88
    s_add_u32 s44, s44, 3072
    s_cmp_lt_u32 s44, 196608
    s_cbranch_scc1 attn_s1
    v_mov_b32 v36, v88
    s_nop 1
    v_permlane32_swap_b32 v88, v36
    v_max_f32 v88, v88, v36
    v_mov_b32 v72, 0
    v_mov_b32 v73, 0
    v_mov_b32 v74, 0
    v_mov_b32 v75, 0
    v_mov_b32 v76, 0
    v_mov_b32 v77, 0
    v_mov_b32 v78, 0
    v_mov_b32 v79, 0
    v_mov_b32 v80, 0
    v_mov_b32 v81, 0
    v_mov_b32 v82, 0
    v_mov_b32 v83, 0
    v_mov_b32 v84, 0
    v_mov_b32 v85, 0
    v_mov_b32 v86, 0
    v_mov_b32 v87, 0
    s_mov_b32 s44, 0
attn_s2:
    buffer_load_dwordx4 v[12:15], v94, s[8:11], s44 offen
    buffer_load_dwordx2 v[16:17], v95, s[8:11], s44 offen
    buffer_load_dwordx4 v[20:23], v96, s[8:11], s44 offen
    buffer_load_dwordx4 v[24:27], v96, s[8:11], s44 offen offset:896
    s_waitcnt vmcnt(0)
    v_mfma_f32_32x32x16_bf16 v[40:55], v[12:15], v[4:7], 0
    v_mfma_f32_32x32x16_bf16 v[40:55], v[16:19], v[8:11], v[40:55]
    s_nop 11
    v_sub_f32 v40, v40, v88
    v_sub_f32 v41, v41, v88
    v_sub_f32 v42, v42, v88
    v_sub_f32 v43, v43, v88
    v_sub_f32 v44, v44, v88
    v_sub_f32 v45, v45, v88
    v_sub_f32 v46, v46, v88
    v_sub_f32 v47, v47, v88
    v_sub_f32 v48, v48, v88
    v_sub_f32 v49, v49, v88
    v_sub_f32 v50, v50, v88
    v_sub_f32 v51, v51, v88
    v_sub_f32 v52, v52, v88
    v_sub_f32 v53, v53, v88
    v_sub_f32 v54, v54, v88
    v_sub_f32 v55, v55, v88
    v_exp_f32 v40, v40
    v_exp_f32 v41, v41
    v_exp_f32 v42, v42
    v_exp_f32 v43, v43
    v_exp_f32 v44, v44
    v_exp_f32 v45, v45
    v_exp_f32 v46, v46
    v_exp_f32 v47, v47
    v_exp_f32 v48, v48
    v_exp_f32 v49, v49
    v_exp_f32 v50, v50
    v_exp_f32 v51, v51
    v_exp_f32 v52, v52
    v_exp_f32 v53, v53
    v_exp_f32 v54, v54
    v_exp_f32 v55, v55
    v_cvt_pk_bf16_f32 v28, v40, v41
    v_cvt_pk_bf16_f32 v29, v42, v43
    v_cvt_pk_bf16_f32 v30, v44, v45
    v_cvt_pk_bf16_f32 v31, v46, v47
    v_cvt_pk_bf16_f32 v32, v48, v49
    v_cvt_pk_bf16_f32 v33, v50, v51
    v_cvt_pk_bf16_f32 v34, v52, v53
    v_cvt_pk_bf16_f32 v35, v54, v55
    v_mfma_f32_32x32x16_bf16 v[72:87], v[20:23], v[28:31], v[72:87]
    s_nop 0
    v_mfma_f32_32x32x16_bf16 v[72:87], v[24:27], v[32:35], v[72:87]
    s_nop 15
    s_add_u32 s44, s44, 3072
    s_cmp_lt_u32 s44, 196608
    s_cbranch_scc1 attn_s2
    s_mov_b32 s47, 1
    s_branch attn_fin
f_oproj:
    s_and_b32 s34, s2, 7
    s_lshr_b32 s35, s2, 3
    s_lshl_b32 s34, s34, 2
    s_lshr_b32 s33, s35, 3
    s_add_u32 s34, s34, s33
    s_lshl_b32 s32, s34, 6
    s_and_b32 s33, s35, 7
    s_add_u32 s8, s36, 0x1380000
    s_addc_u32 s9, s37, 0
    s_mov_b32 s10, 0x740000
    s_mov_b32 s11, 0x20000
    s_cmp_ge_u32 s40, 4
    s_cbranch_scc1 f_loader
    s_setprio 2
    s_add_u32 s4, s36, 0x300000
    s_addc_u32 s5, s37, 0
    s_mov_b32 s6, 0x280000
    s_mov_b32 s7, 0x20000
    s_add_u32 s16, s36, 0x580000
    s_addc_u32 s17, s37, 0
    s_mov_b32 s18, 0x280000
    s_mov_b32 s19, 0x20000
    v_lshlrev_b32 v4, 4, v0
    s_and_b32 s46, s40, 1
    s_lshr_b32 s57, s40, 1
    s_lshr_b32 s42, s32, 4
    s_lshl1_add_u32 s42, s46, s42
    s_mov_b32 s59, s42
    s_add_u32 s42, s42, s57
    s_xor_b32 s58, s42, 1
    s_mul_i32 s43, s42, 20480
    s_mul_i32 s58, s58, 20480
    s_lshl_b32 s46, s57, 10
    s_add_u32 s43, s43, s46
    s_add_u32 s58, s58, s46
    v_and_b32 v2, 15, v0
    v_lshrrev_b32 v3, 4, v0
    s_lshl_b32 s46, s42, 4
    v_add_u32 v5, s46, v2
    s_mul_i32 s45, s33, 5
    s_mul_i32 s47, s42, 20480
    s_add_u32 s48, s45, 0
    s_lshr_b32 s52, s48, 1
    s_lshl_b32 s52, s52, 10
    s_and_b32 s48, s48, 1
    s_lshl_b32 s48, s48, 3
    s_add_u32 s52, s52, s48
    s_add_u32 s52, s52, s47
    s_add_u32 s48, s45, 1
    s_lshr_b32 s53, s48, 1
    s_lshl_b32 s53, s53, 10
    s_and_b32 s48, s48, 1
    s_lshl_b32 s48, s48, 3
    s_add_u32 s53, s53, s48
    s_add_u32 s53, s53, s47
    s_add_u32 s48, s45, 2
    s_lshr_b32 s54, s48, 1
    s_lshl_b32 s54, s54, 10
    s_and_b32 s48, s48, 1
    s_lshl_b32 s48, s48, 3
    s_add_u32 s54, s54, s48
    s_add_u32 s54, s54, s47
    s_add_u32 s48, s45, 3
    s_lshr_b32 s55, s48, 1
    s_lshl_b32 s55, s55, 10
    s_and_b32 s48, s48, 1
    s_lshl_b32 s48, s48, 3
    s_add_u32 s55, s55, s48
    s_add_u32 s55, s55, s47
    s_add_u32 s48, s45, 4
    s_lshr_b32 s56, s48, 1
    s_lshl_b32 s56, s56, 10
    s_and_b32 s48, s48, 1
    s_lshl_b32 s48, s48, 3
    s_add_u32 s56, s56, s48
    s_add_u32 s56, s56, s47
    s_bitcmp1_b32 s33, 0
    s_cbranch_scc1 po_4
    buffer_load_dwordx4 v[136:139], v4, s[20:23], s52 offen sc1
    buffer_load_dwordx4 v[140:143], v4, s[20:23], s54 offen sc1
    buffer_load_dwordx2 v[144:145], v4, s[20:23], s56 offen sc1
    s_branch pz_5
po_4:
    buffer_load_dwordx2 v[136:137], v4, s[20:23], s52 offen sc1
    buffer_load_dwordx4 v[138:141], v4, s[20:23], s53 offen sc1
    buffer_load_dwordx4 v[142:145], v4, s[20:23], s55 offen sc1
pz_5:
    s_lshl_b32 s48, s59, 7
    s_add_u32 s48, s48, s68
    v_and_b32 v6, 15, v0
    v_lshlrev_b32 v6, 2, v6
    v_and_b32 v7, 32, v0
    v_lshl_add_u32 v6, v7, 2, v6
    s_cmp_eq_u32 s65, 0
    s_cbranch_scc1 pf_7
    s_mov_b32 s95, 0x100000
pl_9:
    buffer_load_dword v7, v6, s[24:27], s48 offen sc1
    s_sub_u32 s95, s95, 1
    s_cbranch_scc1 pe_8
    s_waitcnt vmcnt(0)
    v_cmp_eq_u32 vcc, 0, v7
    s_nop 1
    s_cmp_lg_u64 vcc, 0
    s_cbranch_scc1 pl_9
pe_8:
    buffer_inv sc1
    s_branch pd_6
pf_7:
    s_mov_b32 s95, 0x100000
pl_10:
    buffer_load_dword v7, v6, s[24:27], s48 offen sc1
    s_sub_u32 s95, s95, 1
    s_cbranch_scc1 pd_6
    s_waitcnt vmcnt(0)
    v_cmp_eq_u32 vcc, 0, v7
    s_nop 1
    s_cmp_lg_u64 vcc, 0
    s_cbranch_scc1 pl_10
pd_6:
    buffer_load_dwordx4 v[96:99], v4, s[4:7], s43 offen offset:0 sc1
    buffer_load_dwordx4 v[100:103], v4, s[4:7], s58 offen offset:0 sc1
    buffer_load_dwordx4 v[104:107], v4, s[4:7], s43 offen offset:2048 sc1
    buffer_load_dwordx4 v[108:111], v4, s[4:7], s58 offen offset:2048 sc1
    s_add_u32 s43, s43, 4096
    s_add_u32 s58, s58, 4096
    buffer_load_dwordx4 v[112:115], v4, s[4:7], s43 offen offset:0 sc1
    buffer_load_dwordx4 v[116:119], v4, s[4:7], s58 offen offset:0 sc1
    buffer_load_dwordx4 v[120:123], v4, s[4:7], s43 offen offset:2048 sc1
    buffer_load_dwordx4 v[124:127], v4, s[4:7], s58 offen offset:2048 sc1
    s_add_u32 s43, s43, 4096
    s_add_u32 s58, s58, 4096
    buffer_load_dwordx4 v[128:131], v4, s[4:7], s43 offen offset:0 sc1
    buffer_load_dwordx4 v[132:135], v4, s[4:7], s58 offen offset:0 sc1
    s_mul_i32 s47, s57, 5120
    s_lshl_b32 s48, s57, 10
    v_add_u32 v146, s47, v4
    s_add_u32 s47, s47, 61440
    v_add_u32 v147, s47, v4
    s_add_u32 s47, s47, 61440
    v_add_u32 v148, s47, v4
    s_add_u32 s47, s47, 61440
    ds_read_b128 v[56:59], v148 offset:0
    ds_read_b128 v[60:63], v148 offset:1024
    ds_read_b128 v[64:67], v148 offset:2048
    ds_read_b128 v[68:71], v148 offset:3072
    ds_read_b128 v[72:75], v148 offset:4096
    s_waitcnt lgkmcnt(0)
    ds_read_b128 v[76:79], v148 offset:10240
    ds_read_b128 v[80:83], v148 offset:11264
    s_waitcnt vmcnt(8)
    v_mfma_f32_16x16x32_bf16 v[32:35], v[56:59], v[100:103], 0
    ds_read_b128 v[84:87], v148 offset:12288
    v_mfma_f32_16x16x32_bf16 v[8:11], v[56:59], v[96:99], 0
    ds_read_b128 v[88:91], v148 offset:13312
    v_mfma_f32_16x16x32_bf16 v[36:39], v[60:63], v[100:103], 0
    ds_read_b128 v[92:95], v148 offset:14336
    v_mfma_f32_16x16x32_bf16 v[12:15], v[60:63], v[96:99], 0
    v_mfma_f32_16x16x32_bf16 v[40:43], v[64:67], v[100:103], 0
    v_mfma_f32_16x16x32_bf16 v[16:19], v[64:67], v[96:99], 0
    v_mfma_f32_16x16x32_bf16 v[44:47], v[68:71], v[100:103], 0
    v_mfma_f32_16x16x32_bf16 v[20:23], v[68:71], v[96:99], 0
    v_mfma_f32_16x16x32_bf16 v[48:51], v[72:75], v[100:103], 0
    v_mfma_f32_16x16x32_bf16 v[24:27], v[72:75], v[96:99], 0
    s_waitcnt lgkmcnt(0)
    ds_read_b128 v[56:59], v148 offset:20480
    ds_read_b128 v[60:63], v148 offset:21504
    s_waitcnt vmcnt(6)
    v_mfma_f32_16x16x32_bf16 v[32:35], v[76:79], v[108:111], v[32:35]
    ds_read_b128 v[64:67], v148 offset:22528
    v_mfma_f32_16x16x32_bf16 v[8:11], v[76:79], v[104:107], v[8:11]
    ds_read_b128 v[68:71], v148 offset:23552
    v_mfma_f32_16x16x32_bf16 v[36:39], v[80:83], v[108:111], v[36:39]
    ds_read_b128 v[72:75], v148 offset:24576
    v_mfma_f32_16x16x32_bf16 v[12:15], v[80:83], v[104:107], v[12:15]
    buffer_load_dwordx4 v[96:99], v4, s[4:7], s43 offen offset:2048 sc1
    v_mfma_f32_16x16x32_bf16 v[40:43], v[84:87], v[108:111], v[40:43]
    v_mfma_f32_16x16x32_bf16 v[16:19], v[84:87], v[104:107], v[16:19]
    v_mfma_f32_16x16x32_bf16 v[44:47], v[88:91], v[108:111], v[44:47]
    v_mfma_f32_16x16x32_bf16 v[20:23], v[88:91], v[104:107], v[20:23]
    buffer_load_dwordx4 v[100:103], v4, s[4:7], s58 offen offset:2048 sc1
    v_mfma_f32_16x16x32_bf16 v[48:51], v[92:95], v[108:111], v[48:51]
    v_mfma_f32_16x16x32_bf16 v[24:27], v[92:95], v[104:107], v[24:27]
    s_waitcnt lgkmcnt(0)
    ds_read_b128 v[76:79], v148 offset:30720
    ds_read_b128 v[80:83], v148 offset:31744
    s_waitcnt vmcnt(6)
    v_mfma_f32_16x16x32_bf16 v[32:35], v[56:59], v[116:119], v[32:35]
    ds_read_b128 v[84:87], v148 offset:32768
    v_mfma_f32_16x16x32_bf16 v[8:11], v[56:59], v[112:115], v[8:11]
    ds_read_b128 v[88:91], v148 offset:33792
    v_mfma_f32_16x16x32_bf16 v[36:39], v[60:63], v[116:119], v[36:39]
    ds_read_b128 v[92:95], v148 offset:34816
    v_mfma_f32_16x16x32_bf16 v[12:15], v[60:63], v[112:115], v[12:15]
    s_add_u32 s43, s43, 4096
    s_add_u32 s58, s58, 4096
    buffer_load_dwordx4 v[104:107], v4, s[4:7], s43 offen offset:0 sc1
    v_mfma_f32_16x16x32_bf16 v[40:43], v[64:67], v[116:119], v[40:43]
    v_mfma_f32_16x16x32_bf16 v[16:19], v[64:67], v[112:115], v[16:19]
    v_mfma_f32_16x16x32_bf16 v[44:47], v[68:71], v[116:119], v[44:47]
    v_mfma_f32_16x16x32_bf16 v[20:23], v[68:71], v[112:115], v[20:23]
    buffer_load_dwordx4 v[108:111], v4, s[4:7], s58 offen offset:0 sc1
    v_mfma_f32_16x16x32_bf16 v[48:51], v[72:75], v[116:119], v[48:51]
    v_mfma_f32_16x16x32_bf16 v[24:27], v[72:75], v[112:115], v[24:27]
    s_waitcnt lgkmcnt(0)
    ds_read_b128 v[56:59], v146 offset:0
    ds_read_b128 v[60:63], v146 offset:1024
    s_waitcnt vmcnt(6)
    v_mfma_f32_16x16x32_bf16 v[32:35], v[76:79], v[124:127], v[32:35]
    ds_read_b128 v[64:67], v146 offset:2048
    v_mfma_f32_16x16x32_bf16 v[8:11], v[76:79], v[120:123], v[8:11]
    ds_read_b128 v[68:71], v146 offset:3072
    v_mfma_f32_16x16x32_bf16 v[36:39], v[80:83], v[124:127], v[36:39]
    ds_read_b128 v[72:75], v146 offset:4096
    v_mfma_f32_16x16x32_bf16 v[12:15], v[80:83], v[120:123], v[12:15]
    buffer_load_dwordx4 v[112:115], v4, s[4:7], s43 offen offset:2048 sc1
    v_mfma_f32_16x16x32_bf16 v[40:43], v[84:87], v[124:127], v[40:43]
    v_mfma_f32_16x16x32_bf16 v[16:19], v[84:87], v[120:123], v[16:19]
    v_mfma_f32_16x16x32_bf16 v[44:47], v[88:91], v[124:127], v[44:47]
    v_mfma_f32_16x16x32_bf16 v[20:23], v[88:91], v[120:123], v[20:23]
    buffer_load_dwordx4 v[116:119], v4, s[4:7], s58 offen offset:2048 sc1
    v_mfma_f32_16x16x32_bf16 v[48:51], v[92:95], v[124:127], v[48:51]
    v_mfma_f32_16x16x32_bf16 v[24:27], v[92:95], v[120:123], v[24:27]
    s_waitcnt lgkmcnt(0)
    s_barrier
    ds_read_b128 v[76:79], v146 offset:10240
    ds_read_b128 v[80:83], v146 offset:11264
    s_waitcnt vmcnt(6)
    v_mfma_f32_16x16x32_bf16 v[32:35], v[56:59], v[132:135], v[32:35]
    ds_read_b128 v[84:87], v146 offset:12288
    v_mfma_f32_16x16x32_bf16 v[8:11], v[56:59], v[128:131], v[8:11]
    ds_read_b128 v[88:91], v146 offset:13312
    v_mfma_f32_16x16x32_bf16 v[36:39], v[60:63], v[132:135], v[36:39]
    ds_read_b128 v[92:95], v146 offset:14336
    v_mfma_f32_16x16x32_bf16 v[12:15], v[60:63], v[128:131], v[12:15]
    s_add_u32 s43, s43, 4096
    s_add_u32 s58, s58, 4096
    buffer_load_dwordx4 v[120:123], v4, s[4:7], s43 offen offset:0 sc1
    v_mfma_f32_16x16x32_bf16 v[40:43], v[64:67], v[132:135], v[40:43]
    v_mfma_f32_16x16x32_bf16 v[16:19], v[64:67], v[128:131], v[16:19]
    v_mfma_f32_16x16x32_bf16 v[44:47], v[68:71], v[132:135], v[44:47]
    v_mfma_f32_16x16x32_bf16 v[20:23], v[68:71], v[128:131], v[20:23]
    buffer_load_dwordx4 v[124:127], v4, s[4:7], s58 offen offset:0 sc1
    v_mfma_f32_16x16x32_bf16 v[48:51], v[72:75], v[132:135], v[48:51]
    v_mfma_f32_16x16x32_bf16 v[24:27], v[72:75], v[128:131], v[24:27]
    s_waitcnt lgkmcnt(0)
    ds_read_b128 v[56:59], v146 offset:20480
    ds_read_b128 v[60:63], v146 offset:21504
    s_waitcnt vmcnt(6)
    v_mfma_f32_16x16x32_bf16 v[32:35], v[76:79], v[100:103], v[32:35]
    ds_read_b128 v[64:67], v146 offset:22528
    v_mfma_f32_16x16x32_bf16 v[8:11], v[76:79], v[96:99], v[8:11]
    ds_read_b128 v[68:71], v146 offset:23552
    v_mfma_f32_16x16x32_bf16 v[36:39], v[80:83], v[100:103], v[36:39]
    ds_read_b128 v[72:75], v146 offset:24576
    v_mfma_f32_16x16x32_bf16 v[12:15], v[80:83], v[96:99], v[12:15]
    buffer_load_dwordx4 v[128:131], v4, s[4:7], s43 offen offset:2048 sc1
    v_mfma_f32_16x16x32_bf16 v[40:43], v[84:87], v[100:103], v[40:43]
    v_mfma_f32_16x16x32_bf16 v[16:19], v[84:87], v[96:99], v[16:19]
    v_mfma_f32_16x16x32_bf16 v[44:47], v[88:91], v[100:103], v[44:47]
    v_mfma_f32_16x16x32_bf16 v[20:23], v[88:91], v[96:99], v[20:23]
    buffer_load_dwordx4 v[132:135], v4, s[4:7], s58 offen offset:2048 sc1
    v_mfma_f32_16x16x32_bf16 v[48:51], v[92:95], v[100:103], v[48:51]
    v_mfma_f32_16x16x32_bf16 v[24:27], v[92:95], v[96:99], v[24:27]
    s_waitcnt lgkmcnt(0)
    ds_read_b128 v[76:79], v146 offset:30720
    ds_read_b128 v[80:83], v146 offset:31744
    s_waitcnt vmcnt(6)
    v_mfma_f32_16x16x32_bf16 v[32:35], v[56:59], v[108:111], v[32:35]
    ds_read_b128 v[84:87], v146 offset:32768
    v_mfma_f32_16x16x32_bf16 v[8:11], v[56:59], v[104:107], v[8:11]
    ds_read_b128 v[88:91], v146 offset:33792
    v_mfma_f32_16x16x32_bf16 v[36:39], v[60:63], v[108:111], v[36:39]
    ds_read_b128 v[92:95], v146 offset:34816
    v_mfma_f32_16x16x32_bf16 v[12:15], v[60:63], v[104:107], v[12:15]
    v_mfma_f32_16x16x32_bf16 v[40:43], v[64:67], v[108:111], v[40:43]
    v_mfma_f32_16x16x32_bf16 v[16:19], v[64:67], v[104:107], v[16:19]
    v_mfma_f32_16x16x32_bf16 v[44:47], v[68:71], v[108:111], v[44:47]
    v_mfma_f32_16x16x32_bf16 v[20:23], v[68:71], v[104:107], v[20:23]
    v_mfma_f32_16x16x32_bf16 v[48:51], v[72:75], v[108:111], v[48:51]
    v_mfma_f32_16x16x32_bf16 v[24:27], v[72:75], v[104:107], v[24:27]
    s_waitcnt lgkmcnt(0)
    ds_read_b128 v[56:59], v146 offset:40960
    ds_read_b128 v[60:63], v146 offset:41984
    s_waitcnt vmcnt(4)
    v_mfma_f32_16x16x32_bf16 v[32:35], v[76:79], v[116:119], v[32:35]
    ds_read_b128 v[64:67], v146 offset:43008
    v_mfma_f32_16x16x32_bf16 v[8:11], v[76:79], v[112:115], v[8:11]
    ds_read_b128 v[68:71], v146 offset:44032
    v_mfma_f32_16x16x32_bf16 v[36:39], v[80:83], v[116:119], v[36:39]
    ds_read_b128 v[72:75], v146 offset:45056
    v_mfma_f32_16x16x32_bf16 v[12:15], v[80:83], v[112:115], v[12:15]
    v_mfma_f32_16x16x32_bf16 v[40:43], v[84:87], v[116:119], v[40:43]
    v_mfma_f32_16x16x32_bf16 v[16:19], v[84:87], v[112:115], v[16:19]
    v_mfma_f32_16x16x32_bf16 v[44:47], v[88:91], v[116:119], v[44:47]
    v_mfma_f32_16x16x32_bf16 v[20:23], v[88:91], v[112:115], v[20:23]
    v_mfma_f32_16x16x32_bf16 v[48:51], v[92:95], v[116:119], v[48:51]
    v_mfma_f32_16x16x32_bf16 v[24:27], v[92:95], v[112:115], v[24:27]
    s_waitcnt lgkmcnt(0)
    ds_read_b128 v[76:79], v146 offset:51200
    ds_read_b128 v[80:83], v146 offset:52224
    s_waitcnt vmcnt(2)
    v_mfma_f32_16x16x32_bf16 v[32:35], v[56:59], v[124:127], v[32:35]
    ds_read_b128 v[84:87], v146 offset:53248
    v_mfma_f32_16x16x32_bf16 v[8:11], v[56:59], v[120:123], v[8:11]
    ds_read_b128 v[88:91], v146 offset:54272
    v_mfma_f32_16x16x32_bf16 v[36:39], v[60:63], v[124:127], v[36:39]
    ds_read_b128 v[92:95], v146 offset:55296
    v_mfma_f32_16x16x32_bf16 v[12:15], v[60:63], v[120:123], v[12:15]
    v_mfma_f32_16x16x32_bf16 v[40:43], v[64:67], v[124:127], v[40:43]
    v_mfma_f32_16x16x32_bf16 v[16:19], v[64:67], v[120:123], v[16:19]
    v_mfma_f32_16x16x32_bf16 v[44:47], v[68:71], v[124:127], v[44:47]
    v_mfma_f32_16x16x32_bf16 v[20:23], v[68:71], v[120:123], v[20:23]
    v_mfma_f32_16x16x32_bf16 v[48:51], v[72:75], v[124:127], v[48:51]
    v_mfma_f32_16x16x32_bf16 v[24:27], v[72:75], v[120:123], v[24:27]
    s_waitcnt lgkmcnt(0)
    s_waitcnt vmcnt(0)
    v_mfma_f32_16x16x32_bf16 v[32:35], v[76:79], v[132:135], v[32:35]
    v_mfma_f32_16x16x32_bf16 v[36:39], v[80:83], v[132:135], v[36:39]
    v_mfma_f32_16x16x32_bf16 v[40:43], v[84:87], v[132:135], v[40:43]
    v_mfma_f32_16x16x32_bf16 v[44:47], v[88:91], v[132:135], v[44:47]
    v_mfma_f32_16x16x32_bf16 v[48:51], v[92:95], v[132:135], v[48:51]
    v_mfma_f32_16x16x32_bf16 v[8:11], v[76:79], v[128:131], v[8:11]
    v_mfma_f32_16x16x32_bf16 v[12:15], v[80:83], v[128:131], v[12:15]
    v_mfma_f32_16x16x32_bf16 v[16:19], v[84:87], v[128:131], v[16:19]
    v_mfma_f32_16x16x32_bf16 v[20:23], v[88:91], v[128:131], v[20:23]
    v_mfma_f32_16x16x32_bf16 v[24:27], v[92:95], v[128:131], v[24:27]
    s_mul_i32 s47, s40, 5120
    s_add_u32 s47, s47, 122880
    v_add_u32 v6, s47, v4
    s_xor_b32 s47, s40, 2
    s_mul_i32 s47, s47, 5120
    s_add_u32 s47, s47, 122880
    v_add_u32 v7, s47, v4
    ds_write_b128 v6, v[32:35] offset:0
    ds_write_b128 v6, v[36:39] offset:1024
    ds_write_b128 v6, v[40:43] offset:2048
    ds_write_b128 v6, v[44:47] offset:3072
    ds_write_b128 v6, v[48:51] offset:4096
    s_waitcnt lgkmcnt(0)
    s_barrier
    ds_read_b128 v[32:35], v7 offset:0
    ds_read_b128 v[36:39], v7 offset:1024
    ds_read_b128 v[40:43], v7 offset:2048
    ds_read_b128 v[44:47], v7 offset:3072
    ds_read_b128 v[48:51], v7 offset:4096
    s_waitcnt lgkmcnt(4)
    v_pk_add_f32 v[8:9], v[8:9], v[32:33]
    v_pk_add_f32 v[10:11], v[10:11], v[34:35]
    s_waitcnt lgkmcnt(3)
    v_pk_add_f32 v[12:13], v[12:13], v[36:37]
    v_pk_add_f32 v[14:15], v[14:15], v[38:39]
    s_waitcnt lgkmcnt(2)
    v_pk_add_f32 v[16:17], v[16:17], v[40:41]
    v_pk_add_f32 v[18:19], v[18:19], v[42:43]
    s_waitcnt lgkmcnt(1)
    v_pk_add_f32 v[20:21], v[20:21], v[44:45]
    v_pk_add_f32 v[22:23], v[22:23], v[46:47]
    s_waitcnt lgkmcnt(0)
    v_pk_add_f32 v[24:25], v[24:25], v[48:49]
    v_pk_add_f32 v[26:27], v[26:27], v[50:51]
    v_mov_b32 v56, 0
    v_mov_b32 v57, 0
    v_lshlrev_b32 v60, 16, v136
    v_and_b32 v61, 0xffff0000, v136
    v_lshlrev_b32 v62, 16, v137
    v_and_b32 v63, 0xffff0000, v137
    v_pk_add_f32 v[8:9], v[8:9], v[60:61]
    v_pk_add_f32 v[10:11], v[10:11], v[62:63]
    v_cvt_pk_bf16_f32 v136, v8, v9
    v_cvt_pk_bf16_f32 v137, v10, v11
    v_lshlrev_b32 v60, 16, v138
    v_and_b32 v61, 0xffff0000, v138
    v_lshlrev_b32 v62, 16, v139
    v_and_b32 v63, 0xffff0000, v139
    v_pk_add_f32 v[12:13], v[12:13], v[60:61]
    v_pk_add_f32 v[14:15], v[14:15], v[62:63]
    v_cvt_pk_bf16_f32 v138, v12, v13
    v_cvt_pk_bf16_f32 v139, v14, v15
    v_lshlrev_b32 v60, 16, v140
    v_and_b32 v61, 0xffff0000, v140
    v_lshlrev_b32 v62, 16, v141
    v_and_b32 v63, 0xffff0000, v141
    v_pk_add_f32 v[16:17], v[16:17], v[60:61]
    v_pk_add_f32 v[18:19], v[18:19], v[62:63]
    v_cvt_pk_bf16_f32 v140, v16, v17
    v_cvt_pk_bf16_f32 v141, v18, v19
    v_lshlrev_b32 v60, 16, v142
    v_and_b32 v61, 0xffff0000, v142
    v_lshlrev_b32 v62, 16, v143
    v_and_b32 v63, 0xffff0000, v143
    v_pk_add_f32 v[20:21], v[20:21], v[60:61]
    v_pk_add_f32 v[22:23], v[22:23], v[62:63]
    v_cvt_pk_bf16_f32 v142, v20, v21
    v_cvt_pk_bf16_f32 v143, v22, v23
    v_lshlrev_b32 v60, 16, v144
    v_and_b32 v61, 0xffff0000, v144
    v_lshlrev_b32 v62, 16, v145
    v_and_b32 v63, 0xffff0000, v145
    v_pk_add_f32 v[24:25], v[24:25], v[60:61]
    v_pk_add_f32 v[26:27], v[26:27], v[62:63]
    v_cvt_pk_bf16_f32 v144, v24, v25
    v_cvt_pk_bf16_f32 v145, v26, v27
    s_bitcmp1_b32 s33, 0
    s_cbranch_scc1 po_11
    buffer_store_dwordx4 v[136:139], v4, s[16:19], s52 offen
    buffer_store_dwordx4 v[140:143], v4, s[16:19], s54 offen
    buffer_store_dwordx2 v[144:145], v4, s[16:19], s56 offen
    s_branch pz_12
po_11:
    buffer_store_dwordx2 v[136:137], v4, s[16:19], s52 offen
    buffer_store_dwordx4 v[138:141], v4, s[16:19], s53 offen
    buffer_store_dwordx4 v[142:145], v4, s[16:19], s55 offen
pz_12:
    v_mov_b32 v60, 0x3f803f80
    v_dot2_f32_bf16 v56, v136, v60, v56
    v_dot2_f32_bf16 v57, v136, v136, v57
    v_dot2_f32_bf16 v58, v137, v60, 0
    v_dot2_f32_bf16 v59, v137, v137, 0
    v_dot2_f32_bf16 v56, v138, v60, v56
    v_dot2_f32_bf16 v57, v138, v138, v57
    v_dot2_f32_bf16 v58, v139, v60, v58
    v_dot2_f32_bf16 v59, v139, v139, v59
    v_dot2_f32_bf16 v56, v140, v60, v56
    v_dot2_f32_bf16 v57, v140, v140, v57
    v_dot2_f32_bf16 v58, v141, v60, v58
    v_dot2_f32_bf16 v59, v141, v141, v59
    v_dot2_f32_bf16 v56, v142, v60, v56
    v_dot2_f32_bf16 v57, v142, v142, v57
    v_dot2_f32_bf16 v58, v143, v60, v58
    v_dot2_f32_bf16 v59, v143, v143, v59
    v_dot2_f32_bf16 v56, v144, v60, v56
    v_dot2_f32_bf16 v57, v144, v144, v57
    v_dot2_f32_bf16 v58, v145, v60, v58
    v_dot2_f32_bf16 v59, v145, v145, v59
    s_nop 2
    v_pk_add_f32 v[56:57], v[56:57], v[58:59]
    v_mov_b32 v60, v56
    v_mov_b32 v61, v57
    s_nop 0
    v_permlane16_swap_b32 v56, v60
    v_permlane16_swap_b32 v57, v61
    v_pk_add_f32 v[56:57], v[56:57], v[60:61]
    v_mov_b32 v60, v56
    v_mov_b32 v61, v57
    s_nop 0
    v_permlane32_swap_b32 v56, v60
    v_permlane32_swap_b32 v57, v61
    v_pk_add_f32 v[56:57], v[56:57], v[60:61]
    v_lshlrev_b32 v6, 6, v5
    v_cmp_eq_u32 vcc, 0, v3
    v_mov_b32 v7, 0x7ff00000
    s_nop 0
    v_cndmask_b32 v6, v7, v6, vcc
    s_lshl_b32 s47, s33, 3
    s_add_u32 s47, s47, 131072
    buffer_store_dwordx2 v[56:57], v6, s[24:27], s47 offen
foproj_end:
    s_lshl_b32 s48, s42, 7
    s_add_u32 s48, s48, s68
    s_add_u32 s48, s48, 16384
    s_lshl2_add_u32 s48, s33, s48
    v_mov_b32 v8, 1
    v_mov_b32 v9, 0
    s_mov_b64 exec, 1
    s_cmp_eq_u32 s65, 0
    s_cbranch_scc1 sg_13
    s_waitcnt vmcnt(0)
    buffer_wbl2 sc1
    s_waitcnt vmcnt(0)
    buffer_store_dword v8, v9, s[24:27], s48 offen sc1
    s_branch sd_14
sg_13:
    s_waitcnt vmcnt(0)
    buffer_store_dword v8, v9, s[24:27], s48 offen
sd_14:
    s_mov_b64 exec, -1
    s_and_b32 s34, s2, 7
    s_lshr_b32 s35, s2, 3
    s_lshr_b32 s32, s35, 4
    s_lshl1_add_u32 s32, s34, s32
    s_and_b32 s33, s35, 15
    s_lshl_b32 s43, s32, 3
    s_lshl1_add_u32 s43, s40, s43
    v_and_b32 v2, 15, v0
    v_lshrrev_b32 v3, 4, v0
    v_lshlrev_b32 v1, 6, v2
    v_lshl_add_u32 v1, v3, 4, v1
    v_lshlrev_b32 v5, 4, v3
    s_add_u32 s16, s36, 0xa80000
    s_addc_u32 s17, s37, 0
    s_mov_b32 s18, 0x600000
    s_mov_b32 s19, 0x20000
    s_add_u32 s4, s36, 0x580000
    s_addc_u32 s5, s37, 0
    s_mov_b32 s6, 0x280000
    s_mov_b32 s7, 0x20000
    s_lshl_b32 s49, s43, 10
    s_add_u32 s49, s49, 131072
    v_pk_add_f32 v[208:209], v[208:209], v[160:161]
    v_pk_add_f32 v[210:211], v[210:211], v[162:163]
    v_pk_add_f32 v[212:213], v[212:213], v[164:165]
    v_pk_add_f32 v[214:215], v[214:215], v[166:167]
    v_pk_add_f32 v[216:217], v[216:217], v[168:169]
    v_pk_add_f32 v[218:219], v[218:219], v[170:171]
    v_pk_add_f32 v[220:221], v[220:221], v[172:173]
    v_pk_add_f32 v[222:223], v[222:223], v[174:175]
    v_pk_add_f32 v[224:225], v[224:225], v[176:177]
    v_pk_add_f32 v[226:227], v[226:227], v[178:179]
    v_pk_add_f32 v[228:229], v[228:229], v[180:181]
    v_pk_add_f32 v[230:231], v[230:231], v[182:183]
    v_pk_add_f32 v[232:233], v[232:233], v[184:185]
    v_pk_add_f32 v[234:235], v[234:235], v[186:187]
    v_pk_add_f32 v[236:237], v[236:237], v[188:189]
    v_pk_add_f32 v[238:239], v[238:239], v[190:191]
    v_pk_add_f32 v[240:241], v[240:241], v[192:193]
    v_pk_add_f32 v[242:243], v[242:243], v[194:195]
    v_pk_add_f32 v[244:245], v[244:245], v[196:197]
    v_pk_add_f32 v[246:247], v[246:247], v[198:199]
    v_pk_add_f32 v[248:249], v[248:249], v[200:201]
    v_pk_add_f32 v[250:251], v[250:251], v[202:203]
    v_pk_add_f32 v[252:253], v[252:253], v[204:205]
    v_pk_add_f32 v[254:255], v[254:255], v[206:207]
    v_add_u32 v2, 61440, v4
    v_add_u32 v3, 122880, v4
    s_mul_i32 s56, s43, 20480
    s_add_u32 s57, s56, 20480
    s_lshl_b32 s48, s43, 7
    s_add_u32 s48, s48, s68
    s_add_u32 s48, s48, 16384
    v_and_b32 v6, 7, v0
    v_lshlrev_b32 v6, 2, v6
    v_and_b32 v7, 8, v0
    v_lshl_add_u32 v6, v7, 4, v6
    s_barrier
    ds_read_b128 v[104:107], v2 offset:0
    ds_read_b128 v[108:111], v2 offset:1024
    ds_read_b128 v[112:115], v2 offset:2048
    ds_read_b128 v[116:119], v2 offset:3072
    ds_read_b128 v[120:123], v2 offset:4096
    ds_read_b128 v[124:127], v2 offset:5120
    s_cmp_eq_u32 s65, 0
    s_cbranch_scc1 pf_16
    s_mov_b32 s95, 0x100000
pl_18:
    buffer_load_dword v7, v6, s[24:27], s48 offen sc1
    s_sub_u32 s95, s95, 1
    s_cbranch_scc1 pe_17
    s_waitcnt vmcnt(0)
    v_cmp_eq_u32 vcc, 0, v7
    s_nop 1
    s_cmp_lg_u64 vcc, 0
    s_cbranch_scc1 pl_18
pe_17:
    buffer_inv sc1
    s_branch pd_15
pf_16:
    s_mov_b32 s95, 0x100000
pl_19:
    buffer_load_dword v7, v6, s[24:27], s48 offen sc1
    s_sub_u32 s95, s95, 1
    s_cbranch_scc1 pd_15
    s_waitcnt vmcnt(0)
    v_cmp_eq_u32 vcc, 0, v7
    s_nop 1
    s_cmp_lg_u64 vcc, 0
    s_cbranch_scc1 pl_19
pd_15:
    buffer_load_dwordx4 v[152:155], v4, s[4:7], s56 offen offset:0 sc1
    buffer_load_dwordx4 v[156:159], v4, s[4:7], s57 offen offset:0 sc1
    buffer_load_dwordx4 v[160:163], v4, s[4:7], s56 offen offset:1024 sc1
    buffer_load_dwordx4 v[164:167], v4, s[4:7], s57 offen offset:1024 sc1
    buffer_load_dwordx4 v[168:171], v4, s[4:7], s56 offen offset:2048 sc1
    buffer_load_dwordx4 v[172:175], v4, s[4:7], s57 offen offset:2048 sc1
    buffer_load_dwordx4 v[176:179], v4, s[4:7], s56 offen offset:3072 sc1
    buffer_load_dwordx4 v[180:183], v4, s[4:7], s57 offen offset:3072 sc1
    s_add_u32 s56, s56, 4096
    buffer_load_dwordx4 v[184:187], v4, s[4:7], s56 offen offset:0 sc1
    s_add_u32 s57, s57, 4096
    buffer_load_dwordx4 v[188:191], v4, s[4:7], s57 offen offset:0 sc1
    buffer_load_dwordx4 v[192:195], v4, s[4:7], s56 offen offset:1024 sc1
    buffer_load_dwordx4 v[196:199], v4, s[4:7], s57 offen offset:1024 sc1
    buffer_load_dwordx4 v[200:203], v1, s[24:27], s49 offen offset:0 sc1
    buffer_load_dwordx4 v[204:207], v1, s[24:27], s49 offen offset:1024 sc1
    s_waitcnt lgkmcnt(0)
    s_waitcnt vmcnt(12)
    v_mfma_f32_16x16x32_bf16 v[8:11], v[104:107], v[152:155], 0
    ds_read_b128 v[128:131], v2 offset:6144
    v_mfma_f32_16x16x32_bf16 v[16:19], v[104:107], v[156:159], 0
    ds_read_b128 v[132:135], v2 offset:7168
    v_mfma_f32_16x16x32_bf16 v[24:27], v[108:111], v[152:155], 0
    ds_read_b128 v[136:139], v2 offset:8192
    v_mfma_f32_16x16x32_bf16 v[32:35], v[108:111], v[156:159], 0
    ds_read_b128 v[140:143], v2 offset:9216
    v_mfma_f32_16x16x32_bf16 v[40:43], v[112:115], v[152:155], 0
    ds_read_b128 v[144:147], v2 offset:10240
    v_mfma_f32_16x16x32_bf16 v[48:51], v[112:115], v[156:159], 0
    ds_read_b128 v[148:151], v2 offset:11264
    v_mfma_f32_16x16x32_bf16 v[56:59], v[116:119], v[152:155], 0
    v_mfma_f32_16x16x32_bf16 v[64:67], v[116:119], v[156:159], 0
    v_mfma_f32_16x16x32_bf16 v[72:75], v[120:123], v[152:155], 0
    v_mfma_f32_16x16x32_bf16 v[80:83], v[120:123], v[156:159], 0
    v_mfma_f32_16x16x32_bf16 v[88:91], v[124:127], v[152:155], 0
    v_mfma_f32_16x16x32_bf16 v[96:99], v[124:127], v[156:159], 0
    s_waitcnt lgkmcnt(0)
    v_mfma_f32_16x16x32_bf16 v[12:15], v[128:131], v[152:155], 0
    ds_read_b128 v[104:107], v2 offset:12288
    v_mfma_f32_16x16x32_bf16 v[20:23], v[128:131], v[156:159], 0
    ds_read_b128 v[108:111], v2 offset:13312
    v_mfma_f32_16x16x32_bf16 v[28:31], v[132:135], v[152:155], 0
    ds_read_b128 v[112:115], v2 offset:14336
    v_mfma_f32_16x16x32_bf16 v[36:39], v[132:135], v[156:159], 0
    ds_read_b128 v[116:119], v2 offset:15360
    v_mfma_f32_16x16x32_bf16 v[44:47], v[136:139], v[152:155], 0
    ds_read_b128 v[120:123], v2 offset:16384
    v_mfma_f32_16x16x32_bf16 v[52:55], v[136:139], v[156:159], 0
    ds_read_b128 v[124:127], v2 offset:17408
    v_mfma_f32_16x16x32_bf16 v[60:63], v[140:143], v[152:155], 0
    v_mfma_f32_16x16x32_bf16 v[68:71], v[140:143], v[156:159], 0
    v_mfma_f32_16x16x32_bf16 v[76:79], v[144:147], v[152:155], 0
    v_mfma_f32_16x16x32_bf16 v[84:87], v[144:147], v[156:159], 0
    v_mfma_f32_16x16x32_bf16 v[92:95], v[148:151], v[152:155], 0
    v_mfma_f32_16x16x32_bf16 v[100:103], v[148:151], v[156:159], 0
    s_waitcnt lgkmcnt(0)
    s_waitcnt vmcnt(10)
    v_mfma_f32_16x16x32_bf16 v[8:11], v[104:107], v[160:163], v[8:11]
    ds_read_b128 v[128:131], v2 offset:18432
    v_mfma_f32_16x16x32_bf16 v[16:19], v[104:107], v[164:167], v[16:19]
    ds_read_b128 v[132:135], v2 offset:19456
    v_mfma_f32_16x16x32_bf16 v[24:27], v[108:111], v[160:163], v[24:27]
    ds_read_b128 v[136:139], v2 offset:20480
    v_mfma_f32_16x16x32_bf16 v[32:35], v[108:111], v[164:167], v[32:35]
    ds_read_b128 v[140:143], v2 offset:21504
    v_mfma_f32_16x16x32_bf16 v[40:43], v[112:115], v[160:163], v[40:43]
    ds_read_b128 v[144:147], v2 offset:22528
    v_mfma_f32_16x16x32_bf16 v[48:51], v[112:115], v[164:167], v[48:51]
    ds_read_b128 v[148:151], v2 offset:23552
    v_mfma_f32_16x16x32_bf16 v[56:59], v[116:119], v[160:163], v[56:59]
    v_mfma_f32_16x16x32_bf16 v[64:67], v[116:119], v[164:167], v[64:67]
    buffer_load_dwordx4 v[152:155], v4, s[4:7], s56 offen offset:2048 sc1
    v_mfma_f32_16x16x32_bf16 v[72:75], v[120:123], v[160:163], v[72:75]
    v_mfma_f32_16x16x32_bf16 v[80:83], v[120:123], v[164:167], v[80:83]
    v_mfma_f32_16x16x32_bf16 v[88:91], v[124:127], v[160:163], v[88:91]
    v_mfma_f32_16x16x32_bf16 v[96:99], v[124:127], v[164:167], v[96:99]
    s_waitcnt lgkmcnt(0)
    s_barrier
    v_mfma_f32_16x16x32_bf16 v[12:15], v[128:131], v[160:163], v[12:15]
    ds_read_b128 v[104:107], v2 offset:24576
    v_mfma_f32_16x16x32_bf16 v[20:23], v[128:131], v[164:167], v[20:23]
    ds_read_b128 v[108:111], v2 offset:25600
    v_mfma_f32_16x16x32_bf16 v[28:31], v[132:135], v[160:163], v[28:31]
    ds_read_b128 v[112:115], v2 offset:26624
    v_mfma_f32_16x16x32_bf16 v[36:39], v[132:135], v[164:167], v[36:39]
    ds_read_b128 v[116:119], v2 offset:27648
    v_mfma_f32_16x16x32_bf16 v[44:47], v[136:139], v[160:163], v[44:47]
    ds_read_b128 v[120:123], v2 offset:28672
    v_mfma_f32_16x16x32_bf16 v[52:55], v[136:139], v[164:167], v[52:55]
    ds_read_b128 v[124:127], v2 offset:29696
    v_mfma_f32_16x16x32_bf16 v[60:63], v[140:143], v[160:163], v[60:63]
    v_mfma_f32_16x16x32_bf16 v[68:71], v[140:143], v[164:167], v[68:71]
    buffer_load_dwordx4 v[156:159], v4, s[4:7], s57 offen offset:2048 sc1
    v_mfma_f32_16x16x32_bf16 v[76:79], v[144:147], v[160:163], v[76:79]
    v_mfma_f32_16x16x32_bf16 v[84:87], v[144:147], v[164:167], v[84:87]
    v_mfma_f32_16x16x32_bf16 v[92:95], v[148:151], v[160:163], v[92:95]
    v_mfma_f32_16x16x32_bf16 v[100:103], v[148:151], v[164:167], v[100:103]
    s_waitcnt lgkmcnt(0)
    s_waitcnt vmcnt(10)
    v_mfma_f32_16x16x32_bf16 v[8:11], v[104:107], v[168:171], v[8:11]
    ds_read_b128 v[128:131], v2 offset:30720
    v_mfma_f32_16x16x32_bf16 v[16:19], v[104:107], v[172:175], v[16:19]
    ds_read_b128 v[132:135], v2 offset:31744
    v_mfma_f32_16x16x32_bf16 v[24:27], v[108:111], v[168:171], v[24:27]
    ds_read_b128 v[136:139], v2 offset:32768
    v_mfma_f32_16x16x32_bf16 v[32:35], v[108:111], v[172:175], v[32:35]
    ds_read_b128 v[140:143], v2 offset:33792
    v_mfma_f32_16x16x32_bf16 v[40:43], v[112:115], v[168:171], v[40:43]
    ds_read_b128 v[144:147], v2 offset:34816
    v_mfma_f32_16x16x32_bf16 v[48:51], v[112:115], v[172:175], v[48:51]
    ds_read_b128 v[148:151], v2 offset:35840
    v_mfma_f32_16x16x32_bf16 v[56:59], v[116:119], v[168:171], v[56:59]
    v_mfma_f32_16x16x32_bf16 v[64:67], v[116:119], v[172:175], v[64:67]
    buffer_load_dwordx4 v[160:163], v4, s[4:7], s56 offen offset:3072 sc1
    v_mfma_f32_16x16x32_bf16 v[72:75], v[120:123], v[168:171], v[72:75]
    v_mfma_f32_16x16x32_bf16 v[80:83], v[120:123], v[172:175], v[80:83]
    v_mfma_f32_16x16x32_bf16 v[88:91], v[124:127], v[168:171], v[88:91]
    v_mfma_f32_16x16x32_bf16 v[96:99], v[124:127], v[172:175], v[96:99]
    s_waitcnt lgkmcnt(0)
    v_mfma_f32_16x16x32_bf16 v[12:15], v[128:131], v[168:171], v[12:15]
    ds_read_b128 v[104:107], v2 offset:36864
    v_mfma_f32_16x16x32_bf16 v[20:23], v[128:131], v[172:175], v[20:23]
    ds_read_b128 v[108:111], v2 offset:37888
    v_mfma_f32_16x16x32_bf16 v[28:31], v[132:135], v[168:171], v[28:31]
    ds_read_b128 v[112:115], v2 offset:38912
    v_mfma_f32_16x16x32_bf16 v[36:39], v[132:135], v[172:175], v[36:39]
    ds_read_b128 v[116:119], v2 offset:39936
    v_mfma_f32_16x16x32_bf16 v[44:47], v[136:139], v[168:171], v[44:47]
    ds_read_b128 v[120:123], v2 offset:40960
    v_mfma_f32_16x16x32_bf16 v[52:55], v[136:139], v[172:175], v[52:55]
    ds_read_b128 v[124:127], v2 offset:41984
    v_mfma_f32_16x16x32_bf16 v[60:63], v[140:143], v[168:171], v[60:63]
    v_mfma_f32_16x16x32_bf16 v[68:71], v[140:143], v[172:175], v[68:71]
    buffer_load_dwordx4 v[164:167], v4, s[4:7], s57 offen offset:3072 sc1
    v_mfma_f32_16x16x32_bf16 v[76:79], v[144:147], v[168:171], v[76:79]
    v_mfma_f32_16x16x32_bf16 v[84:87], v[144:147], v[172:175], v[84:87]
    v_mfma_f32_16x16x32_bf16 v[92:95], v[148:151], v[168:171], v[92:95]
    v_mfma_f32_16x16x32_bf16 v[100:103], v[148:151], v[172:175], v[100:103]
    s_waitcnt lgkmcnt(0)
    s_waitcnt vmcnt(10)
    v_mfma_f32_16x16x32_bf16 v[8:11], v[104:107], v[176:179], v[8:11]
    ds_read_b128 v[128:131], v2 offset:43008
    v_mfma_f32_16x16x32_bf16 v[16:19], v[104:107], v[180:183], v[16:19]
    ds_read_b128 v[132:135], v2 offset:44032
    v_mfma_f32_16x16x32_bf16 v[24:27], v[108:111], v[176:179], v[24:27]
    ds_read_b128 v[136:139], v2 offset:45056
    v_mfma_f32_16x16x32_bf16 v[32:35], v[108:111], v[180:183], v[32:35]
    ds_read_b128 v[140:143], v2 offset:46080
    v_mfma_f32_16x16x32_bf16 v[40:43], v[112:115], v[176:179], v[40:43]
    ds_read_b128 v[144:147], v2 offset:47104
    v_mfma_f32_16x16x32_bf16 v[48:51], v[112:115], v[180:183], v[48:51]
    ds_read_b128 v[148:151], v2 offset:48128
    v_mfma_f32_16x16x32_bf16 v[56:59], v[116:119], v[176:179], v[56:59]
    v_mfma_f32_16x16x32_bf16 v[64:67], v[116:119], v[180:183], v[64:67]
    s_add_u32 s56, s56, 4096
    buffer_load_dwordx4 v[168:171], v4, s[4:7], s56 offen offset:0 sc1
    v_mfma_f32_16x16x32_bf16 v[72:75], v[120:123], v[176:179], v[72:75]
    v_mfma_f32_16x16x32_bf16 v[80:83], v[120:123], v[180:183], v[80:83]
    v_mfma_f32_16x16x32_bf16 v[88:91], v[124:127], v[176:179], v[88:91]
    v_mfma_f32_16x16x32_bf16 v[96:99], v[124:127], v[180:183], v[96:99]
    s_waitcnt lgkmcnt(0)
    s_barrier
    v_mfma_f32_16x16x32_bf16 v[12:15], v[128:131], v[176:179], v[12:15]
    ds_read_b128 v[104:107], v2 offset:49152
    v_mfma_f32_16x16x32_bf16 v[20:23], v[128:131], v[180:183], v[20:23]
    ds_read_b128 v[108:111], v2 offset:50176
    v_mfma_f32_16x16x32_bf16 v[28:31], v[132:135], v[176:179], v[28:31]
    ds_read_b128 v[112:115], v2 offset:51200
    v_mfma_f32_16x16x32_bf16 v[36:39], v[132:135], v[180:183], v[36:39]
    ds_read_b128 v[116:119], v2 offset:52224
    v_mfma_f32_16x16x32_bf16 v[44:47], v[136:139], v[176:179], v[44:47]
    ds_read_b128 v[120:123], v2 offset:53248
    v_mfma_f32_16x16x32_bf16 v[52:55], v[136:139], v[180:183], v[52:55]
    ds_read_b128 v[124:127], v2 offset:54272
    v_mfma_f32_16x16x32_bf16 v[60:63], v[140:143], v[176:179], v[60:63]
    v_mfma_f32_16x16x32_bf16 v[68:71], v[140:143], v[180:183], v[68:71]
    s_add_u32 s57, s57, 4096
    buffer_load_dwordx4 v[172:175], v4, s[4:7], s57 offen offset:0 sc1
    v_mfma_f32_16x16x32_bf16 v[76:79], v[144:147], v[176:179], v[76:79]
    v_mfma_f32_16x16x32_bf16 v[84:87], v[144:147], v[180:183], v[84:87]
    v_mfma_f32_16x16x32_bf16 v[92:95], v[148:151], v[176:179], v[92:95]
    v_mfma_f32_16x16x32_bf16 v[100:103], v[148:151], v[180:183], v[100:103]
    s_waitcnt lgkmcnt(0)
    s_waitcnt vmcnt(10)
    v_mfma_f32_16x16x32_bf16 v[8:11], v[104:107], v[184:187], v[8:11]
    ds_read_b128 v[128:131], v2 offset:55296
    v_mfma_f32_16x16x32_bf16 v[16:19], v[104:107], v[188:191], v[16:19]
    ds_read_b128 v[132:135], v2 offset:56320
    v_mfma_f32_16x16x32_bf16 v[24:27], v[108:111], v[184:187], v[24:27]
    ds_read_b128 v[136:139], v2 offset:57344
    v_mfma_f32_16x16x32_bf16 v[32:35], v[108:111], v[188:191], v[32:35]
    ds_read_b128 v[140:143], v2 offset:58368
    v_mfma_f32_16x16x32_bf16 v[40:43], v[112:115], v[184:187], v[40:43]
    ds_read_b128 v[144:147], v2 offset:59392
    v_mfma_f32_16x16x32_bf16 v[48:51], v[112:115], v[188:191], v[48:51]
    ds_read_b128 v[148:151], v2 offset:60416
    v_mfma_f32_16x16x32_bf16 v[56:59], v[116:119], v[184:187], v[56:59]
    v_mfma_f32_16x16x32_bf16 v[64:67], v[116:119], v[188:191], v[64:67]
    buffer_load_dwordx4 v[176:179], v4, s[4:7], s56 offen offset:1024 sc1
    v_mfma_f32_16x16x32_bf16 v[72:75], v[120:123], v[184:187], v[72:75]
    v_mfma_f32_16x16x32_bf16 v[80:83], v[120:123], v[188:191], v[80:83]
    v_mfma_f32_16x16x32_bf16 v[88:91], v[124:127], v[184:187], v[88:91]
    v_mfma_f32_16x16x32_bf16 v[96:99], v[124:127], v[188:191], v[96:99]
    s_waitcnt lgkmcnt(0)
    v_mfma_f32_16x16x32_bf16 v[12:15], v[128:131], v[184:187], v[12:15]
    ds_read_b128 v[104:107], v3 offset:0
    v_mfma_f32_16x16x32_bf16 v[20:23], v[128:131], v[188:191], v[20:23]
    ds_read_b128 v[108:111], v3 offset:1024
    v_mfma_f32_16x16x32_bf16 v[28:31], v[132:135], v[184:187], v[28:31]
    ds_read_b128 v[112:115], v3 offset:2048
    v_mfma_f32_16x16x32_bf16 v[36:39], v[132:135], v[188:191], v[36:39]
    ds_read_b128 v[116:119], v3 offset:3072
    v_mfma_f32_16x16x32_bf16 v[44:47], v[136:139], v[184:187], v[44:47]
    ds_read_b128 v[120:123], v3 offset:4096
    v_mfma_f32_16x16x32_bf16 v[52:55], v[136:139], v[188:191], v[52:55]
    ds_read_b128 v[124:127], v3 offset:5120
    v_mfma_f32_16x16x32_bf16 v[60:63], v[140:143], v[184:187], v[60:63]
    v_mfma_f32_16x16x32_bf16 v[68:71], v[140:143], v[188:191], v[68:71]
    buffer_load_dwordx4 v[180:183], v4, s[4:7], s57 offen offset:1024 sc1
    v_mfma_f32_16x16x32_bf16 v[76:79], v[144:147], v[184:187], v[76:79]
    v_mfma_f32_16x16x32_bf16 v[84:87], v[144:147], v[188:191], v[84:87]
    v_mfma_f32_16x16x32_bf16 v[92:95], v[148:151], v[184:187], v[92:95]
    v_mfma_f32_16x16x32_bf16 v[100:103], v[148:151], v[188:191], v[100:103]
    s_waitcnt lgkmcnt(0)
    s_waitcnt vmcnt(10)
    v_mfma_f32_16x16x32_bf16 v[8:11], v[104:107], v[192:195], v[8:11]
    ds_read_b128 v[128:131], v3 offset:6144
    v_mfma_f32_16x16x32_bf16 v[16:19], v[104:107], v[196:199], v[16:19]
    ds_read_b128 v[132:135], v3 offset:7168
    v_mfma_f32_16x16x32_bf16 v[24:27], v[108:111], v[192:195], v[24:27]
    ds_read_b128 v[136:139], v3 offset:8192
    v_mfma_f32_16x16x32_bf16 v[32:35], v[108:111], v[196:199], v[32:35]
    ds_read_b128 v[140:143], v3 offset:9216
    v_mfma_f32_16x16x32_bf16 v[40:43], v[112:115], v[192:195], v[40:43]
    ds_read_b128 v[144:147], v3 offset:10240
    v_mfma_f32_16x16x32_bf16 v[48:51], v[112:115], v[196:199], v[48:51]
    ds_read_b128 v[148:151], v3 offset:11264
    v_mfma_f32_16x16x32_bf16 v[56:59], v[116:119], v[192:195], v[56:59]
    v_mfma_f32_16x16x32_bf16 v[64:67], v[116:119], v[196:199], v[64:67]
    buffer_load_dwordx4 v[184:187], v4, s[4:7], s56 offen offset:2048 sc1
    v_mfma_f32_16x16x32_bf16 v[72:75], v[120:123], v[192:195], v[72:75]
    v_mfma_f32_16x16x32_bf16 v[80:83], v[120:123], v[196:199], v[80:83]
    v_mfma_f32_16x16x32_bf16 v[88:91], v[124:127], v[192:195], v[88:91]
    v_mfma_f32_16x16x32_bf16 v[96:99], v[124:127], v[196:199], v[96:99]
    s_waitcnt lgkmcnt(0)
    s_barrier
    v_mfma_f32_16x16x32_bf16 v[12:15], v[128:131], v[192:195], v[12:15]
    ds_read_b128 v[104:107], v3 offset:12288
    v_mfma_f32_16x16x32_bf16 v[20:23], v[128:131], v[196:199], v[20:23]
    ds_read_b128 v[108:111], v3 offset:13312
    v_mfma_f32_16x16x32_bf16 v[28:31], v[132:135], v[192:195], v[28:31]
    ds_read_b128 v[112:115], v3 offset:14336
    v_mfma_f32_16x16x32_bf16 v[36:39], v[132:135], v[196:199], v[36:39]
    ds_read_b128 v[116:119], v3 offset:15360
    v_mfma_f32_16x16x32_bf16 v[44:47], v[136:139], v[192:195], v[44:47]
    ds_read_b128 v[120:123], v3 offset:16384
    v_mfma_f32_16x16x32_bf16 v[52:55], v[136:139], v[196:199], v[52:55]
    ds_read_b128 v[124:127], v3 offset:17408
    v_mfma_f32_16x16x32_bf16 v[60:63], v[140:143], v[192:195], v[60:63]
    v_mfma_f32_16x16x32_bf16 v[68:71], v[140:143], v[196:199], v[68:71]
    buffer_load_dwordx4 v[188:191], v4, s[4:7], s57 offen offset:2048 sc1
    v_mfma_f32_16x16x32_bf16 v[76:79], v[144:147], v[192:195], v[76:79]
    v_mfma_f32_16x16x32_bf16 v[84:87], v[144:147], v[196:199], v[84:87]
    v_mfma_f32_16x16x32_bf16 v[92:95], v[148:151], v[192:195], v[92:95]
    v_mfma_f32_16x16x32_bf16 v[100:103], v[148:151], v[196:199], v[100:103]
    s_waitcnt lgkmcnt(0)
    s_waitcnt vmcnt(8)
    v_mfma_f32_16x16x32_bf16 v[8:11], v[104:107], v[152:155], v[8:11]
    ds_read_b128 v[128:131], v3 offset:18432
    v_mfma_f32_16x16x32_bf16 v[16:19], v[104:107], v[156:159], v[16:19]
    ds_read_b128 v[132:135], v3 offset:19456
    v_mfma_f32_16x16x32_bf16 v[24:27], v[108:111], v[152:155], v[24:27]
    ds_read_b128 v[136:139], v3 offset:20480
    v_mfma_f32_16x16x32_bf16 v[32:35], v[108:111], v[156:159], v[32:35]
    ds_read_b128 v[140:143], v3 offset:21504
    v_mfma_f32_16x16x32_bf16 v[40:43], v[112:115], v[152:155], v[40:43]
    ds_read_b128 v[144:147], v3 offset:22528
    v_mfma_f32_16x16x32_bf16 v[48:51], v[112:115], v[156:159], v[48:51]
    ds_read_b128 v[148:151], v3 offset:23552
    v_mfma_f32_16x16x32_bf16 v[56:59], v[116:119], v[152:155], v[56:59]
    v_add_f32 v200, v200, v202
    v_mfma_f32_16x16x32_bf16 v[64:67], v[116:119], v[156:159], v[64:67]
    buffer_load_dwordx4 v[192:195], v4, s[4:7], s56 offen offset:3072 sc1
    v_mfma_f32_16x16x32_bf16 v[72:75], v[120:123], v[152:155], v[72:75]
    v_add_f32 v201, v201, v203
    v_mfma_f32_16x16x32_bf16 v[80:83], v[120:123], v[156:159], v[80:83]
    v_mov_b32 v202, v200
    v_mfma_f32_16x16x32_bf16 v[88:91], v[124:127], v[152:155], v[88:91]
    s_nop 0
    v_permlane16_swap_b32 v200, v202
    v_mfma_f32_16x16x32_bf16 v[96:99], v[124:127], v[156:159], v[96:99]
    v_add_f32 v200, v200, v202
    s_waitcnt lgkmcnt(0)
    v_mfma_f32_16x16x32_bf16 v[12:15], v[128:131], v[152:155], v[12:15]
    ds_read_b128 v[104:107], v3 offset:24576
    v_mfma_f32_16x16x32_bf16 v[20:23], v[128:131], v[156:159], v[20:23]
    ds_read_b128 v[108:111], v3 offset:25600
    v_mfma_f32_16x16x32_bf16 v[28:31], v[132:135], v[152:155], v[28:31]
    ds_read_b128 v[112:115], v3 offset:26624
    v_mfma_f32_16x16x32_bf16 v[36:39], v[132:135], v[156:159], v[36:39]
    ds_read_b128 v[116:119], v3 offset:27648
    v_mfma_f32_16x16x32_bf16 v[44:47], v[136:139], v[152:155], v[44:47]
    ds_read_b128 v[120:123], v3 offset:28672
    v_mfma_f32_16x16x32_bf16 v[52:55], v[136:139], v[156:159], v[52:55]
    ds_read_b128 v[124:127], v3 offset:29696
    v_mfma_f32_16x16x32_bf16 v[60:63], v[140:143], v[152:155], v[60:63]
    v_mov_b32 v202, v200
    v_mfma_f32_16x16x32_bf16 v[68:71], v[140:143], v[156:159], v[68:71]
    buffer_load_dwordx4 v[196:199], v4, s[4:7], s57 offen offset:3072 sc1
    v_mfma_f32_16x16x32_bf16 v[76:79], v[144:147], v[152:155], v[76:79]
    v_permlane32_swap_b32 v200, v202
    v_mfma_f32_16x16x32_bf16 v[84:87], v[144:147], v[156:159], v[84:87]
    v_add_f32 v200, v200, v202
    v_mfma_f32_16x16x32_bf16 v[92:95], v[148:151], v[152:155], v[92:95]
    v_mov_b32 v203, v201
    v_mfma_f32_16x16x32_bf16 v[100:103], v[148:151], v[156:159], v[100:103]
    s_nop 0
    v_permlane16_swap_b32 v201, v203
    s_waitcnt lgkmcnt(0)
    s_waitcnt vmcnt(8)
    v_mfma_f32_16x16x32_bf16 v[8:11], v[104:107], v[160:163], v[8:11]
    ds_read_b128 v[128:131], v3 offset:30720
    v_mfma_f32_16x16x32_bf16 v[16:19], v[104:107], v[164:167], v[16:19]
    ds_read_b128 v[132:135], v3 offset:31744
    v_mfma_f32_16x16x32_bf16 v[24:27], v[108:111], v[160:163], v[24:27]
    ds_read_b128 v[136:139], v3 offset:32768
    v_mfma_f32_16x16x32_bf16 v[32:35], v[108:111], v[164:167], v[32:35]
    ds_read_b128 v[140:143], v3 offset:33792
    v_mfma_f32_16x16x32_bf16 v[40:43], v[112:115], v[160:163], v[40:43]
    ds_read_b128 v[144:147], v3 offset:34816
    v_mfma_f32_16x16x32_bf16 v[48:51], v[112:115], v[164:167], v[48:51]
    ds_read_b128 v[148:151], v3 offset:35840
    v_mfma_f32_16x16x32_bf16 v[56:59], v[116:119], v[160:163], v[56:59]
    v_add_f32 v201, v201, v203
    v_mfma_f32_16x16x32_bf16 v[64:67], v[116:119], v[164:167], v[64:67]
    s_add_u32 s56, s56, 4096
    buffer_load_dwordx4 v[152:155], v4, s[4:7], s56 offen offset:0 sc1
    v_mfma_f32_16x16x32_bf16 v[72:75], v[120:123], v[160:163], v[72:75]
    v_mov_b32 v203, v201
    v_mfma_f32_16x16x32_bf16 v[80:83], v[120:123], v[164:167], v[80:83]
    s_nop 0
    v_permlane32_swap_b32 v201, v203
    v_mfma_f32_16x16x32_bf16 v[88:91], v[124:127], v[160:163], v[88:91]
    v_add_f32 v201, v201, v203
    v_mfma_f32_16x16x32_bf16 v[96:99], v[124:127], v[164:167], v[96:99]
    v_mul_f32 v200, 0xbacccccd, v200
    s_waitcnt lgkmcnt(0)
    s_barrier
    v_mfma_f32_16x16x32_bf16 v[12:15], v[128:131], v[160:163], v[12:15]
    ds_read_b128 v[104:107], v4 offset:0
    v_mfma_f32_16x16x32_bf16 v[20:23], v[128:131], v[164:167], v[20:23]
    ds_read_b128 v[108:111], v4 offset:1024
    v_mfma_f32_16x16x32_bf16 v[28:31], v[132:135], v[160:163], v[28:31]
    ds_read_b128 v[112:115], v4 offset:2048
    v_mfma_f32_16x16x32_bf16 v[36:39], v[132:135], v[164:167], v[36:39]
    ds_read_b128 v[116:119], v4 offset:3072
    v_mfma_f32_16x16x32_bf16 v[44:47], v[136:139], v[160:163], v[44:47]
    ds_read_b128 v[120:123], v4 offset:4096
    v_mfma_f32_16x16x32_bf16 v[52:55], v[136:139], v[164:167], v[52:55]
    ds_read_b128 v[124:127], v4 offset:5120
    v_mfma_f32_16x16x32_bf16 v[60:63], v[140:143], v[160:163], v[60:63]
    v_mul_f32 v201, 0x3acccccd, v201
    v_mfma_f32_16x16x32_bf16 v[68:71], v[140:143], v[164:167], v[68:71]
    s_add_u32 s57, s57, 4096
    buffer_load_dwordx4 v[156:159], v4, s[4:7], s57 offen offset:0 sc1
    v_mfma_f32_16x16x32_bf16 v[76:79], v[144:147], v[160:163], v[76:79]
    v_fma_f32 v201, -v200, v200, v201
    v_mfma_f32_16x16x32_bf16 v[84:87], v[144:147], v[164:167], v[84:87]
    v_max_f32 v201, 0, v201
    v_mfma_f32_16x16x32_bf16 v[92:95], v[148:151], v[160:163], v[92:95]
    v_add_f32 v203, 0x3727c5ac, v201
    v_mfma_f32_16x16x32_bf16 v[100:103], v[148:151], v[164:167], v[100:103]
    v_rsq_f32 v201, v203
    s_waitcnt lgkmcnt(0)
    s_waitcnt vmcnt(8)
    v_mfma_f32_16x16x32_bf16 v[8:11], v[104:107], v[168:171], v[8:11]
    ds_read_b128 v[128:131], v4 offset:6144
    v_mfma_f32_16x16x32_bf16 v[16:19], v[104:107], v[172:175], v[16:19]
    ds_read_b128 v[132:135], v4 offset:7168
    v_mfma_f32_16x16x32_bf16 v[24:27], v[108:111], v[168:171], v[24:27]
    ds_read_b128 v[136:139], v4 offset:8192
    v_mfma_f32_16x16x32_bf16 v[32:35], v[108:111], v[172:175], v[32:35]
    ds_read_b128 v[140:143], v4 offset:9216
    v_mfma_f32_16x16x32_bf16 v[40:43], v[112:115], v[168:171], v[40:43]
    ds_read_b128 v[144:147], v4 offset:10240
    v_mfma_f32_16x16x32_bf16 v[48:51], v[112:115], v[172:175], v[48:51]
    ds_read_b128 v[148:151], v4 offset:11264
    v_mfma_f32_16x16x32_bf16 v[56:59], v[116:119], v[168:171], v[56:59]
    v_mul_f32 v202, v201, v201
    v_mfma_f32_16x16x32_bf16 v[64:67], v[116:119], v[172:175], v[64:67]
    buffer_load_dwordx4 v[160:163], v4, s[4:7], s56 offen offset:1024 sc1
    v_mfma_f32_16x16x32_bf16 v[72:75], v[120:123], v[168:171], v[72:75]
    v_mul_f32 v202, v202, v201
    v_mfma_f32_16x16x32_bf16 v[80:83], v[120:123], v[172:175], v[80:83]
    v_mul_f32 v201, 0xc0135761, v201
    v_mfma_f32_16x16x32_bf16 v[88:91], v[124:127], v[168:171], v[88:91]
    v_mul_f32 v202, 0xbdd2d3e8, v202
    v_mfma_f32_16x16x32_bf16 v[96:99], v[124:127], v[172:175], v[96:99]
    s_waitcnt lgkmcnt(0)
    v_mfma_f32_16x16x32_bf16 v[12:15], v[128:131], v[168:171], v[12:15]
    ds_read_b128 v[104:107], v4 offset:12288
    v_mfma_f32_16x16x32_bf16 v[20:23], v[128:131], v[172:175], v[20:23]
    ds_read_b128 v[108:111], v4 offset:13312
    v_mfma_f32_16x16x32_bf16 v[28:31], v[132:135], v[168:171], v[28:31]
    ds_read_b128 v[112:115], v4 offset:14336
    v_mfma_f32_16x16x32_bf16 v[36:39], v[132:135], v[172:175], v[36:39]
    ds_read_b128 v[116:119], v4 offset:15360
    v_mfma_f32_16x16x32_bf16 v[44:47], v[136:139], v[168:171], v[44:47]
    ds_read_b128 v[120:123], v4 offset:16384
    v_mfma_f32_16x16x32_bf16 v[52:55], v[136:139], v[172:175], v[52:55]
    ds_read_b128 v[124:127], v4 offset:17408
    v_mfma_f32_16x16x32_bf16 v[60:63], v[140:143], v[168:171], v[60:63]
    v_mfma_f32_16x16x32_bf16 v[68:71], v[140:143], v[172:175], v[68:71]
    buffer_load_dwordx4 v[164:167], v4, s[4:7], s57 offen offset:1024 sc1
    v_mfma_f32_16x16x32_bf16 v[76:79], v[144:147], v[168:171], v[76:79]
    v_mfma_f32_16x16x32_bf16 v[84:87], v[144:147], v[172:175], v[84:87]
    v_mfma_f32_16x16x32_bf16 v[92:95], v[148:151], v[168:171], v[92:95]
    v_mfma_f32_16x16x32_bf16 v[100:103], v[148:151], v[172:175], v[100:103]
    s_waitcnt lgkmcnt(0)
    s_waitcnt vmcnt(8)
    v_mfma_f32_16x16x32_bf16 v[8:11], v[104:107], v[176:179], v[8:11]
    ds_read_b128 v[128:131], v4 offset:18432
    v_mfma_f32_16x16x32_bf16 v[16:19], v[104:107], v[180:183], v[16:19]
    ds_read_b128 v[132:135], v4 offset:19456
    v_mfma_f32_16x16x32_bf16 v[24:27], v[108:111], v[176:179], v[24:27]
    ds_read_b128 v[136:139], v4 offset:20480
    v_mfma_f32_16x16x32_bf16 v[32:35], v[108:111], v[180:183], v[32:35]
    ds_read_b128 v[140:143], v4 offset:21504
    v_mfma_f32_16x16x32_bf16 v[40:43], v[112:115], v[176:179], v[40:43]
    ds_read_b128 v[144:147], v4 offset:22528
    v_mfma_f32_16x16x32_bf16 v[48:51], v[112:115], v[180:183], v[48:51]
    ds_read_b128 v[148:151], v4 offset:23552
    v_mfma_f32_16x16x32_bf16 v[56:59], v[116:119], v[176:179], v[56:59]
    v_add_f32 v204, v204, v206
    v_mfma_f32_16x16x32_bf16 v[64:67], v[116:119], v[180:183], v[64:67]
    buffer_load_dwordx4 v[168:171], v4, s[4:7], s56 offen offset:2048 sc1
    v_mfma_f32_16x16x32_bf16 v[72:75], v[120:123], v[176:179], v[72:75]
    v_add_f32 v205, v205, v207
    v_mfma_f32_16x16x32_bf16 v[80:83], v[120:123], v[180:183], v[80:83]
    v_mov_b32 v206, v204
    v_mfma_f32_16x16x32_bf16 v[88:91], v[124:127], v[176:179], v[88:91]
    s_nop 0
    v_permlane16_swap_b32 v204, v206
    v_mfma_f32_16x16x32_bf16 v[96:99], v[124:127], v[180:183], v[96:99]
    v_add_f32 v204, v204, v206
    s_waitcnt lgkmcnt(0)
    s_barrier
    v_mfma_f32_16x16x32_bf16 v[12:15], v[128:131], v[176:179], v[12:15]
    ds_read_b128 v[104:107], v4 offset:24576
    v_mfma_f32_16x16x32_bf16 v[20:23], v[128:131], v[180:183], v[20:23]
    ds_read_b128 v[108:111], v4 offset:25600
    v_mfma_f32_16x16x32_bf16 v[28:31], v[132:135], v[176:179], v[28:31]
    ds_read_b128 v[112:115], v4 offset:26624
    v_mfma_f32_16x16x32_bf16 v[36:39], v[132:135], v[180:183], v[36:39]
    ds_read_b128 v[116:119], v4 offset:27648
    v_mfma_f32_16x16x32_bf16 v[44:47], v[136:139], v[176:179], v[44:47]
    ds_read_b128 v[120:123], v4 offset:28672
    v_mfma_f32_16x16x32_bf16 v[52:55], v[136:139], v[180:183], v[52:55]
    ds_read_b128 v[124:127], v4 offset:29696
    v_mfma_f32_16x16x32_bf16 v[60:63], v[140:143], v[176:179], v[60:63]
    v_mov_b32 v206, v204
    v_mfma_f32_16x16x32_bf16 v[68:71], v[140:143], v[180:183], v[68:71]
    buffer_load_dwordx4 v[172:175], v4, s[4:7], s57 offen offset:2048 sc1
    v_mfma_f32_16x16x32_bf16 v[76:79], v[144:147], v[176:179], v[76:79]
    v_permlane32_swap_b32 v204, v206
    v_mfma_f32_16x16x32_bf16 v[84:87], v[144:147], v[180:183], v[84:87]
    v_add_f32 v204, v204, v206
    v_mfma_f32_16x16x32_bf16 v[92:95], v[148:151], v[176:179], v[92:95]
    v_mov_b32 v207, v205
    v_mfma_f32_16x16x32_bf16 v[100:103], v[148:151], v[180:183], v[100:103]
    s_nop 0
    v_permlane16_swap_b32 v205, v207
    s_waitcnt lgkmcnt(0)
    s_waitcnt vmcnt(8)
    v_mfma_f32_16x16x32_bf16 v[8:11], v[104:107], v[184:187], v[8:11]
    ds_read_b128 v[128:131], v4 offset:30720
    v_mfma_f32_16x16x32_bf16 v[16:19], v[104:107], v[188:191], v[16:19]
    ds_read_b128 v[132:135], v4 offset:31744
    v_mfma_f32_16x16x32_bf16 v[24:27], v[108:111], v[184:187], v[24:27]
    ds_read_b128 v[136:139], v4 offset:32768
    v_mfma_f32_16x16x32_bf16 v[32:35], v[108:111], v[188:191], v[32:35]
    ds_read_b128 v[140:143], v4 offset:33792
    v_mfma_f32_16x16x32_bf16 v[40:43], v[112:115], v[184:187], v[40:43]
    ds_read_b128 v[144:147], v4 offset:34816
    v_mfma_f32_16x16x32_bf16 v[48:51], v[112:115], v[188:191], v[48:51]
    ds_read_b128 v[148:151], v4 offset:35840
    v_mfma_f32_16x16x32_bf16 v[56:59], v[116:119], v[184:187], v[56:59]
    v_add_f32 v205, v205, v207
    v_mfma_f32_16x16x32_bf16 v[64:67], v[116:119], v[188:191], v[64:67]
    buffer_load_dwordx4 v[176:179], v4, s[4:7], s56 offen offset:3072 sc1
    v_mfma_f32_16x16x32_bf16 v[72:75], v[120:123], v[184:187], v[72:75]
    v_mov_b32 v207, v205
    v_mfma_f32_16x16x32_bf16 v[80:83], v[120:123], v[188:191], v[80:83]
    s_nop 0
    v_permlane32_swap_b32 v205, v207
    v_mfma_f32_16x16x32_bf16 v[88:91], v[124:127], v[184:187], v[88:91]
    v_add_f32 v205, v205, v207
    v_mfma_f32_16x16x32_bf16 v[96:99], v[124:127], v[188:191], v[96:99]
    v_mul_f32 v204, 0xbacccccd, v204
    s_waitcnt lgkmcnt(0)
    v_mfma_f32_16x16x32_bf16 v[12:15], v[128:131], v[184:187], v[12:15]
    ds_read_b128 v[104:107], v4 offset:36864
    v_mfma_f32_16x16x32_bf16 v[20:23], v[128:131], v[188:191], v[20:23]
    ds_read_b128 v[108:111], v4 offset:37888
    v_mfma_f32_16x16x32_bf16 v[28:31], v[132:135], v[184:187], v[28:31]
    ds_read_b128 v[112:115], v4 offset:38912
    v_mfma_f32_16x16x32_bf16 v[36:39], v[132:135], v[188:191], v[36:39]
    ds_read_b128 v[116:119], v4 offset:39936
    v_mfma_f32_16x16x32_bf16 v[44:47], v[136:139], v[184:187], v[44:47]
    ds_read_b128 v[120:123], v4 offset:40960
    v_mfma_f32_16x16x32_bf16 v[52:55], v[136:139], v[188:191], v[52:55]
    ds_read_b128 v[124:127], v4 offset:41984
    v_mfma_f32_16x16x32_bf16 v[60:63], v[140:143], v[184:187], v[60:63]
    v_mul_f32 v205, 0x3acccccd, v205
    v_mfma_f32_16x16x32_bf16 v[68:71], v[140:143], v[188:191], v[68:71]
    buffer_load_dwordx4 v[180:183], v4, s[4:7], s57 offen offset:3072 sc1
    v_mfma_f32_16x16x32_bf16 v[76:79], v[144:147], v[184:187], v[76:79]
    v_fma_f32 v205, -v204, v204, v205
    v_mfma_f32_16x16x32_bf16 v[84:87], v[144:147], v[188:191], v[84:87]
    v_max_f32 v205, 0, v205
    v_mfma_f32_16x16x32_bf16 v[92:95], v[148:151], v[184:187], v[92:95]
    v_add_f32 v207, 0x3727c5ac, v205
    v_mfma_f32_16x16x32_bf16 v[100:103], v[148:151], v[188:191], v[100:103]
    v_rsq_f32 v205, v207
    s_waitcnt lgkmcnt(0)
    s_waitcnt vmcnt(8)
    v_mfma_f32_16x16x32_bf16 v[8:11], v[104:107], v[192:195], v[8:11]
    ds_read_b128 v[128:131], v4 offset:43008
    v_mfma_f32_16x16x32_bf16 v[16:19], v[104:107], v[196:199], v[16:19]
    ds_read_b128 v[132:135], v4 offset:44032
    v_mfma_f32_16x16x32_bf16 v[24:27], v[108:111], v[192:195], v[24:27]
    ds_read_b128 v[136:139], v4 offset:45056
    v_mfma_f32_16x16x32_bf16 v[32:35], v[108:111], v[196:199], v[32:35]
    ds_read_b128 v[140:143], v4 offset:46080
    v_mfma_f32_16x16x32_bf16 v[40:43], v[112:115], v[192:195], v[40:43]
    ds_read_b128 v[144:147], v4 offset:47104
    v_mfma_f32_16x16x32_bf16 v[48:51], v[112:115], v[196:199], v[48:51]
    ds_read_b128 v[148:151], v4 offset:48128
    v_mfma_f32_16x16x32_bf16 v[56:59], v[116:119], v[192:195], v[56:59]
    v_mul_f32 v206, v205, v205
    v_mfma_f32_16x16x32_bf16 v[64:67], v[116:119], v[196:199], v[64:67]
    s_add_u32 s56, s56, 4096
    buffer_load_dwordx4 v[184:187], v4, s[4:7], s56 offen offset:0 sc1
    v_mfma_f32_16x16x32_bf16 v[72:75], v[120:123], v[192:195], v[72:75]
    v_mul_f32 v206, v206, v205
    v_mfma_f32_16x16x32_bf16 v[80:83], v[120:123], v[196:199], v[80:83]
    v_mul_f32 v205, 0xc0135761, v205
    v_mfma_f32_16x16x32_bf16 v[88:91], v[124:127], v[192:195], v[88:91]
    v_mul_f32 v206, 0xbdd2d3e8, v206
    v_mfma_f32_16x16x32_bf16 v[96:99], v[124:127], v[196:199], v[96:99]
    s_waitcnt lgkmcnt(0)
    s_barrier
    v_mfma_f32_16x16x32_bf16 v[12:15], v[128:131], v[192:195], v[12:15]
    ds_read_b128 v[104:107], v4 offset:49152
    v_mfma_f32_16x16x32_bf16 v[20:23], v[128:131], v[196:199], v[20:23]
    ds_read_b128 v[108:111], v4 offset:50176
    v_mfma_f32_16x16x32_bf16 v[28:31], v[132:135], v[192:195], v[28:31]
    ds_read_b128 v[112:115], v4 offset:51200
    v_mfma_f32_16x16x32_bf16 v[36:39], v[132:135], v[196:199], v[36:39]
    ds_read_b128 v[116:119], v4 offset:52224
    v_mfma_f32_16x16x32_bf16 v[44:47], v[136:139], v[192:195], v[44:47]
    ds_read_b128 v[120:123], v4 offset:53248
    v_mfma_f32_16x16x32_bf16 v[52:55], v[136:139], v[196:199], v[52:55]
    ds_read_b128 v[124:127], v4 offset:54272
    v_mfma_f32_16x16x32_bf16 v[60:63], v[140:143], v[192:195], v[60:63]
    v_mfma_f32_16x16x32_bf16 v[68:71], v[140:143], v[196:199], v[68:71]
    s_add_u32 s57, s57, 4096
    buffer_load_dwordx4 v[188:191], v4, s[4:7], s57 offen offset:0 sc1
    v_mfma_f32_16x16x32_bf16 v[76:79], v[144:147], v[192:195], v[76:79]
    v_mfma_f32_16x16x32_bf16 v[84:87], v[144:147], v[196:199], v[84:87]
    v_mfma_f32_16x16x32_bf16 v[92:95], v[148:151], v[192:195], v[92:95]
    v_mfma_f32_16x16x32_bf16 v[100:103], v[148:151], v[196:199], v[100:103]
    s_waitcnt lgkmcnt(0)
    s_waitcnt vmcnt(8)
    v_mfma_f32_16x16x32_bf16 v[8:11], v[104:107], v[152:155], v[8:11]
    ds_read_b128 v[128:131], v4 offset:55296
    v_mfma_f32_16x16x32_bf16 v[16:19], v[104:107], v[156:159], v[16:19]
    ds_read_b128 v[132:135], v4 offset:56320
    v_mfma_f32_16x16x32_bf16 v[24:27], v[108:111], v[152:155], v[24:27]
    ds_read_b128 v[136:139], v4 offset:57344
    v_mfma_f32_16x16x32_bf16 v[32:35], v[108:111], v[156:159], v[32:35]
    ds_read_b128 v[140:143], v4 offset:58368
    v_mfma_f32_16x16x32_bf16 v[40:43], v[112:115], v[152:155], v[40:43]
    ds_read_b128 v[144:147], v4 offset:59392
    v_mfma_f32_16x16x32_bf16 v[48:51], v[112:115], v[156:159], v[48:51]
    ds_read_b128 v[148:151], v4 offset:60416
    v_mfma_f32_16x16x32_bf16 v[56:59], v[116:119], v[152:155], v[56:59]
    v_mfma_f32_16x16x32_bf16 v[64:67], v[116:119], v[156:159], v[64:67]
    buffer_load_dwordx4 v[192:195], v4, s[4:7], s56 offen offset:1024 sc1
    v_mfma_f32_16x16x32_bf16 v[72:75], v[120:123], v[152:155], v[72:75]
    v_mfma_f32_16x16x32_bf16 v[80:83], v[120:123], v[156:159], v[80:83]
    v_mfma_f32_16x16x32_bf16 v[88:91], v[124:127], v[152:155], v[88:91]
    v_mfma_f32_16x16x32_bf16 v[96:99], v[124:127], v[156:159], v[96:99]
    s_waitcnt lgkmcnt(0)
    v_mfma_f32_16x16x32_bf16 v[12:15], v[128:131], v[152:155], v[12:15]
    ds_read_b128 v[104:107], v2 offset:0
    v_mfma_f32_16x16x32_bf16 v[20:23], v[128:131], v[156:159], v[20:23]
    ds_read_b128 v[108:111], v2 offset:1024
    v_mfma_f32_16x16x32_bf16 v[28:31], v[132:135], v[152:155], v[28:31]
    ds_read_b128 v[112:115], v2 offset:2048
    v_mfma_f32_16x16x32_bf16 v[36:39], v[132:135], v[156:159], v[36:39]
    ds_read_b128 v[116:119], v2 offset:3072
    v_mfma_f32_16x16x32_bf16 v[44:47], v[136:139], v[152:155], v[44:47]
    ds_read_b128 v[120:123], v2 offset:4096
    v_mfma_f32_16x16x32_bf16 v[52:55], v[136:139], v[156:159], v[52:55]
    ds_read_b128 v[124:127], v2 offset:5120
    v_mfma_f32_16x16x32_bf16 v[60:63], v[140:143], v[152:155], v[60:63]
    v_mfma_f32_16x16x32_bf16 v[68:71], v[140:143], v[156:159], v[68:71]
    buffer_load_dwordx4 v[196:199], v4, s[4:7], s57 offen offset:1024 sc1
    v_mfma_f32_16x16x32_bf16 v[76:79], v[144:147], v[152:155], v[76:79]
    v_mfma_f32_16x16x32_bf16 v[84:87], v[144:147], v[156:159], v[84:87]
    v_mfma_f32_16x16x32_bf16 v[92:95], v[148:151], v[152:155], v[92:95]
    v_mfma_f32_16x16x32_bf16 v[100:103], v[148:151], v[156:159], v[100:103]
    s_waitcnt lgkmcnt(0)
    s_waitcnt vmcnt(8)
    v_mfma_f32_16x16x32_bf16 v[8:11], v[104:107], v[160:163], v[8:11]
    ds_read_b128 v[128:131], v2 offset:6144
    v_mfma_f32_16x16x32_bf16 v[16:19], v[104:107], v[164:167], v[16:19]
    ds_read_b128 v[132:135], v2 offset:7168
    v_mfma_f32_16x16x32_bf16 v[24:27], v[108:111], v[160:163], v[24:27]
    ds_read_b128 v[136:139], v2 offset:8192
    v_mfma_f32_16x16x32_bf16 v[32:35], v[108:111], v[164:167], v[32:35]
    ds_read_b128 v[140:143], v2 offset:9216
    v_mfma_f32_16x16x32_bf16 v[40:43], v[112:115], v[160:163], v[40:43]
    ds_read_b128 v[144:147], v2 offset:10240
    v_mfma_f32_16x16x32_bf16 v[48:51], v[112:115], v[164:167], v[48:51]
    ds_read_b128 v[148:151], v2 offset:11264
    v_mfma_f32_16x16x32_bf16 v[56:59], v[116:119], v[160:163], v[56:59]
    v_mfma_f32_16x16x32_bf16 v[64:67], v[116:119], v[164:167], v[64:67]
    buffer_load_dwordx4 v[152:155], v4, s[4:7], s56 offen offset:2048 sc1
    v_mfma_f32_16x16x32_bf16 v[72:75], v[120:123], v[160:163], v[72:75]
    v_mfma_f32_16x16x32_bf16 v[80:83], v[120:123], v[164:167], v[80:83]
    v_mfma_f32_16x16x32_bf16 v[88:91], v[124:127], v[160:163], v[88:91]
    v_mfma_f32_16x16x32_bf16 v[96:99], v[124:127], v[164:167], v[96:99]
    s_waitcnt lgkmcnt(0)
    s_barrier
    v_mfma_f32_16x16x32_bf16 v[12:15], v[128:131], v[160:163], v[12:15]
    ds_read_b128 v[104:107], v2 offset:12288
    v_mfma_f32_16x16x32_bf16 v[20:23], v[128:131], v[164:167], v[20:23]
    ds_read_b128 v[108:111], v2 offset:13312
    v_mfma_f32_16x16x32_bf16 v[28:31], v[132:135], v[160:163], v[28:31]
    ds_read_b128 v[112:115], v2 offset:14336
    v_mfma_f32_16x16x32_bf16 v[36:39], v[132:135], v[164:167], v[36:39]
    ds_read_b128 v[116:119], v2 offset:15360
    v_mfma_f32_16x16x32_bf16 v[44:47], v[136:139], v[160:163], v[44:47]
    ds_read_b128 v[120:123], v2 offset:16384
    v_mfma_f32_16x16x32_bf16 v[52:55], v[136:139], v[164:167], v[52:55]
    ds_read_b128 v[124:127], v2 offset:17408
    v_mfma_f32_16x16x32_bf16 v[60:63], v[140:143], v[160:163], v[60:63]
    v_mfma_f32_16x16x32_bf16 v[68:71], v[140:143], v[164:167], v[68:71]
    buffer_load_dwordx4 v[156:159], v4, s[4:7], s57 offen offset:2048 sc1
    v_mfma_f32_16x16x32_bf16 v[76:79], v[144:147], v[160:163], v[76:79]
    v_mfma_f32_16x16x32_bf16 v[84:87], v[144:147], v[164:167], v[84:87]
    v_mfma_f32_16x16x32_bf16 v[92:95], v[148:151], v[160:163], v[92:95]
    v_mfma_f32_16x16x32_bf16 v[100:103], v[148:151], v[164:167], v[100:103]
    s_waitcnt lgkmcnt(0)
    s_waitcnt vmcnt(8)
    v_mfma_f32_16x16x32_bf16 v[8:11], v[104:107], v[168:171], v[8:11]
    ds_read_b128 v[128:131], v2 offset:18432
    v_mfma_f32_16x16x32_bf16 v[16:19], v[104:107], v[172:175], v[16:19]
    ds_read_b128 v[132:135], v2 offset:19456
    v_mfma_f32_16x16x32_bf16 v[24:27], v[108:111], v[168:171], v[24:27]
    ds_read_b128 v[136:139], v2 offset:20480
    v_mfma_f32_16x16x32_bf16 v[32:35], v[108:111], v[172:175], v[32:35]
    ds_read_b128 v[140:143], v2 offset:21504
    v_mfma_f32_16x16x32_bf16 v[40:43], v[112:115], v[168:171], v[40:43]
    ds_read_b128 v[144:147], v2 offset:22528
    v_mfma_f32_16x16x32_bf16 v[48:51], v[112:115], v[172:175], v[48:51]
    ds_read_b128 v[148:151], v2 offset:23552
    v_mfma_f32_16x16x32_bf16 v[56:59], v[116:119], v[168:171], v[56:59]
    v_mfma_f32_16x16x32_bf16 v[64:67], v[116:119], v[172:175], v[64:67]
    buffer_load_dwordx4 v[160:163], v4, s[4:7], s56 offen offset:3072 sc1
    v_mfma_f32_16x16x32_bf16 v[72:75], v[120:123], v[168:171], v[72:75]
    v_mfma_f32_16x16x32_bf16 v[80:83], v[120:123], v[172:175], v[80:83]
    v_mfma_f32_16x16x32_bf16 v[88:91], v[124:127], v[168:171], v[88:91]
    v_mfma_f32_16x16x32_bf16 v[96:99], v[124:127], v[172:175], v[96:99]
    s_waitcnt lgkmcnt(0)
    v_mfma_f32_16x16x32_bf16 v[12:15], v[128:131], v[168:171], v[12:15]
    ds_read_b128 v[104:107], v2 offset:24576
    v_mfma_f32_16x16x32_bf16 v[20:23], v[128:131], v[172:175], v[20:23]
    ds_read_b128 v[108:111], v2 offset:25600
    v_mfma_f32_16x16x32_bf16 v[28:31], v[132:135], v[168:171], v[28:31]
    ds_read_b128 v[112:115], v2 offset:26624
    v_mfma_f32_16x16x32_bf16 v[36:39], v[132:135], v[172:175], v[36:39]
    ds_read_b128 v[116:119], v2 offset:27648
    v_mfma_f32_16x16x32_bf16 v[44:47], v[136:139], v[168:171], v[44:47]
    ds_read_b128 v[120:123], v2 offset:28672
    v_mfma_f32_16x16x32_bf16 v[52:55], v[136:139], v[172:175], v[52:55]
    ds_read_b128 v[124:127], v2 offset:29696
    v_mfma_f32_16x16x32_bf16 v[60:63], v[140:143], v[168:171], v[60:63]
    v_mfma_f32_16x16x32_bf16 v[68:71], v[140:143], v[172:175], v[68:71]
    buffer_load_dwordx4 v[164:167], v4, s[4:7], s57 offen offset:3072 sc1
    v_mfma_f32_16x16x32_bf16 v[76:79], v[144:147], v[168:171], v[76:79]
    v_mfma_f32_16x16x32_bf16 v[84:87], v[144:147], v[172:175], v[84:87]
    v_mfma_f32_16x16x32_bf16 v[92:95], v[148:151], v[168:171], v[92:95]
    v_mfma_f32_16x16x32_bf16 v[100:103], v[148:151], v[172:175], v[100:103]
    s_waitcnt lgkmcnt(0)
    s_waitcnt vmcnt(8)
    v_mfma_f32_16x16x32_bf16 v[8:11], v[104:107], v[176:179], v[8:11]
    ds_read_b128 v[128:131], v2 offset:30720
    v_mfma_f32_16x16x32_bf16 v[16:19], v[104:107], v[180:183], v[16:19]
    ds_read_b128 v[132:135], v2 offset:31744
    v_mfma_f32_16x16x32_bf16 v[24:27], v[108:111], v[176:179], v[24:27]
    ds_read_b128 v[136:139], v2 offset:32768
    v_mfma_f32_16x16x32_bf16 v[32:35], v[108:111], v[180:183], v[32:35]
    ds_read_b128 v[140:143], v2 offset:33792
    v_mfma_f32_16x16x32_bf16 v[40:43], v[112:115], v[176:179], v[40:43]
    ds_read_b128 v[144:147], v2 offset:34816
    v_mfma_f32_16x16x32_bf16 v[48:51], v[112:115], v[180:183], v[48:51]
    ds_read_b128 v[148:151], v2 offset:35840
    v_mfma_f32_16x16x32_bf16 v[56:59], v[116:119], v[176:179], v[56:59]
    v_mfma_f32_16x16x32_bf16 v[64:67], v[116:119], v[180:183], v[64:67]
    v_mfma_f32_16x16x32_bf16 v[72:75], v[120:123], v[176:179], v[72:75]
    v_mfma_f32_16x16x32_bf16 v[80:83], v[120:123], v[180:183], v[80:83]
    v_mfma_f32_16x16x32_bf16 v[88:91], v[124:127], v[176:179], v[88:91]
    v_mfma_f32_16x16x32_bf16 v[96:99], v[124:127], v[180:183], v[96:99]
    s_waitcnt lgkmcnt(0)
    s_barrier
    v_mfma_f32_16x16x32_bf16 v[12:15], v[128:131], v[176:179], v[12:15]
    ds_read_b128 v[104:107], v2 offset:36864
    v_mfma_f32_16x16x32_bf16 v[20:23], v[128:131], v[180:183], v[20:23]
    ds_read_b128 v[108:111], v2 offset:37888
    v_mfma_f32_16x16x32_bf16 v[28:31], v[132:135], v[176:179], v[28:31]
    ds_read_b128 v[112:115], v2 offset:38912
    v_mfma_f32_16x16x32_bf16 v[36:39], v[132:135], v[180:183], v[36:39]
    ds_read_b128 v[116:119], v2 offset:39936
    v_mfma_f32_16x16x32_bf16 v[44:47], v[136:139], v[176:179], v[44:47]
    ds_read_b128 v[120:123], v2 offset:40960
    v_mfma_f32_16x16x32_bf16 v[52:55], v[136:139], v[180:183], v[52:55]
    ds_read_b128 v[124:127], v2 offset:41984
    v_mfma_f32_16x16x32_bf16 v[60:63], v[140:143], v[176:179], v[60:63]
    v_mfma_f32_16x16x32_bf16 v[68:71], v[140:143], v[180:183], v[68:71]
    v_mfma_f32_16x16x32_bf16 v[76:79], v[144:147], v[176:179], v[76:79]
    v_mfma_f32_16x16x32_bf16 v[84:87], v[144:147], v[180:183], v[84:87]
    v_mfma_f32_16x16x32_bf16 v[92:95], v[148:151], v[176:179], v[92:95]
    v_mfma_f32_16x16x32_bf16 v[100:103], v[148:151], v[180:183], v[100:103]
    s_waitcnt lgkmcnt(0)
    s_waitcnt vmcnt(6)
    v_mfma_f32_16x16x32_bf16 v[8:11], v[104:107], v[184:187], v[8:11]
    ds_read_b128 v[128:131], v2 offset:43008
    v_mfma_f32_16x16x32_bf16 v[16:19], v[104:107], v[188:191], v[16:19]
    ds_read_b128 v[132:135], v2 offset:44032
    v_mfma_f32_16x16x32_bf16 v[24:27], v[108:111], v[184:187], v[24:27]
    ds_read_b128 v[136:139], v2 offset:45056
    v_mfma_f32_16x16x32_bf16 v[32:35], v[108:111], v[188:191], v[32:35]
    ds_read_b128 v[140:143], v2 offset:46080
    v_mfma_f32_16x16x32_bf16 v[40:43], v[112:115], v[184:187], v[40:43]
    ds_read_b128 v[144:147], v2 offset:47104
    v_mfma_f32_16x16x32_bf16 v[48:51], v[112:115], v[188:191], v[48:51]
    ds_read_b128 v[148:151], v2 offset:48128
    v_mfma_f32_16x16x32_bf16 v[56:59], v[116:119], v[184:187], v[56:59]
    v_mfma_f32_16x16x32_bf16 v[64:67], v[116:119], v[188:191], v[64:67]
    v_mfma_f32_16x16x32_bf16 v[72:75], v[120:123], v[184:187], v[72:75]
    v_mfma_f32_16x16x32_bf16 v[80:83], v[120:123], v[188:191], v[80:83]
    v_mfma_f32_16x16x32_bf16 v[88:91], v[124:127], v[184:187], v[88:91]
    v_mfma_f32_16x16x32_bf16 v[96:99], v[124:127], v[188:191], v[96:99]
    s_waitcnt lgkmcnt(0)
    v_mfma_f32_16x16x32_bf16 v[12:15], v[128:131], v[184:187], v[12:15]
    ds_read_b128 v[104:107], v2 offset:49152
    v_mfma_f32_16x16x32_bf16 v[20:23], v[128:131], v[188:191], v[20:23]
    ds_read_b128 v[108:111], v2 offset:50176
    v_mfma_f32_16x16x32_bf16 v[28:31], v[132:135], v[184:187], v[28:31]
    ds_read_b128 v[112:115], v2 offset:51200
    v_mfma_f32_16x16x32_bf16 v[36:39], v[132:135], v[188:191], v[36:39]
    ds_read_b128 v[116:119], v2 offset:52224
    v_mfma_f32_16x16x32_bf16 v[44:47], v[136:139], v[184:187], v[44:47]
    ds_read_b128 v[120:123], v2 offset:53248
    v_mfma_f32_16x16x32_bf16 v[52:55], v[136:139], v[188:191], v[52:55]
    ds_read_b128 v[124:127], v2 offset:54272
    v_mfma_f32_16x16x32_bf16 v[60:63], v[140:143], v[184:187], v[60:63]
    v_mfma_f32_16x16x32_bf16 v[68:71], v[140:143], v[188:191], v[68:71]
    v_mfma_f32_16x16x32_bf16 v[76:79], v[144:147], v[184:187], v[76:79]
    v_mfma_f32_16x16x32_bf16 v[84:87], v[144:147], v[188:191], v[84:87]
    v_mfma_f32_16x16x32_bf16 v[92:95], v[148:151], v[184:187], v[92:95]
    v_mfma_f32_16x16x32_bf16 v[100:103], v[148:151], v[188:191], v[100:103]
    s_waitcnt lgkmcnt(0)
    s_waitcnt vmcnt(4)
    v_mfma_f32_16x16x32_bf16 v[8:11], v[104:107], v[192:195], v[8:11]
    ds_read_b128 v[128:131], v2 offset:55296
    v_mfma_f32_16x16x32_bf16 v[16:19], v[104:107], v[196:199], v[16:19]
    ds_read_b128 v[132:135], v2 offset:56320
    v_mfma_f32_16x16x32_bf16 v[24:27], v[108:111], v[192:195], v[24:27]
    ds_read_b128 v[136:139], v2 offset:57344
    v_mfma_f32_16x16x32_bf16 v[32:35], v[108:111], v[196:199], v[32:35]
    ds_read_b128 v[140:143], v2 offset:58368
    v_mfma_f32_16x16x32_bf16 v[40:43], v[112:115], v[192:195], v[40:43]
    ds_read_b128 v[144:147], v2 offset:59392
    v_mfma_f32_16x16x32_bf16 v[48:51], v[112:115], v[196:199], v[48:51]
    ds_read_b128 v[148:151], v2 offset:60416
    v_mfma_f32_16x16x32_bf16 v[56:59], v[116:119], v[192:195], v[56:59]
    v_mfma_f32_16x16x32_bf16 v[64:67], v[116:119], v[196:199], v[64:67]
    v_mfma_f32_16x16x32_bf16 v[72:75], v[120:123], v[192:195], v[72:75]
    v_mfma_f32_16x16x32_bf16 v[80:83], v[120:123], v[196:199], v[80:83]
    v_mfma_f32_16x16x32_bf16 v[88:91], v[124:127], v[192:195], v[88:91]
    v_mfma_f32_16x16x32_bf16 v[96:99], v[124:127], v[196:199], v[96:99]
    s_waitcnt lgkmcnt(0)
    s_barrier
    v_mfma_f32_16x16x32_bf16 v[12:15], v[128:131], v[192:195], v[12:15]
    ds_read_b128 v[104:107], v3 offset:0
    v_mfma_f32_16x16x32_bf16 v[20:23], v[128:131], v[196:199], v[20:23]
    ds_read_b128 v[108:111], v3 offset:1024
    v_mfma_f32_16x16x32_bf16 v[28:31], v[132:135], v[192:195], v[28:31]
    ds_read_b128 v[112:115], v3 offset:2048
    v_mfma_f32_16x16x32_bf16 v[36:39], v[132:135], v[196:199], v[36:39]
    ds_read_b128 v[116:119], v3 offset:3072
    v_mfma_f32_16x16x32_bf16 v[44:47], v[136:139], v[192:195], v[44:47]
    ds_read_b128 v[120:123], v3 offset:4096
    v_mfma_f32_16x16x32_bf16 v[52:55], v[136:139], v[196:199], v[52:55]
    ds_read_b128 v[124:127], v3 offset:5120
    v_mfma_f32_16x16x32_bf16 v[60:63], v[140:143], v[192:195], v[60:63]
    v_mfma_f32_16x16x32_bf16 v[68:71], v[140:143], v[196:199], v[68:71]
    v_mfma_f32_16x16x32_bf16 v[76:79], v[144:147], v[192:195], v[76:79]
    v_mfma_f32_16x16x32_bf16 v[84:87], v[144:147], v[196:199], v[84:87]
    v_mfma_f32_16x16x32_bf16 v[92:95], v[148:151], v[192:195], v[92:95]
    v_mfma_f32_16x16x32_bf16 v[100:103], v[148:151], v[196:199], v[100:103]
    s_waitcnt lgkmcnt(0)
    s_waitcnt vmcnt(2)
    v_mfma_f32_16x16x32_bf16 v[8:11], v[104:107], v[152:155], v[8:11]
    ds_read_b128 v[128:131], v3 offset:6144
    v_mfma_f32_16x16x32_bf16 v[16:19], v[104:107], v[156:159], v[16:19]
    ds_read_b128 v[132:135], v3 offset:7168
    v_mfma_f32_16x16x32_bf16 v[24:27], v[108:111], v[152:155], v[24:27]
    ds_read_b128 v[136:139], v3 offset:8192
    v_mfma_f32_16x16x32_bf16 v[32:35], v[108:111], v[156:159], v[32:35]
    ds_read_b128 v[140:143], v3 offset:9216
    v_mfma_f32_16x16x32_bf16 v[40:43], v[112:115], v[152:155], v[40:43]
    ds_read_b128 v[144:147], v3 offset:10240
    v_mfma_f32_16x16x32_bf16 v[48:51], v[112:115], v[156:159], v[48:51]
    ds_read_b128 v[148:151], v3 offset:11264
    v_mfma_f32_16x16x32_bf16 v[56:59], v[116:119], v[152:155], v[56:59]
    v_mfma_f32_16x16x32_bf16 v[64:67], v[116:119], v[156:159], v[64:67]
    v_mfma_f32_16x16x32_bf16 v[72:75], v[120:123], v[152:155], v[72:75]
    v_mfma_f32_16x16x32_bf16 v[80:83], v[120:123], v[156:159], v[80:83]
    v_mfma_f32_16x16x32_bf16 v[88:91], v[124:127], v[152:155], v[88:91]
    v_mfma_f32_16x16x32_bf16 v[96:99], v[124:127], v[156:159], v[96:99]
    s_waitcnt lgkmcnt(0)
    v_mfma_f32_16x16x32_bf16 v[12:15], v[128:131], v[152:155], v[12:15]
    ds_read_b128 v[104:107], v3 offset:12288
    v_mfma_f32_16x16x32_bf16 v[20:23], v[128:131], v[156:159], v[20:23]
    ds_read_b128 v[108:111], v3 offset:13312
    v_mfma_f32_16x16x32_bf16 v[28:31], v[132:135], v[152:155], v[28:31]
    ds_read_b128 v[112:115], v3 offset:14336
    v_mfma_f32_16x16x32_bf16 v[36:39], v[132:135], v[156:159], v[36:39]
    ds_read_b128 v[116:119], v3 offset:15360
    v_mfma_f32_16x16x32_bf16 v[44:47], v[136:139], v[152:155], v[44:47]
    ds_read_b128 v[120:123], v3 offset:16384
    v_mfma_f32_16x16x32_bf16 v[52:55], v[136:139], v[156:159], v[52:55]
    ds_read_b128 v[124:127], v3 offset:17408
    v_mfma_f32_16x16x32_bf16 v[60:63], v[140:143], v[152:155], v[60:63]
    v_mfma_f32_16x16x32_bf16 v[68:71], v[140:143], v[156:159], v[68:71]
    v_mfma_f32_16x16x32_bf16 v[76:79], v[144:147], v[152:155], v[76:79]
    v_mfma_f32_16x16x32_bf16 v[84:87], v[144:147], v[156:159], v[84:87]
    v_mfma_f32_16x16x32_bf16 v[92:95], v[148:151], v[152:155], v[92:95]
    v_mfma_f32_16x16x32_bf16 v[100:103], v[148:151], v[156:159], v[100:103]
    s_waitcnt lgkmcnt(0)
    s_waitcnt vmcnt(0)
    v_mfma_f32_16x16x32_bf16 v[8:11], v[104:107], v[160:163], v[8:11]
    ds_read_b128 v[128:131], v3 offset:18432
    v_mfma_f32_16x16x32_bf16 v[16:19], v[104:107], v[164:167], v[16:19]
    ds_read_b128 v[132:135], v3 offset:19456
    v_mfma_f32_16x16x32_bf16 v[24:27], v[108:111], v[160:163], v[24:27]
    ds_read_b128 v[136:139], v3 offset:20480
    v_mfma_f32_16x16x32_bf16 v[32:35], v[108:111], v[164:167], v[32:35]
    ds_read_b128 v[140:143], v3 offset:21504
    v_mfma_f32_16x16x32_bf16 v[40:43], v[112:115], v[160:163], v[40:43]
    ds_read_b128 v[144:147], v3 offset:22528
    v_mfma_f32_16x16x32_bf16 v[48:51], v[112:115], v[164:167], v[48:51]
    ds_read_b128 v[148:151], v3 offset:23552
    v_mfma_f32_16x16x32_bf16 v[56:59], v[116:119], v[160:163], v[56:59]
    v_mfma_f32_16x16x32_bf16 v[64:67], v[116:119], v[164:167], v[64:67]
    v_mfma_f32_16x16x32_bf16 v[72:75], v[120:123], v[160:163], v[72:75]
    v_mfma_f32_16x16x32_bf16 v[80:83], v[120:123], v[164:167], v[80:83]
    v_mfma_f32_16x16x32_bf16 v[88:91], v[124:127], v[160:163], v[88:91]
    v_mfma_f32_16x16x32_bf16 v[96:99], v[124:127], v[164:167], v[96:99]
    s_waitcnt lgkmcnt(0)
    s_barrier
    v_mfma_f32_16x16x32_bf16 v[12:15], v[128:131], v[160:163], v[12:15]
    v_mfma_f32_16x16x32_bf16 v[20:23], v[128:131], v[164:167], v[20:23]
    v_mfma_f32_16x16x32_bf16 v[28:31], v[132:135], v[160:163], v[28:31]
    v_mfma_f32_16x16x32_bf16 v[36:39], v[132:135], v[164:167], v[36:39]
    v_mfma_f32_16x16x32_bf16 v[44:47], v[136:139], v[160:163], v[44:47]
    v_mfma_f32_16x16x32_bf16 v[52:55], v[136:139], v[164:167], v[52:55]
    v_mfma_f32_16x16x32_bf16 v[60:63], v[140:143], v[160:163], v[60:63]
    v_mfma_f32_16x16x32_bf16 v[68:71], v[140:143], v[164:167], v[68:71]
    v_mfma_f32_16x16x32_bf16 v[76:79], v[144:147], v[160:163], v[76:79]
    v_mfma_f32_16x16x32_bf16 v[84:87], v[144:147], v[164:167], v[84:87]
    v_mfma_f32_16x16x32_bf16 v[92:95], v[148:151], v[160:163], v[92:95]
    v_mfma_f32_16x16x32_bf16 v[100:103], v[148:151], v[164:167], v[100:103]
    s_mul_i32 s52, s43, 49152
    s_mul_i32 s47, s33, 3072
    s_add_u32 s52, s52, s47
    v_pk_fma_f32 v[8:9], v[208:209], v[200:201], v[8:9] op_sel_hi:[1,0,1]
    v_pk_fma_f32 v[10:11], v[210:211], v[200:201], v[10:11] op_sel_hi:[1,0,1]
    v_pk_fma_f32 v[24:25], v[212:213], v[200:201], v[24:25] op_sel_hi:[1,0,1]
    v_pk_fma_f32 v[26:27], v[214:215], v[200:201], v[26:27] op_sel_hi:[1,0,1]
    v_pk_fma_f32 v[40:41], v[216:217], v[200:201], v[40:41] op_sel_hi:[1,0,1]
    v_pk_fma_f32 v[42:43], v[218:219], v[200:201], v[42:43] op_sel_hi:[1,0,1]
    v_pk_mul_f32 v[104:105], v[8:9], v[8:9]
    v_pk_mul_f32 v[106:107], v[10:11], v[10:11]
    v_pk_mul_f32 v[108:109], v[24:25], v[24:25]
    v_pk_mul_f32 v[110:111], v[26:27], v[26:27]
    v_pk_mul_f32 v[112:113], v[40:41], v[40:41]
    v_pk_mul_f32 v[114:115], v[42:43], v[42:43]
    v_pk_fma_f32 v[104:105], v[104:105], v[202:203], v[200:201] op_sel:[0,0,1] op_sel_hi:[1,0,1]
    v_pk_fma_f32 v[106:107], v[106:107], v[202:203], v[200:201] op_sel:[0,0,1] op_sel_hi:[1,0,1]
    v_pk_fma_f32 v[108:109], v[108:109], v[202:203], v[200:201] op_sel:[0,0,1] op_sel_hi:[1,0,1]
    v_pk_fma_f32 v[110:111], v[110:111], v[202:203], v[200:201] op_sel:[0,0,1] op_sel_hi:[1,0,1]
    v_pk_fma_f32 v[112:113], v[112:113], v[202:203], v[200:201] op_sel:[0,0,1] op_sel_hi:[1,0,1]
    v_pk_fma_f32 v[114:115], v[114:115], v[202:203], v[200:201] op_sel:[0,0,1] op_sel_hi:[1,0,1]
    v_pk_mul_f32 v[104:105], v[104:105], v[8:9]
    v_pk_mul_f32 v[106:107], v[106:107], v[10:11]
    v_pk_mul_f32 v[108:109], v[108:109], v[24:25]
    v_pk_mul_f32 v[110:111], v[110:111], v[26:27]
    v_pk_mul_f32 v[112:113], v[112:113], v[40:41]
    v_pk_mul_f32 v[114:115], v[114:115], v[42:43]
    v_exp_f32 v104, v104
    v_exp_f32 v105, v105
    v_pk_fma_f32 v[56:57], v[220:221], v[200:201], v[56:57] op_sel_hi:[1,0,1]
    v_exp_f32 v106, v106
    v_exp_f32 v107, v107
    v_pk_fma_f32 v[58:59], v[222:223], v[200:201], v[58:59] op_sel_hi:[1,0,1]
    v_exp_f32 v108, v108
    v_exp_f32 v109, v109
    v_pk_fma_f32 v[72:73], v[224:225], v[200:201], v[72:73] op_sel_hi:[1,0,1]
    v_exp_f32 v110, v110
    v_exp_f32 v111, v111
    v_pk_fma_f32 v[74:75], v[226:227], v[200:201], v[74:75] op_sel_hi:[1,0,1]
    v_exp_f32 v112, v112
    v_exp_f32 v113, v113
    v_pk_fma_f32 v[88:89], v[228:229], v[200:201], v[88:89] op_sel_hi:[1,0,1]
    v_exp_f32 v114, v114
    v_exp_f32 v115, v115
    v_pk_fma_f32 v[90:91], v[230:231], v[200:201], v[90:91] op_sel_hi:[1,0,1]
    v_pk_fma_f32 v[104:105], v[104:105], v[202:203], v[202:203] op_sel:[0,1,1] op_sel_hi:[1,1,1]
    v_pk_fma_f32 v[106:107], v[106:107], v[202:203], v[202:203] op_sel:[0,1,1] op_sel_hi:[1,1,1]
    v_pk_fma_f32 v[108:109], v[108:109], v[202:203], v[202:203] op_sel:[0,1,1] op_sel_hi:[1,1,1]
    v_pk_fma_f32 v[110:111], v[110:111], v[202:203], v[202:203] op_sel:[0,1,1] op_sel_hi:[1,1,1]
    v_pk_fma_f32 v[112:113], v[112:113], v[202:203], v[202:203] op_sel:[0,1,1] op_sel_hi:[1,1,1]
    v_pk_fma_f32 v[114:115], v[114:115], v[202:203], v[202:203] op_sel:[0,1,1] op_sel_hi:[1,1,1]
    v_rcp_f32 v104, v104
    v_rcp_f32 v105, v105
    v_pk_mul_f32 v[8:9], v[8:9], v[56:57]
    v_rcp_f32 v106, v106
    v_rcp_f32 v107, v107
    v_pk_mul_f32 v[10:11], v[10:11], v[58:59]
    v_rcp_f32 v108, v108
    v_rcp_f32 v109, v109
    v_pk_mul_f32 v[24:25], v[24:25], v[72:73]
    v_rcp_f32 v110, v110
    v_rcp_f32 v111, v111
    v_pk_mul_f32 v[26:27], v[26:27], v[74:75]
    v_rcp_f32 v112, v112
    v_rcp_f32 v113, v113
    v_pk_mul_f32 v[40:41], v[40:41], v[88:89]
    v_rcp_f32 v114, v114
    v_rcp_f32 v115, v115
    v_pk_mul_f32 v[42:43], v[42:43], v[90:91]
    v_pk_mul_f32 v[8:9], v[8:9], v[104:105]
    v_pk_mul_f32 v[10:11], v[10:11], v[106:107]
    v_pk_mul_f32 v[24:25], v[24:25], v[108:109]
    v_pk_mul_f32 v[26:27], v[26:27], v[110:111]
    v_pk_mul_f32 v[40:41], v[40:41], v[112:113]
    v_pk_mul_f32 v[42:43], v[42:43], v[114:115]
    v_cvt_pk_bf16_f32 v152, v8, v9
    v_cvt_pk_bf16_f32 v153, v10, v11
    v_cvt_pk_bf16_f32 v154, v24, v25
    v_cvt_pk_bf16_f32 v155, v26, v27
    v_cvt_pk_bf16_f32 v156, v40, v41
    v_cvt_pk_bf16_f32 v157, v42, v43
    buffer_store_dwordx4 v[152:155], v4, s[16:19], s52 offen offset:0
    v_pk_fma_f32 v[12:13], v[232:233], v[200:201], v[12:13] op_sel_hi:[1,0,1]
    v_pk_fma_f32 v[14:15], v[234:235], v[200:201], v[14:15] op_sel_hi:[1,0,1]
    v_pk_fma_f32 v[28:29], v[236:237], v[200:201], v[28:29] op_sel_hi:[1,0,1]
    v_pk_fma_f32 v[30:31], v[238:239], v[200:201], v[30:31] op_sel_hi:[1,0,1]
    v_pk_fma_f32 v[44:45], v[240:241], v[200:201], v[44:45] op_sel_hi:[1,0,1]
    v_pk_fma_f32 v[46:47], v[242:243], v[200:201], v[46:47] op_sel_hi:[1,0,1]
    v_pk_mul_f32 v[104:105], v[12:13], v[12:13]
    v_pk_mul_f32 v[106:107], v[14:15], v[14:15]
    v_pk_mul_f32 v[108:109], v[28:29], v[28:29]
    v_pk_mul_f32 v[110:111], v[30:31], v[30:31]
    v_pk_mul_f32 v[112:113], v[44:45], v[44:45]
    v_pk_mul_f32 v[114:115], v[46:47], v[46:47]
    v_pk_fma_f32 v[104:105], v[104:105], v[202:203], v[200:201] op_sel:[0,0,1] op_sel_hi:[1,0,1]
    v_pk_fma_f32 v[106:107], v[106:107], v[202:203], v[200:201] op_sel:[0,0,1] op_sel_hi:[1,0,1]
    v_pk_fma_f32 v[108:109], v[108:109], v[202:203], v[200:201] op_sel:[0,0,1] op_sel_hi:[1,0,1]
    v_pk_fma_f32 v[110:111], v[110:111], v[202:203], v[200:201] op_sel:[0,0,1] op_sel_hi:[1,0,1]
    v_pk_fma_f32 v[112:113], v[112:113], v[202:203], v[200:201] op_sel:[0,0,1] op_sel_hi:[1,0,1]
    v_pk_fma_f32 v[114:115], v[114:115], v[202:203], v[200:201] op_sel:[0,0,1] op_sel_hi:[1,0,1]
    v_pk_mul_f32 v[104:105], v[104:105], v[12:13]
    v_pk_mul_f32 v[106:107], v[106:107], v[14:15]
    v_pk_mul_f32 v[108:109], v[108:109], v[28:29]
    v_pk_mul_f32 v[110:111], v[110:111], v[30:31]
    v_pk_mul_f32 v[112:113], v[112:113], v[44:45]
    v_pk_mul_f32 v[114:115], v[114:115], v[46:47]
    v_exp_f32 v104, v104
    v_exp_f32 v105, v105
    v_pk_fma_f32 v[60:61], v[244:245], v[200:201], v[60:61] op_sel_hi:[1,0,1]
    v_exp_f32 v106, v106
    v_exp_f32 v107, v107
    v_pk_fma_f32 v[62:63], v[246:247], v[200:201], v[62:63] op_sel_hi:[1,0,1]
    v_exp_f32 v108, v108
    v_exp_f32 v109, v109
    v_pk_fma_f32 v[76:77], v[248:249], v[200:201], v[76:77] op_sel_hi:[1,0,1]
    v_exp_f32 v110, v110
    v_exp_f32 v111, v111
    v_pk_fma_f32 v[78:79], v[250:251], v[200:201], v[78:79] op_sel_hi:[1,0,1]
    v_exp_f32 v112, v112
    v_exp_f32 v113, v113
    v_pk_fma_f32 v[92:93], v[252:253], v[200:201], v[92:93] op_sel_hi:[1,0,1]
    v_exp_f32 v114, v114
    v_exp_f32 v115, v115
    v_pk_fma_f32 v[94:95], v[254:255], v[200:201], v[94:95] op_sel_hi:[1,0,1]
    v_pk_fma_f32 v[104:105], v[104:105], v[202:203], v[202:203] op_sel:[0,1,1] op_sel_hi:[1,1,1]
    v_pk_fma_f32 v[106:107], v[106:107], v[202:203], v[202:203] op_sel:[0,1,1] op_sel_hi:[1,1,1]
    v_pk_fma_f32 v[108:109], v[108:109], v[202:203], v[202:203] op_sel:[0,1,1] op_sel_hi:[1,1,1]
    v_pk_fma_f32 v[110:111], v[110:111], v[202:203], v[202:203] op_sel:[0,1,1] op_sel_hi:[1,1,1]
    v_pk_fma_f32 v[112:113], v[112:113], v[202:203], v[202:203] op_sel:[0,1,1] op_sel_hi:[1,1,1]
    v_pk_fma_f32 v[114:115], v[114:115], v[202:203], v[202:203] op_sel:[0,1,1] op_sel_hi:[1,1,1]
    v_rcp_f32 v104, v104
    v_rcp_f32 v105, v105
    v_pk_mul_f32 v[12:13], v[12:13], v[60:61]
    v_rcp_f32 v106, v106
    v_rcp_f32 v107, v107
    v_pk_mul_f32 v[14:15], v[14:15], v[62:63]
    v_rcp_f32 v108, v108
    v_rcp_f32 v109, v109
    v_pk_mul_f32 v[28:29], v[28:29], v[76:77]
    v_rcp_f32 v110, v110
    v_rcp_f32 v111, v111
    v_pk_mul_f32 v[30:31], v[30:31], v[78:79]
    v_rcp_f32 v112, v112
    v_rcp_f32 v113, v113
    v_pk_mul_f32 v[44:45], v[44:45], v[92:93]
    v_rcp_f32 v114, v114
    v_rcp_f32 v115, v115
    v_pk_mul_f32 v[46:47], v[46:47], v[94:95]
    v_pk_mul_f32 v[12:13], v[12:13], v[104:105]
    v_pk_mul_f32 v[14:15], v[14:15], v[106:107]
    v_pk_mul_f32 v[28:29], v[28:29], v[108:109]
    v_pk_mul_f32 v[30:31], v[30:31], v[110:111]
    v_pk_mul_f32 v[44:45], v[44:45], v[112:113]
    v_pk_mul_f32 v[46:47], v[46:47], v[114:115]
    v_cvt_pk_bf16_f32 v158, v12, v13
    v_cvt_pk_bf16_f32 v159, v14, v15
    v_cvt_pk_bf16_f32 v160, v28, v29
    v_cvt_pk_bf16_f32 v161, v30, v31
    v_cvt_pk_bf16_f32 v162, v44, v45
    v_cvt_pk_bf16_f32 v163, v46, v47
    buffer_store_dwordx4 v[156:159], v4, s[16:19], s52 offen offset:1024
    buffer_store_dwordx4 v[160:163], v4, s[16:19], s52 offen offset:2048
    s_add_u32 s52, s52, 49152
    v_pk_fma_f32 v[16:17], v[208:209], v[204:205], v[16:17] op_sel_hi:[1,0,1]
    v_pk_fma_f32 v[18:19], v[210:211], v[204:205], v[18:19] op_sel_hi:[1,0,1]
    v_pk_fma_f32 v[32:33], v[212:213], v[204:205], v[32:33] op_sel_hi:[1,0,1]
    v_pk_fma_f32 v[34:35], v[214:215], v[204:205], v[34:35] op_sel_hi:[1,0,1]
    v_pk_fma_f32 v[48:49], v[216:217], v[204:205], v[48:49] op_sel_hi:[1,0,1]
    v_pk_fma_f32 v[50:51], v[218:219], v[204:205], v[50:51] op_sel_hi:[1,0,1]
    v_pk_mul_f32 v[104:105], v[16:17], v[16:17]
    v_pk_mul_f32 v[106:107], v[18:19], v[18:19]
    v_pk_mul_f32 v[108:109], v[32:33], v[32:33]
    v_pk_mul_f32 v[110:111], v[34:35], v[34:35]
    v_pk_mul_f32 v[112:113], v[48:49], v[48:49]
    v_pk_mul_f32 v[114:115], v[50:51], v[50:51]
    v_pk_fma_f32 v[104:105], v[104:105], v[206:207], v[204:205] op_sel:[0,0,1] op_sel_hi:[1,0,1]
    v_pk_fma_f32 v[106:107], v[106:107], v[206:207], v[204:205] op_sel:[0,0,1] op_sel_hi:[1,0,1]
    v_pk_fma_f32 v[108:109], v[108:109], v[206:207], v[204:205] op_sel:[0,0,1] op_sel_hi:[1,0,1]
    v_pk_fma_f32 v[110:111], v[110:111], v[206:207], v[204:205] op_sel:[0,0,1] op_sel_hi:[1,0,1]
    v_pk_fma_f32 v[112:113], v[112:113], v[206:207], v[204:205] op_sel:[0,0,1] op_sel_hi:[1,0,1]
    v_pk_fma_f32 v[114:115], v[114:115], v[206:207], v[204:205] op_sel:[0,0,1] op_sel_hi:[1,0,1]
    v_pk_mul_f32 v[104:105], v[104:105], v[16:17]
    v_pk_mul_f32 v[106:107], v[106:107], v[18:19]
    v_pk_mul_f32 v[108:109], v[108:109], v[32:33]
    v_pk_mul_f32 v[110:111], v[110:111], v[34:35]
    v_pk_mul_f32 v[112:113], v[112:113], v[48:49]
    v_pk_mul_f32 v[114:115], v[114:115], v[50:51]
    v_exp_f32 v104, v104
    v_exp_f32 v105, v105
    v_pk_fma_f32 v[64:65], v[220:221], v[204:205], v[64:65] op_sel_hi:[1,0,1]
    v_exp_f32 v106, v106
    v_exp_f32 v107, v107
    v_pk_fma_f32 v[66:67], v[222:223], v[204:205], v[66:67] op_sel_hi:[1,0,1]
    v_exp_f32 v108, v108
    v_exp_f32 v109, v109
    v_pk_fma_f32 v[80:81], v[224:225], v[204:205], v[80:81] op_sel_hi:[1,0,1]
    v_exp_f32 v110, v110
    v_exp_f32 v111, v111
    v_pk_fma_f32 v[82:83], v[226:227], v[204:205], v[82:83] op_sel_hi:[1,0,1]
    v_exp_f32 v112, v112
    v_exp_f32 v113, v113
    v_pk_fma_f32 v[96:97], v[228:229], v[204:205], v[96:97] op_sel_hi:[1,0,1]
    v_exp_f32 v114, v114
    v_exp_f32 v115, v115
    v_pk_fma_f32 v[98:99], v[230:231], v[204:205], v[98:99] op_sel_hi:[1,0,1]
    v_pk_fma_f32 v[104:105], v[104:105], v[206:207], v[206:207] op_sel:[0,1,1] op_sel_hi:[1,1,1]
    v_pk_fma_f32 v[106:107], v[106:107], v[206:207], v[206:207] op_sel:[0,1,1] op_sel_hi:[1,1,1]
    v_pk_fma_f32 v[108:109], v[108:109], v[206:207], v[206:207] op_sel:[0,1,1] op_sel_hi:[1,1,1]
    v_pk_fma_f32 v[110:111], v[110:111], v[206:207], v[206:207] op_sel:[0,1,1] op_sel_hi:[1,1,1]
    v_pk_fma_f32 v[112:113], v[112:113], v[206:207], v[206:207] op_sel:[0,1,1] op_sel_hi:[1,1,1]
    v_pk_fma_f32 v[114:115], v[114:115], v[206:207], v[206:207] op_sel:[0,1,1] op_sel_hi:[1,1,1]
    v_rcp_f32 v104, v104
    v_rcp_f32 v105, v105
    v_pk_mul_f32 v[16:17], v[16:17], v[64:65]
    v_rcp_f32 v106, v106
    v_rcp_f32 v107, v107
    v_pk_mul_f32 v[18:19], v[18:19], v[66:67]
    v_rcp_f32 v108, v108
    v_rcp_f32 v109, v109
    v_pk_mul_f32 v[32:33], v[32:33], v[80:81]
    v_rcp_f32 v110, v110
    v_rcp_f32 v111, v111
    v_pk_mul_f32 v[34:35], v[34:35], v[82:83]
    v_rcp_f32 v112, v112
    v_rcp_f32 v113, v113
    v_pk_mul_f32 v[48:49], v[48:49], v[96:97]
    v_rcp_f32 v114, v114
    v_rcp_f32 v115, v115
    v_pk_mul_f32 v[50:51], v[50:51], v[98:99]
    v_pk_mul_f32 v[16:17], v[16:17], v[104:105]
    v_pk_mul_f32 v[18:19], v[18:19], v[106:107]
    v_pk_mul_f32 v[32:33], v[32:33], v[108:109]
    v_pk_mul_f32 v[34:35], v[34:35], v[110:111]
    v_pk_mul_f32 v[48:49], v[48:49], v[112:113]
    v_pk_mul_f32 v[50:51], v[50:51], v[114:115]
    v_cvt_pk_bf16_f32 v164, v16, v17
    v_cvt_pk_bf16_f32 v165, v18, v19
    v_cvt_pk_bf16_f32 v166, v32, v33
    v_cvt_pk_bf16_f32 v167, v34, v35
    v_cvt_pk_bf16_f32 v168, v48, v49
    v_cvt_pk_bf16_f32 v169, v50, v51
    buffer_store_dwordx4 v[164:167], v4, s[16:19], s52 offen offset:0
    v_pk_fma_f32 v[20:21], v[232:233], v[204:205], v[20:21] op_sel_hi:[1,0,1]
    v_pk_fma_f32 v[22:23], v[234:235], v[204:205], v[22:23] op_sel_hi:[1,0,1]
    v_pk_fma_f32 v[36:37], v[236:237], v[204:205], v[36:37] op_sel_hi:[1,0,1]
    v_pk_fma_f32 v[38:39], v[238:239], v[204:205], v[38:39] op_sel_hi:[1,0,1]
    v_pk_fma_f32 v[52:53], v[240:241], v[204:205], v[52:53] op_sel_hi:[1,0,1]
    v_pk_fma_f32 v[54:55], v[242:243], v[204:205], v[54:55] op_sel_hi:[1,0,1]
    v_pk_mul_f32 v[104:105], v[20:21], v[20:21]
    v_pk_mul_f32 v[106:107], v[22:23], v[22:23]
    v_pk_mul_f32 v[108:109], v[36:37], v[36:37]
    v_pk_mul_f32 v[110:111], v[38:39], v[38:39]
    v_pk_mul_f32 v[112:113], v[52:53], v[52:53]
    v_pk_mul_f32 v[114:115], v[54:55], v[54:55]
    v_pk_fma_f32 v[104:105], v[104:105], v[206:207], v[204:205] op_sel:[0,0,1] op_sel_hi:[1,0,1]
    v_pk_fma_f32 v[106:107], v[106:107], v[206:207], v[204:205] op_sel:[0,0,1] op_sel_hi:[1,0,1]
    v_pk_fma_f32 v[108:109], v[108:109], v[206:207], v[204:205] op_sel:[0,0,1] op_sel_hi:[1,0,1]
    v_pk_fma_f32 v[110:111], v[110:111], v[206:207], v[204:205] op_sel:[0,0,1] op_sel_hi:[1,0,1]
    v_pk_fma_f32 v[112:113], v[112:113], v[206:207], v[204:205] op_sel:[0,0,1] op_sel_hi:[1,0,1]
    v_pk_fma_f32 v[114:115], v[114:115], v[206:207], v[204:205] op_sel:[0,0,1] op_sel_hi:[1,0,1]
    v_pk_mul_f32 v[104:105], v[104:105], v[20:21]
    v_pk_mul_f32 v[106:107], v[106:107], v[22:23]
    v_pk_mul_f32 v[108:109], v[108:109], v[36:37]
    v_pk_mul_f32 v[110:111], v[110:111], v[38:39]
    v_pk_mul_f32 v[112:113], v[112:113], v[52:53]
    v_pk_mul_f32 v[114:115], v[114:115], v[54:55]
    v_exp_f32 v104, v104
    v_exp_f32 v105, v105
    v_pk_fma_f32 v[68:69], v[244:245], v[204:205], v[68:69] op_sel_hi:[1,0,1]
    v_exp_f32 v106, v106
    v_exp_f32 v107, v107
    v_pk_fma_f32 v[70:71], v[246:247], v[204:205], v[70:71] op_sel_hi:[1,0,1]
    v_exp_f32 v108, v108
    v_exp_f32 v109, v109
    v_pk_fma_f32 v[84:85], v[248:249], v[204:205], v[84:85] op_sel_hi:[1,0,1]
    v_exp_f32 v110, v110
    v_exp_f32 v111, v111
    v_pk_fma_f32 v[86:87], v[250:251], v[204:205], v[86:87] op_sel_hi:[1,0,1]
    v_exp_f32 v112, v112
    v_exp_f32 v113, v113
    v_pk_fma_f32 v[100:101], v[252:253], v[204:205], v[100:101] op_sel_hi:[1,0,1]
    v_exp_f32 v114, v114
    v_exp_f32 v115, v115
    v_pk_fma_f32 v[102:103], v[254:255], v[204:205], v[102:103] op_sel_hi:[1,0,1]
    v_pk_fma_f32 v[104:105], v[104:105], v[206:207], v[206:207] op_sel:[0,1,1] op_sel_hi:[1,1,1]
    v_pk_fma_f32 v[106:107], v[106:107], v[206:207], v[206:207] op_sel:[0,1,1] op_sel_hi:[1,1,1]
    v_pk_fma_f32 v[108:109], v[108:109], v[206:207], v[206:207] op_sel:[0,1,1] op_sel_hi:[1,1,1]
    v_pk_fma_f32 v[110:111], v[110:111], v[206:207], v[206:207] op_sel:[0,1,1] op_sel_hi:[1,1,1]
    v_pk_fma_f32 v[112:113], v[112:113], v[206:207], v[206:207] op_sel:[0,1,1] op_sel_hi:[1,1,1]
    v_pk_fma_f32 v[114:115], v[114:115], v[206:207], v[206:207] op_sel:[0,1,1] op_sel_hi:[1,1,1]
    v_rcp_f32 v104, v104
    v_rcp_f32 v105, v105
    v_pk_mul_f32 v[20:21], v[20:21], v[68:69]
    v_rcp_f32 v106, v106
    v_rcp_f32 v107, v107
    v_pk_mul_f32 v[22:23], v[22:23], v[70:71]
    v_rcp_f32 v108, v108
    v_rcp_f32 v109, v109
    v_pk_mul_f32 v[36:37], v[36:37], v[84:85]
    v_rcp_f32 v110, v110
    v_rcp_f32 v111, v111
    v_pk_mul_f32 v[38:39], v[38:39], v[86:87]
    v_rcp_f32 v112, v112
    v_rcp_f32 v113, v113
    v_pk_mul_f32 v[52:53], v[52:53], v[100:101]
    v_rcp_f32 v114, v114
    v_rcp_f32 v115, v115
    v_pk_mul_f32 v[54:55], v[54:55], v[102:103]
    v_pk_mul_f32 v[20:21], v[20:21], v[104:105]
    v_pk_mul_f32 v[22:23], v[22:23], v[106:107]
    v_pk_mul_f32 v[36:37], v[36:37], v[108:109]
    v_pk_mul_f32 v[38:39], v[38:39], v[110:111]
    v_pk_mul_f32 v[52:53], v[52:53], v[112:113]
    v_pk_mul_f32 v[54:55], v[54:55], v[114:115]
    v_cvt_pk_bf16_f32 v170, v20, v21
    v_cvt_pk_bf16_f32 v171, v22, v23
    v_cvt_pk_bf16_f32 v172, v36, v37
    v_cvt_pk_bf16_f32 v173, v38, v39
    v_cvt_pk_bf16_f32 v174, v52, v53
    v_cvt_pk_bf16_f32 v175, v54, v55
    buffer_store_dwordx4 v[168:171], v4, s[16:19], s52 offen offset:1024
    buffer_store_dwordx4 v[172:175], v4, s[16:19], s52 offen offset:2048
    s_lshr_b32 s47, s43, 2
    s_and_b32 s49, s40, 1
    s_lshl1_add_u32 s49, s33, s49
    s_lshl_b32 s48, s47, 7
    s_add_u32 s48, s48, s68
    s_add_u32 s48, s48, 32768
    s_lshl2_add_u32 s48, s49, s48
    v_mov_b32 v8, 1
    v_mov_b32 v9, 0
    s_mov_b64 exec, 1
    s_cmp_eq_u32 s65, 0
    s_cbranch_scc1 sg_20
    s_waitcnt vmcnt(0)
    buffer_wbl2 sc1
    s_waitcnt vmcnt(0)
    buffer_store_dword v8, v9, s[24:27], s48 offen sc1
    s_branch sd_21
sg_20:
    s_waitcnt vmcnt(0)
    buffer_store_dword v8, v9, s[24:27], s48 offen
sd_21:
    s_mov_b64 exec, -1
    s_and_b32 s34, s2, 7
    s_lshr_b32 s35, s2, 3
    s_lshl_b32 s34, s34, 2
    s_lshr_b32 s33, s35, 3
    s_add_u32 s34, s34, s33
    s_lshl_b32 s32, s34, 6
    s_and_b32 s33, s35, 7
    s_add_u32 s4, s36, 0xa80000
    s_addc_u32 s5, s37, 0
    s_mov_b32 s6, 0x600000
    s_mov_b32 s7, 0x20000
    s_add_u32 s20, s36, 0x580000
    s_addc_u32 s21, s37, 0
    s_mov_b32 s22, 0x280000
    s_mov_b32 s23, 0x20000
    s_add_u32 s16, s36, 0x800000
    s_addc_u32 s17, s37, 0
    s_mov_b32 s18, 0x280000
    s_mov_b32 s19, 0x20000
    s_cmp_eq_u32 s94, 0
    s_cselect_b32 s16, s16, s66
    s_cselect_b32 s17, s17, s67
    v_lshlrev_b32 v4, 4, v0
    s_and_b32 s46, s40, 1
    s_lshr_b32 s57, s40, 1
    s_lshr_b32 s42, s32, 4
    s_lshl1_add_u32 s42, s46, s42
    s_mov_b32 s59, s42
    s_add_u32 s42, s42, s57
    s_xor_b32 s58, s42, 1
    s_mul_i32 s43, s42, 49152
    s_mul_i32 s58, s58, 49152
    s_lshl_b32 s46, s57, 10
    s_add_u32 s43, s43, s46
    s_add_u32 s58, s58, s46
    v_and_b32 v2, 15, v0
    v_lshrrev_b32 v3, 4, v0
    s_lshl_b32 s46, s42, 4
    v_add_u32 v5, s46, v2
    s_mul_i32 s45, s33, 5
    s_mul_i32 s47, s42, 20480
    s_add_u32 s48, s45, 0
    s_lshr_b32 s52, s48, 1
    s_lshl_b32 s52, s52, 10
    s_and_b32 s48, s48, 1
    s_lshl_b32 s48, s48, 3
    s_add_u32 s52, s52, s48
    s_add_u32 s52, s52, s47
    s_add_u32 s48, s45, 1
    s_lshr_b32 s53, s48, 1
    s_lshl_b32 s53, s53, 10
    s_and_b32 s48, s48, 1
    s_lshl_b32 s48, s48, 3
    s_add_u32 s53, s53, s48
    s_add_u32 s53, s53, s47
    s_add_u32 s48, s45, 2
    s_lshr_b32 s54, s48, 1
    s_lshl_b32 s54, s54, 10
    s_and_b32 s48, s48, 1
    s_lshl_b32 s48, s48, 3
    s_add_u32 s54, s54, s48
    s_add_u32 s54, s54, s47
    s_add_u32 s48, s45, 3
    s_lshr_b32 s55, s48, 1
    s_lshl_b32 s55, s55, 10
    s_and_b32 s48, s48, 1
    s_lshl_b32 s48, s48, 3
    s_add_u32 s55, s55, s48
    s_add_u32 s55, s55, s47
    s_add_u32 s48, s45, 4
    s_lshr_b32 s56, s48, 1
    s_lshl_b32 s56, s56, 10
    s_and_b32 s48, s48, 1
    s_lshl_b32 s48, s48, 3
    s_add_u32 s56, s56, s48
    s_add_u32 s56, s56, s47
    s_bitcmp1_b32 s33, 0
    s_cbranch_scc1 po_22
    buffer_load_dwordx4 v[136:139], v4, s[20:23], s52 offen sc1
    buffer_load_dwordx4 v[140:143], v4, s[20:23], s54 offen sc1
    buffer_load_dwordx2 v[144:145], v4, s[20:23], s56 offen sc1
    s_branch pz_23
po_22:
    buffer_load_dwordx2 v[136:137], v4, s[20:23], s52 offen sc1
    buffer_load_dwordx4 v[138:141], v4, s[20:23], s53 offen sc1
    buffer_load_dwordx4 v[142:145], v4, s[20:23], s55 offen sc1
pz_23:
    s_lshr_b32 s47, s32, 6
    s_lshl_b32 s48, s47, 7
    s_add_u32 s48, s48, s68
    s_add_u32 s48, s48, 32768
    v_and_b32 v6, 31, v0
    v_lshlrev_b32 v6, 2, v6
    s_cmp_eq_u32 s65, 0
    s_cbranch_scc1 pf_25
    s_mov_b32 s95, 0x100000
pl_27:
    buffer_load_dword v7, v6, s[24:27], s48 offen sc1
    s_sub_u32 s95, s95, 1
    s_cbranch_scc1 pe_26
    s_waitcnt vmcnt(0)
    v_cmp_eq_u32 vcc, 0, v7
    s_nop 1
    s_cmp_lg_u64 vcc, 0
    s_cbranch_scc1 pl_27
pe_26:
    buffer_inv sc1
    s_branch pd_24
pf_25:
    s_mov_b32 s95, 0x100000
pl_28:
    buffer_load_dword v7, v6, s[24:27], s48 offen sc1
    s_sub_u32 s95, s95, 1
    s_cbranch_scc1 pd_24
    s_waitcnt vmcnt(0)
    v_cmp_eq_u32 vcc, 0, v7
    s_nop 1
    s_cmp_lg_u64 vcc, 0
    s_cbranch_scc1 pl_28
pd_24:
    buffer_load_dwordx4 v[96:99], v4, s[4:7], s43 offen offset:0 sc1
    buffer_load_dwordx4 v[100:103], v4, s[4:7], s58 offen offset:0 sc1
    buffer_load_dwordx4 v[104:107], v4, s[4:7], s43 offen offset:2048 sc1
    buffer_load_dwordx4 v[108:111], v4, s[4:7], s58 offen offset:2048 sc1
    s_add_u32 s43, s43, 4096
    s_add_u32 s58, s58, 4096
    buffer_load_dwordx4 v[112:115], v4, s[4:7], s43 offen offset:0 sc1
    buffer_load_dwordx4 v[116:119], v4, s[4:7], s58 offen offset:0 sc1
    buffer_load_dwordx4 v[120:123], v4, s[4:7], s43 offen offset:2048 sc1
    buffer_load_dwordx4 v[124:127], v4, s[4:7], s58 offen offset:2048 sc1
    s_add_u32 s43, s43, 4096
    s_add_u32 s58, s58, 4096
    buffer_load_dwordx4 v[128:131], v4, s[4:7], s43 offen offset:0 sc1
    buffer_load_dwordx4 v[132:135], v4, s[4:7], s58 offen offset:0 sc1
    s_mul_i32 s47, s57, 5120
    s_lshl_b32 s48, s57, 10
    v_add_u32 v146, s47, v4
    s_add_u32 s47, s47, 61440
    v_add_u32 v147, s47, v4
    s_add_u32 s47, s47, 61440
    v_add_u32 v148, s47, v4
    s_add_u32 s47, s47, 61440
    s_barrier
    ds_read_b128 v[56:59], v146 offset:0
    ds_read_b128 v[60:63], v146 offset:1024
    ds_read_b128 v[64:67], v146 offset:2048
    ds_read_b128 v[68:71], v146 offset:3072
    ds_read_b128 v[72:75], v146 offset:4096
    s_waitcnt lgkmcnt(0)
    ds_read_b128 v[76:79], v146 offset:10240
    ds_read_b128 v[80:83], v146 offset:11264
    s_waitcnt vmcnt(8)
    v_mfma_f32_16x16x32_bf16 v[32:35], v[56:59], v[100:103], 0
    ds_read_b128 v[84:87], v146 offset:12288
    v_mfma_f32_16x16x32_bf16 v[8:11], v[56:59], v[96:99], 0
    ds_read_b128 v[88:91], v146 offset:13312
    v_mfma_f32_16x16x32_bf16 v[36:39], v[60:63], v[100:103], 0
    ds_read_b128 v[92:95], v146 offset:14336
    v_mfma_f32_16x16x32_bf16 v[12:15], v[60:63], v[96:99], 0
    v_mfma_f32_16x16x32_bf16 v[40:43], v[64:67], v[100:103], 0
    v_mfma_f32_16x16x32_bf16 v[16:19], v[64:67], v[96:99], 0
    v_mfma_f32_16x16x32_bf16 v[44:47], v[68:71], v[100:103], 0
    v_mfma_f32_16x16x32_bf16 v[20:23], v[68:71], v[96:99], 0
    v_mfma_f32_16x16x32_bf16 v[48:51], v[72:75], v[100:103], 0
    v_mfma_f32_16x16x32_bf16 v[24:27], v[72:75], v[96:99], 0
    s_waitcnt lgkmcnt(0)
    s_barrier
    ds_read_b128 v[56:59], v146 offset:20480
    ds_read_b128 v[60:63], v146 offset:21504
    s_waitcnt vmcnt(6)
    v_mfma_f32_16x16x32_bf16 v[32:35], v[76:79], v[108:111], v[32:35]
    ds_read_b128 v[64:67], v146 offset:22528
    v_mfma_f32_16x16x32_bf16 v[8:11], v[76:79], v[104:107], v[8:11]
    ds_read_b128 v[68:71], v146 offset:23552
    v_mfma_f32_16x16x32_bf16 v[36:39], v[80:83], v[108:111], v[36:39]
    ds_read_b128 v[72:75], v146 offset:24576
    v_mfma_f32_16x16x32_bf16 v[12:15], v[80:83], v[104:107], v[12:15]
    buffer_load_dwordx4 v[96:99], v4, s[4:7], s43 offen offset:2048 sc1
    v_mfma_f32_16x16x32_bf16 v[40:43], v[84:87], v[108:111], v[40:43]
    v_mfma_f32_16x16x32_bf16 v[16:19], v[84:87], v[104:107], v[16:19]
    v_mfma_f32_16x16x32_bf16 v[44:47], v[88:91], v[108:111], v[44:47]
    v_mfma_f32_16x16x32_bf16 v[20:23], v[88:91], v[104:107], v[20:23]
    buffer_load_dwordx4 v[100:103], v4, s[4:7], s58 offen offset:2048 sc1
    v_mfma_f32_16x16x32_bf16 v[48:51], v[92:95], v[108:111], v[48:51]
    v_mfma_f32_16x16x32_bf16 v[24:27], v[92:95], v[104:107], v[24:27]
    s_waitcnt lgkmcnt(0)
    ds_read_b128 v[76:79], v146 offset:30720
    ds_read_b128 v[80:83], v146 offset:31744
    s_waitcnt vmcnt(6)
    v_mfma_f32_16x16x32_bf16 v[32:35], v[56:59], v[116:119], v[32:35]
    ds_read_b128 v[84:87], v146 offset:32768
    v_mfma_f32_16x16x32_bf16 v[8:11], v[56:59], v[112:115], v[8:11]
    ds_read_b128 v[88:91], v146 offset:33792
    v_mfma_f32_16x16x32_bf16 v[36:39], v[60:63], v[116:119], v[36:39]
    ds_read_b128 v[92:95], v146 offset:34816
    v_mfma_f32_16x16x32_bf16 v[12:15], v[60:63], v[112:115], v[12:15]
    s_add_u32 s43, s43, 4096
    s_add_u32 s58, s58, 4096
    buffer_load_dwordx4 v[104:107], v4, s[4:7], s43 offen offset:0 sc1
    v_mfma_f32_16x16x32_bf16 v[40:43], v[64:67], v[116:119], v[40:43]
    v_mfma_f32_16x16x32_bf16 v[16:19], v[64:67], v[112:115], v[16:19]
    v_mfma_f32_16x16x32_bf16 v[44:47], v[68:71], v[116:119], v[44:47]
    v_mfma_f32_16x16x32_bf16 v[20:23], v[68:71], v[112:115], v[20:23]
    buffer_load_dwordx4 v[108:111], v4, s[4:7], s58 offen offset:0 sc1
    v_mfma_f32_16x16x32_bf16 v[48:51], v[72:75], v[116:119], v[48:51]
    v_mfma_f32_16x16x32_bf16 v[24:27], v[72:75], v[112:115], v[24:27]
    s_waitcnt lgkmcnt(0)
    s_barrier
    ds_read_b128 v[56:59], v146 offset:40960
    ds_read_b128 v[60:63], v146 offset:41984
    s_waitcnt vmcnt(6)
    v_mfma_f32_16x16x32_bf16 v[32:35], v[76:79], v[124:127], v[32:35]
    ds_read_b128 v[64:67], v146 offset:43008
    v_mfma_f32_16x16x32_bf16 v[8:11], v[76:79], v[120:123], v[8:11]
    ds_read_b128 v[68:71], v146 offset:44032
    v_mfma_f32_16x16x32_bf16 v[36:39], v[80:83], v[124:127], v[36:39]
    ds_read_b128 v[72:75], v146 offset:45056
    v_mfma_f32_16x16x32_bf16 v[12:15], v[80:83], v[120:123], v[12:15]
    buffer_load_dwordx4 v[112:115], v4, s[4:7], s43 offen offset:2048 sc1
    v_mfma_f32_16x16x32_bf16 v[40:43], v[84:87], v[124:127], v[40:43]
    v_mfma_f32_16x16x32_bf16 v[16:19], v[84:87], v[120:123], v[16:19]
    v_mfma_f32_16x16x32_bf16 v[44:47], v[88:91], v[124:127], v[44:47]
    v_mfma_f32_16x16x32_bf16 v[20:23], v[88:91], v[120:123], v[20:23]
    buffer_load_dwordx4 v[116:119], v4, s[4:7], s58 offen offset:2048 sc1
    v_mfma_f32_16x16x32_bf16 v[48:51], v[92:95], v[124:127], v[48:51]
    v_mfma_f32_16x16x32_bf16 v[24:27], v[92:95], v[120:123], v[24:27]
    s_waitcnt lgkmcnt(0)
    ds_read_b128 v[76:79], v146 offset:51200
    ds_read_b128 v[80:83], v146 offset:52224
    s_waitcnt vmcnt(6)
    v_mfma_f32_16x16x32_bf16 v[32:35], v[56:59], v[132:135], v[32:35]
    ds_read_b128 v[84:87], v146 offset:53248
    v_mfma_f32_16x16x32_bf16 v[8:11], v[56:59], v[128:131], v[8:11]
    ds_read_b128 v[88:91], v146 offset:54272
    v_mfma_f32_16x16x32_bf16 v[36:39], v[60:63], v[132:135], v[36:39]
    ds_read_b128 v[92:95], v146 offset:55296
    v_mfma_f32_16x16x32_bf16 v[12:15], v[60:63], v[128:131], v[12:15]
    s_add_u32 s43, s43, 4096
    s_add_u32 s58, s58, 4096
    buffer_load_dwordx4 v[120:123], v4, s[4:7], s43 offen offset:0 sc1
    v_mfma_f32_16x16x32_bf16 v[40:43], v[64:67], v[132:135], v[40:43]
    v_mfma_f32_16x16x32_bf16 v[16:19], v[64:67], v[128:131], v[16:19]
    v_mfma_f32_16x16x32_bf16 v[44:47], v[68:71], v[132:135], v[44:47]
    v_mfma_f32_16x16x32_bf16 v[20:23], v[68:71], v[128:131], v[20:23]
    buffer_load_dwordx4 v[124:127], v4, s[4:7], s58 offen offset:0 sc1
    v_mfma_f32_16x16x32_bf16 v[48:51], v[72:75], v[132:135], v[48:51]
    v_mfma_f32_16x16x32_bf16 v[24:27], v[72:75], v[128:131], v[24:27]
    s_waitcnt lgkmcnt(0)
    s_barrier
    ds_read_b128 v[56:59], v147 offset:0
    ds_read_b128 v[60:63], v147 offset:1024
    s_waitcnt vmcnt(6)
    v_mfma_f32_16x16x32_bf16 v[32:35], v[76:79], v[100:103], v[32:35]
    ds_read_b128 v[64:67], v147 offset:2048
    v_mfma_f32_16x16x32_bf16 v[8:11], v[76:79], v[96:99], v[8:11]
    ds_read_b128 v[68:71], v147 offset:3072
    v_mfma_f32_16x16x32_bf16 v[36:39], v[80:83], v[100:103], v[36:39]
    ds_read_b128 v[72:75], v147 offset:4096
    v_mfma_f32_16x16x32_bf16 v[12:15], v[80:83], v[96:99], v[12:15]
    buffer_load_dwordx4 v[128:131], v4, s[4:7], s43 offen offset:2048 sc1
    v_mfma_f32_16x16x32_bf16 v[40:43], v[84:87], v[100:103], v[40:43]
    v_mfma_f32_16x16x32_bf16 v[16:19], v[84:87], v[96:99], v[16:19]
    v_mfma_f32_16x16x32_bf16 v[44:47], v[88:91], v[100:103], v[44:47]
    v_mfma_f32_16x16x32_bf16 v[20:23], v[88:91], v[96:99], v[20:23]
    buffer_load_dwordx4 v[132:135], v4, s[4:7], s58 offen offset:2048 sc1
    v_mfma_f32_16x16x32_bf16 v[48:51], v[92:95], v[100:103], v[48:51]
    v_mfma_f32_16x16x32_bf16 v[24:27], v[92:95], v[96:99], v[24:27]
    s_waitcnt lgkmcnt(0)
    ds_read_b128 v[76:79], v147 offset:10240
    ds_read_b128 v[80:83], v147 offset:11264
    s_waitcnt vmcnt(6)
    v_mfma_f32_16x16x32_bf16 v[32:35], v[56:59], v[108:111], v[32:35]
    ds_read_b128 v[84:87], v147 offset:12288
    v_mfma_f32_16x16x32_bf16 v[8:11], v[56:59], v[104:107], v[8:11]
    ds_read_b128 v[88:91], v147 offset:13312
    v_mfma_f32_16x16x32_bf16 v[36:39], v[60:63], v[108:111], v[36:39]
    ds_read_b128 v[92:95], v147 offset:14336
    v_mfma_f32_16x16x32_bf16 v[12:15], v[60:63], v[104:107], v[12:15]
    s_add_u32 s43, s43, 4096
    s_add_u32 s58, s58, 4096
    buffer_load_dwordx4 v[96:99], v4, s[4:7], s43 offen offset:0 sc1
    v_mfma_f32_16x16x32_bf16 v[40:43], v[64:67], v[108:111], v[40:43]
    v_mfma_f32_16x16x32_bf16 v[16:19], v[64:67], v[104:107], v[16:19]
    v_mfma_f32_16x16x32_bf16 v[44:47], v[68:71], v[108:111], v[44:47]
    v_mfma_f32_16x16x32_bf16 v[20:23], v[68:71], v[104:107], v[20:23]
    buffer_load_dwordx4 v[100:103], v4, s[4:7], s58 offen offset:0 sc1
    v_mfma_f32_16x16x32_bf16 v[48:51], v[72:75], v[108:111], v[48:51]
    v_mfma_f32_16x16x32_bf16 v[24:27], v[72:75], v[104:107], v[24:27]
    s_waitcnt lgkmcnt(0)
    s_barrier
    ds_read_b128 v[56:59], v147 offset:20480
    ds_read_b128 v[60:63], v147 offset:21504
    s_waitcnt vmcnt(6)
    v_mfma_f32_16x16x32_bf16 v[32:35], v[76:79], v[116:119], v[32:35]
    ds_read_b128 v[64:67], v147 offset:22528
    v_mfma_f32_16x16x32_bf16 v[8:11], v[76:79], v[112:115], v[8:11]
    ds_read_b128 v[68:71], v147 offset:23552
    v_mfma_f32_16x16x32_bf16 v[36:39], v[80:83], v[116:119], v[36:39]
    ds_read_b128 v[72:75], v147 offset:24576
    v_mfma_f32_16x16x32_bf16 v[12:15], v[80:83], v[112:115], v[12:15]
    buffer_load_dwordx4 v[104:107], v4, s[4:7], s43 offen offset:2048 sc1
    v_mfma_f32_16x16x32_bf16 v[40:43], v[84:87], v[116:119], v[40:43]
    v_mfma_f32_16x16x32_bf16 v[16:19], v[84:87], v[112:115], v[16:19]
    v_mfma_f32_16x16x32_bf16 v[44:47], v[88:91], v[116:119], v[44:47]
    v_mfma_f32_16x16x32_bf16 v[20:23], v[88:91], v[112:115], v[20:23]
    buffer_load_dwordx4 v[108:111], v4, s[4:7], s58 offen offset:2048 sc1
    v_mfma_f32_16x16x32_bf16 v[48:51], v[92:95], v[116:119], v[48:51]
    v_mfma_f32_16x16x32_bf16 v[24:27], v[92:95], v[112:115], v[24:27]
    s_waitcnt lgkmcnt(0)
    ds_read_b128 v[76:79], v147 offset:30720
    ds_read_b128 v[80:83], v147 offset:31744
    s_waitcnt vmcnt(6)
    v_mfma_f32_16x16x32_bf16 v[32:35], v[56:59], v[124:127], v[32:35]
    ds_read_b128 v[84:87], v147 offset:32768
    v_mfma_f32_16x16x32_bf16 v[8:11], v[56:59], v[120:123], v[8:11]
    ds_read_b128 v[88:91], v147 offset:33792
    v_mfma_f32_16x16x32_bf16 v[36:39], v[60:63], v[124:127], v[36:39]
    ds_read_b128 v[92:95], v147 offset:34816
    v_mfma_f32_16x16x32_bf16 v[12:15], v[60:63], v[120:123], v[12:15]
    s_add_u32 s43, s43, 4096
    s_add_u32 s58, s58, 4096
    buffer_load_dwordx4 v[112:115], v4, s[4:7], s43 offen offset:0 sc1
    v_mfma_f32_16x16x32_bf16 v[40:43], v[64:67], v[124:127], v[40:43]
    v_mfma_f32_16x16x32_bf16 v[16:19], v[64:67], v[120:123], v[16:19]
    v_mfma_f32_16x16x32_bf16 v[44:47], v[68:71], v[124:127], v[44:47]
    v_mfma_f32_16x16x32_bf16 v[20:23], v[68:71], v[120:123], v[20:23]
    buffer_load_dwordx4 v[116:119], v4, s[4:7], s58 offen offset:0 sc1
    v_mfma_f32_16x16x32_bf16 v[48:51], v[72:75], v[124:127], v[48:51]
    v_mfma_f32_16x16x32_bf16 v[24:27], v[72:75], v[120:123], v[24:27]
    s_waitcnt lgkmcnt(0)
    s_barrier
    ds_read_b128 v[56:59], v147 offset:40960
    ds_read_b128 v[60:63], v147 offset:41984
    s_waitcnt vmcnt(6)
    v_mfma_f32_16x16x32_bf16 v[32:35], v[76:79], v[132:135], v[32:35]
    ds_read_b128 v[64:67], v147 offset:43008
    v_mfma_f32_16x16x32_bf16 v[8:11], v[76:79], v[128:131], v[8:11]
    ds_read_b128 v[68:71], v147 offset:44032
    v_mfma_f32_16x16x32_bf16 v[36:39], v[80:83], v[132:135], v[36:39]
    ds_read_b128 v[72:75], v147 offset:45056
    v_mfma_f32_16x16x32_bf16 v[12:15], v[80:83], v[128:131], v[12:15]
    buffer_load_dwordx4 v[120:123], v4, s[4:7], s43 offen offset:2048 sc1
    v_mfma_f32_16x16x32_bf16 v[40:43], v[84:87], v[132:135], v[40:43]
    v_mfma_f32_16x16x32_bf16 v[16:19], v[84:87], v[128:131], v[16:19]
    v_mfma_f32_16x16x32_bf16 v[44:47], v[88:91], v[132:135], v[44:47]
    v_mfma_f32_16x16x32_bf16 v[20:23], v[88:91], v[128:131], v[20:23]
    buffer_load_dwordx4 v[124:127], v4, s[4:7], s58 offen offset:2048 sc1
    v_mfma_f32_16x16x32_bf16 v[48:51], v[92:95], v[132:135], v[48:51]
    v_mfma_f32_16x16x32_bf16 v[24:27], v[92:95], v[128:131], v[24:27]
    s_waitcnt lgkmcnt(0)
    ds_read_b128 v[76:79], v147 offset:51200
    ds_read_b128 v[80:83], v147 offset:52224
    s_waitcnt vmcnt(6)
    v_mfma_f32_16x16x32_bf16 v[32:35], v[56:59], v[100:103], v[32:35]
    ds_read_b128 v[84:87], v147 offset:53248
    v_mfma_f32_16x16x32_bf16 v[8:11], v[56:59], v[96:99], v[8:11]
    ds_read_b128 v[88:91], v147 offset:54272
    v_mfma_f32_16x16x32_bf16 v[36:39], v[60:63], v[100:103], v[36:39]
    ds_read_b128 v[92:95], v147 offset:55296
    v_mfma_f32_16x16x32_bf16 v[12:15], v[60:63], v[96:99], v[12:15]
    s_add_u32 s43, s43, 4096
    s_add_u32 s58, s58, 4096
    buffer_load_dwordx4 v[128:131], v4, s[4:7], s43 offen offset:0 sc1
    v_mfma_f32_16x16x32_bf16 v[40:43], v[64:67], v[100:103], v[40:43]
    v_mfma_f32_16x16x32_bf16 v[16:19], v[64:67], v[96:99], v[16:19]
    v_mfma_f32_16x16x32_bf16 v[44:47], v[68:71], v[100:103], v[44:47]
    v_mfma_f32_16x16x32_bf16 v[20:23], v[68:71], v[96:99], v[20:23]
    buffer_load_dwordx4 v[132:135], v4, s[4:7], s58 offen offset:0 sc1
    v_mfma_f32_16x16x32_bf16 v[48:51], v[72:75], v[100:103], v[48:51]
    v_mfma_f32_16x16x32_bf16 v[24:27], v[72:75], v[96:99], v[24:27]
    s_waitcnt lgkmcnt(0)
    s_barrier
    ds_read_b128 v[56:59], v148 offset:0
    ds_read_b128 v[60:63], v148 offset:1024
    s_waitcnt vmcnt(6)
    v_mfma_f32_16x16x32_bf16 v[32:35], v[76:79], v[108:111], v[32:35]
    ds_read_b128 v[64:67], v148 offset:2048
    v_mfma_f32_16x16x32_bf16 v[8:11], v[76:79], v[104:107], v[8:11]
    ds_read_b128 v[68:71], v148 offset:3072
    v_mfma_f32_16x16x32_bf16 v[36:39], v[80:83], v[108:111], v[36:39]
    ds_read_b128 v[72:75], v148 offset:4096
    v_mfma_f32_16x16x32_bf16 v[12:15], v[80:83], v[104:107], v[12:15]
    buffer_load_dwordx4 v[96:99], v4, s[4:7], s43 offen offset:2048 sc1
    v_mfma_f32_16x16x32_bf16 v[40:43], v[84:87], v[108:111], v[40:43]
    v_mfma_f32_16x16x32_bf16 v[16:19], v[84:87], v[104:107], v[16:19]
    v_mfma_f32_16x16x32_bf16 v[44:47], v[88:91], v[108:111], v[44:47]
    v_mfma_f32_16x16x32_bf16 v[20:23], v[88:91], v[104:107], v[20:23]
    buffer_load_dwordx4 v[100:103], v4, s[4:7], s58 offen offset:2048 sc1
    v_mfma_f32_16x16x32_bf16 v[48:51], v[92:95], v[108:111], v[48:51]
    v_mfma_f32_16x16x32_bf16 v[24:27], v[92:95], v[104:107], v[24:27]
    s_waitcnt lgkmcnt(0)
    ds_read_b128 v[76:79], v148 offset:10240
    ds_read_b128 v[80:83], v148 offset:11264
    s_waitcnt vmcnt(6)
    v_mfma_f32_16x16x32_bf16 v[32:35], v[56:59], v[116:119], v[32:35]
    ds_read_b128 v[84:87], v148 offset:12288
    v_mfma_f32_16x16x32_bf16 v[8:11], v[56:59], v[112:115], v[8:11]
    ds_read_b128 v[88:91], v148 offset:13312
    v_mfma_f32_16x16x32_bf16 v[36:39], v[60:63], v[116:119], v[36:39]
    ds_read_b128 v[92:95], v148 offset:14336
    v_mfma_f32_16x16x32_bf16 v[12:15], v[60:63], v[112:115], v[12:15]
    s_add_u32 s43, s43, 4096
    s_add_u32 s58, s58, 4096
    buffer_load_dwordx4 v[104:107], v4, s[4:7], s43 offen offset:0 sc1
    v_mfma_f32_16x16x32_bf16 v[40:43], v[64:67], v[116:119], v[40:43]
    v_mfma_f32_16x16x32_bf16 v[16:19], v[64:67], v[112:115], v[16:19]
    v_mfma_f32_16x16x32_bf16 v[44:47], v[68:71], v[116:119], v[44:47]
    v_mfma_f32_16x16x32_bf16 v[20:23], v[68:71], v[112:115], v[20:23]
    buffer_load_dwordx4 v[108:111], v4, s[4:7], s58 offen offset:0 sc1
    v_mfma_f32_16x16x32_bf16 v[48:51], v[72:75], v[116:119], v[48:51]
    v_mfma_f32_16x16x32_bf16 v[24:27], v[72:75], v[112:115], v[24:27]
    s_waitcnt lgkmcnt(0)
    s_barrier
    ds_read_b128 v[56:59], v148 offset:20480
    ds_read_b128 v[60:63], v148 offset:21504
    s_waitcnt vmcnt(6)
    v_mfma_f32_16x16x32_bf16 v[32:35], v[76:79], v[124:127], v[32:35]
    ds_read_b128 v[64:67], v148 offset:22528
    v_mfma_f32_16x16x32_bf16 v[8:11], v[76:79], v[120:123], v[8:11]
    ds_read_b128 v[68:71], v148 offset:23552
    v_mfma_f32_16x16x32_bf16 v[36:39], v[80:83], v[124:127], v[36:39]
    ds_read_b128 v[72:75], v148 offset:24576
    v_mfma_f32_16x16x32_bf16 v[12:15], v[80:83], v[120:123], v[12:15]
    buffer_load_dwordx4 v[112:115], v4, s[4:7], s43 offen offset:2048 sc1
    v_mfma_f32_16x16x32_bf16 v[40:43], v[84:87], v[124:127], v[40:43]
    v_mfma_f32_16x16x32_bf16 v[16:19], v[84:87], v[120:123], v[16:19]
    v_mfma_f32_16x16x32_bf16 v[44:47], v[88:91], v[124:127], v[44:47]
    v_mfma_f32_16x16x32_bf16 v[20:23], v[88:91], v[120:123], v[20:23]
    buffer_load_dwordx4 v[116:119], v4, s[4:7], s58 offen offset:2048 sc1
    v_mfma_f32_16x16x32_bf16 v[48:51], v[92:95], v[124:127], v[48:51]
    v_mfma_f32_16x16x32_bf16 v[24:27], v[92:95], v[120:123], v[24:27]
    s_waitcnt lgkmcnt(0)
    ds_read_b128 v[76:79], v148 offset:30720
    ds_read_b128 v[80:83], v148 offset:31744
    s_waitcnt vmcnt(6)
    v_mfma_f32_16x16x32_bf16 v[32:35], v[56:59], v[132:135], v[32:35]
    ds_read_b128 v[84:87], v148 offset:32768
    v_mfma_f32_16x16x32_bf16 v[8:11], v[56:59], v[128:131], v[8:11]
    ds_read_b128 v[88:91], v148 offset:33792
    v_mfma_f32_16x16x32_bf16 v[36:39], v[60:63], v[132:135], v[36:39]
    ds_read_b128 v[92:95], v148 offset:34816
    v_mfma_f32_16x16x32_bf16 v[12:15], v[60:63], v[128:131], v[12:15]
    s_add_u32 s43, s43, 4096
    s_add_u32 s58, s58, 4096
    buffer_load_dwordx4 v[120:123], v4, s[4:7], s43 offen offset:0 sc1
    v_mfma_f32_16x16x32_bf16 v[40:43], v[64:67], v[132:135], v[40:43]
    v_mfma_f32_16x16x32_bf16 v[16:19], v[64:67], v[128:131], v[16:19]
    v_mfma_f32_16x16x32_bf16 v[44:47], v[68:71], v[132:135], v[44:47]
    v_mfma_f32_16x16x32_bf16 v[20:23], v[68:71], v[128:131], v[20:23]
    buffer_load_dwordx4 v[124:127], v4, s[4:7], s58 offen offset:0 sc1
    v_mfma_f32_16x16x32_bf16 v[48:51], v[72:75], v[132:135], v[48:51]
    v_mfma_f32_16x16x32_bf16 v[24:27], v[72:75], v[128:131], v[24:27]
    s_waitcnt lgkmcnt(0)
    s_barrier
    ds_read_b128 v[56:59], v146 offset:0
    ds_read_b128 v[60:63], v146 offset:1024
    s_waitcnt vmcnt(6)
    v_mfma_f32_16x16x32_bf16 v[32:35], v[76:79], v[100:103], v[32:35]
    ds_read_b128 v[64:67], v146 offset:2048
    v_mfma_f32_16x16x32_bf16 v[8:11], v[76:79], v[96:99], v[8:11]
    ds_read_b128 v[68:71], v146 offset:3072
    v_mfma_f32_16x16x32_bf16 v[36:39], v[80:83], v[100:103], v[36:39]
    ds_read_b128 v[72:75], v146 offset:4096
    v_mfma_f32_16x16x32_bf16 v[12:15], v[80:83], v[96:99], v[12:15]
    buffer_load_dwordx4 v[128:131], v4, s[4:7], s43 offen offset:2048 sc1
    v_mfma_f32_16x16x32_bf16 v[40:43], v[84:87], v[100:103], v[40:43]
    v_mfma_f32_16x16x32_bf16 v[16:19], v[84:87], v[96:99], v[16:19]
    v_mfma_f32_16x16x32_bf16 v[44:47], v[88:91], v[100:103], v[44:47]
    v_mfma_f32_16x16x32_bf16 v[20:23], v[88:91], v[96:99], v[20:23]
    buffer_load_dwordx4 v[132:135], v4, s[4:7], s58 offen offset:2048 sc1
    v_mfma_f32_16x16x32_bf16 v[48:51], v[92:95], v[100:103], v[48:51]
    v_mfma_f32_16x16x32_bf16 v[24:27], v[92:95], v[96:99], v[24:27]
    s_waitcnt lgkmcnt(0)
    ds_read_b128 v[76:79], v146 offset:10240
    ds_read_b128 v[80:83], v146 offset:11264
    s_waitcnt vmcnt(6)
    v_mfma_f32_16x16x32_bf16 v[32:35], v[56:59], v[108:111], v[32:35]
    ds_read_b128 v[84:87], v146 offset:12288
    v_mfma_f32_16x16x32_bf16 v[8:11], v[56:59], v[104:107], v[8:11]
    ds_read_b128 v[88:91], v146 offset:13312
    v_mfma_f32_16x16x32_bf16 v[36:39], v[60:63], v[108:111], v[36:39]
    ds_read_b128 v[92:95], v146 offset:14336
    v_mfma_f32_16x16x32_bf16 v[12:15], v[60:63], v[104:107], v[12:15]
    s_add_u32 s43, s43, 4096
    s_add_u32 s58, s58, 4096
    buffer_load_dwordx4 v[96:99], v4, s[4:7], s43 offen offset:0 sc1
    v_mfma_f32_16x16x32_bf16 v[40:43], v[64:67], v[108:111], v[40:43]
    v_mfma_f32_16x16x32_bf16 v[16:19], v[64:67], v[104:107], v[16:19]
    v_mfma_f32_16x16x32_bf16 v[44:47], v[68:71], v[108:111], v[44:47]
    v_mfma_f32_16x16x32_bf16 v[20:23], v[68:71], v[104:107], v[20:23]
    buffer_load_dwordx4 v[100:103], v4, s[4:7], s58 offen offset:0 sc1
    v_mfma_f32_16x16x32_bf16 v[48:51], v[72:75], v[108:111], v[48:51]
    v_mfma_f32_16x16x32_bf16 v[24:27], v[72:75], v[104:107], v[24:27]
    s_waitcnt lgkmcnt(0)
    s_barrier
    ds_read_b128 v[56:59], v146 offset:20480
    ds_read_b128 v[60:63], v146 offset:21504
    s_waitcnt vmcnt(6)
    v_mfma_f32_16x16x32_bf16 v[32:35], v[76:79], v[116:119], v[32:35]
    ds_read_b128 v[64:67], v146 offset:22528
    v_mfma_f32_16x16x32_bf16 v[8:11], v[76:79], v[112:115], v[8:11]
    ds_read_b128 v[68:71], v146 offset:23552
    v_mfma_f32_16x16x32_bf16 v[36:39], v[80:83], v[116:119], v[36:39]
    ds_read_b128 v[72:75], v146 offset:24576
    v_mfma_f32_16x16x32_bf16 v[12:15], v[80:83], v[112:115], v[12:15]
    buffer_load_dwordx4 v[104:107], v4, s[4:7], s43 offen offset:2048 sc1
    v_mfma_f32_16x16x32_bf16 v[40:43], v[84:87], v[116:119], v[40:43]
    v_mfma_f32_16x16x32_bf16 v[16:19], v[84:87], v[112:115], v[16:19]
    v_mfma_f32_16x16x32_bf16 v[44:47], v[88:91], v[116:119], v[44:47]
    v_mfma_f32_16x16x32_bf16 v[20:23], v[88:91], v[112:115], v[20:23]
    buffer_load_dwordx4 v[108:111], v4, s[4:7], s58 offen offset:2048 sc1
    v_mfma_f32_16x16x32_bf16 v[48:51], v[92:95], v[116:119], v[48:51]
    v_mfma_f32_16x16x32_bf16 v[24:27], v[92:95], v[112:115], v[24:27]
    s_waitcnt lgkmcnt(0)
    ds_read_b128 v[76:79], v146 offset:30720
    ds_read_b128 v[80:83], v146 offset:31744
    s_waitcnt vmcnt(6)
    v_mfma_f32_16x16x32_bf16 v[32:35], v[56:59], v[124:127], v[32:35]
    ds_read_b128 v[84:87], v146 offset:32768
    v_mfma_f32_16x16x32_bf16 v[8:11], v[56:59], v[120:123], v[8:11]
    ds_read_b128 v[88:91], v146 offset:33792
    v_mfma_f32_16x16x32_bf16 v[36:39], v[60:63], v[124:127], v[36:39]
    ds_read_b128 v[92:95], v146 offset:34816
    v_mfma_f32_16x16x32_bf16 v[12:15], v[60:63], v[120:123], v[12:15]
    s_add_u32 s43, s43, 4096
    s_add_u32 s58, s58, 4096
    buffer_load_dwordx4 v[112:115], v4, s[4:7], s43 offen offset:0 sc1
    v_mfma_f32_16x16x32_bf16 v[40:43], v[64:67], v[124:127], v[40:43]
    v_mfma_f32_16x16x32_bf16 v[16:19], v[64:67], v[120:123], v[16:19]
    v_mfma_f32_16x16x32_bf16 v[44:47], v[68:71], v[124:127], v[44:47]
    v_mfma_f32_16x16x32_bf16 v[20:23], v[68:71], v[120:123], v[20:23]
    buffer_load_dwordx4 v[116:119], v4, s[4:7], s58 offen offset:0 sc1
    v_mfma_f32_16x16x32_bf16 v[48:51], v[72:75], v[124:127], v[48:51]
    v_mfma_f32_16x16x32_bf16 v[24:27], v[72:75], v[120:123], v[24:27]
    s_waitcnt lgkmcnt(0)
    s_barrier
    ds_read_b128 v[56:59], v146 offset:40960
    ds_read_b128 v[60:63], v146 offset:41984
    s_waitcnt vmcnt(6)
    v_mfma_f32_16x16x32_bf16 v[32:35], v[76:79], v[132:135], v[32:35]
    ds_read_b128 v[64:67], v146 offset:43008
    v_mfma_f32_16x16x32_bf16 v[8:11], v[76:79], v[128:131], v[8:11]
    ds_read_b128 v[68:71], v146 offset:44032
    v_mfma_f32_16x16x32_bf16 v[36:39], v[80:83], v[132:135], v[36:39]
    ds_read_b128 v[72:75], v146 offset:45056
    v_mfma_f32_16x16x32_bf16 v[12:15], v[80:83], v[128:131], v[12:15]
    buffer_load_dwordx4 v[120:123], v4, s[4:7], s43 offen offset:2048 sc1
    v_mfma_f32_16x16x32_bf16 v[40:43], v[84:87], v[132:135], v[40:43]
    v_mfma_f32_16x16x32_bf16 v[16:19], v[84:87], v[128:131], v[16:19]
    v_mfma_f32_16x16x32_bf16 v[44:47], v[88:91], v[132:135], v[44:47]
    v_mfma_f32_16x16x32_bf16 v[20:23], v[88:91], v[128:131], v[20:23]
    buffer_load_dwordx4 v[124:127], v4, s[4:7], s58 offen offset:2048 sc1
    v_mfma_f32_16x16x32_bf16 v[48:51], v[92:95], v[132:135], v[48:51]
    v_mfma_f32_16x16x32_bf16 v[24:27], v[92:95], v[128:131], v[24:27]
    s_waitcnt lgkmcnt(0)
    ds_read_b128 v[76:79], v146 offset:51200
    ds_read_b128 v[80:83], v146 offset:52224
    s_waitcnt vmcnt(6)
    v_mfma_f32_16x16x32_bf16 v[32:35], v[56:59], v[100:103], v[32:35]
    ds_read_b128 v[84:87], v146 offset:53248
    v_mfma_f32_16x16x32_bf16 v[8:11], v[56:59], v[96:99], v[8:11]
    ds_read_b128 v[88:91], v146 offset:54272
    v_mfma_f32_16x16x32_bf16 v[36:39], v[60:63], v[100:103], v[36:39]
    ds_read_b128 v[92:95], v146 offset:55296
    v_mfma_f32_16x16x32_bf16 v[12:15], v[60:63], v[96:99], v[12:15]
    v_mfma_f32_16x16x32_bf16 v[40:43], v[64:67], v[100:103], v[40:43]
    v_mfma_f32_16x16x32_bf16 v[16:19], v[64:67], v[96:99], v[16:19]
    v_mfma_f32_16x16x32_bf16 v[44:47], v[68:71], v[100:103], v[44:47]
    v_mfma_f32_16x16x32_bf16 v[20:23], v[68:71], v[96:99], v[20:23]
    v_mfma_f32_16x16x32_bf16 v[48:51], v[72:75], v[100:103], v[48:51]
    v_mfma_f32_16x16x32_bf16 v[24:27], v[72:75], v[96:99], v[24:27]
    s_waitcnt lgkmcnt(0)
    s_barrier
    ds_read_b128 v[56:59], v147 offset:0
    ds_read_b128 v[60:63], v147 offset:1024
    s_waitcnt vmcnt(4)
    v_mfma_f32_16x16x32_bf16 v[32:35], v[76:79], v[108:111], v[32:35]
    ds_read_b128 v[64:67], v147 offset:2048
    v_mfma_f32_16x16x32_bf16 v[8:11], v[76:79], v[104:107], v[8:11]
    ds_read_b128 v[68:71], v147 offset:3072
    v_mfma_f32_16x16x32_bf16 v[36:39], v[80:83], v[108:111], v[36:39]
    ds_read_b128 v[72:75], v147 offset:4096
    v_mfma_f32_16x16x32_bf16 v[12:15], v[80:83], v[104:107], v[12:15]
    v_mfma_f32_16x16x32_bf16 v[40:43], v[84:87], v[108:111], v[40:43]
    v_mfma_f32_16x16x32_bf16 v[16:19], v[84:87], v[104:107], v[16:19]
    v_mfma_f32_16x16x32_bf16 v[44:47], v[88:91], v[108:111], v[44:47]
    v_mfma_f32_16x16x32_bf16 v[20:23], v[88:91], v[104:107], v[20:23]
    v_mfma_f32_16x16x32_bf16 v[48:51], v[92:95], v[108:111], v[48:51]
    v_mfma_f32_16x16x32_bf16 v[24:27], v[92:95], v[104:107], v[24:27]
    s_waitcnt lgkmcnt(0)
    ds_read_b128 v[76:79], v147 offset:10240
    ds_read_b128 v[80:83], v147 offset:11264
    s_waitcnt vmcnt(2)
    v_mfma_f32_16x16x32_bf16 v[32:35], v[56:59], v[116:119], v[32:35]
    ds_read_b128 v[84:87], v147 offset:12288
    v_mfma_f32_16x16x32_bf16 v[8:11], v[56:59], v[112:115], v[8:11]
    ds_read_b128 v[88:91], v147 offset:13312
    v_mfma_f32_16x16x32_bf16 v[36:39], v[60:63], v[116:119], v[36:39]
    ds_read_b128 v[92:95], v147 offset:14336
    v_mfma_f32_16x16x32_bf16 v[12:15], v[60:63], v[112:115], v[12:15]
    v_mfma_f32_16x16x32_bf16 v[40:43], v[64:67], v[116:119], v[40:43]
    v_mfma_f32_16x16x32_bf16 v[16:19], v[64:67], v[112:115], v[16:19]
    v_mfma_f32_16x16x32_bf16 v[44:47], v[68:71], v[116:119], v[44:47]
    v_mfma_f32_16x16x32_bf16 v[20:23], v[68:71], v[112:115], v[20:23]
    v_mfma_f32_16x16x32_bf16 v[48:51], v[72:75], v[116:119], v[48:51]
    v_mfma_f32_16x16x32_bf16 v[24:27], v[72:75], v[112:115], v[24:27]
    s_waitcnt lgkmcnt(0)
    s_waitcnt vmcnt(0)
    v_mfma_f32_16x16x32_bf16 v[32:35], v[76:79], v[124:127], v[32:35]
    v_mfma_f32_16x16x32_bf16 v[36:39], v[80:83], v[124:127], v[36:39]
    v_mfma_f32_16x16x32_bf16 v[40:43], v[84:87], v[124:127], v[40:43]
    v_mfma_f32_16x16x32_bf16 v[44:47], v[88:91], v[124:127], v[44:47]
    v_mfma_f32_16x16x32_bf16 v[48:51], v[92:95], v[124:127], v[48:51]
    v_mfma_f32_16x16x32_bf16 v[8:11], v[76:79], v[120:123], v[8:11]
    v_mfma_f32_16x16x32_bf16 v[12:15], v[80:83], v[120:123], v[12:15]
    v_mfma_f32_16x16x32_bf16 v[16:19], v[84:87], v[120:123], v[16:19]
    v_mfma_f32_16x16x32_bf16 v[20:23], v[88:91], v[120:123], v[20:23]
    v_mfma_f32_16x16x32_bf16 v[24:27], v[92:95], v[120:123], v[24:27]
    s_mul_i32 s47, s40, 5120
    s_add_u32 s47, s47, 40960
    v_add_u32 v6, s47, v4
    s_xor_b32 s47, s40, 2
    s_mul_i32 s47, s47, 5120
    s_add_u32 s47, s47, 40960
    v_add_u32 v7, s47, v4
    ds_write_b128 v6, v[32:35] offset:0
    ds_write_b128 v6, v[36:39] offset:1024
    ds_write_b128 v6, v[40:43] offset:2048
    ds_write_b128 v6, v[44:47] offset:3072
    ds_write_b128 v6, v[48:51] offset:4096
    s_waitcnt lgkmcnt(0)
    s_barrier
    ds_read_b128 v[32:35], v7 offset:0
    ds_read_b128 v[36:39], v7 offset:1024
    ds_read_b128 v[40:43], v7 offset:2048
    ds_read_b128 v[44:47], v7 offset:3072
    ds_read_b128 v[48:51], v7 offset:4096
    s_waitcnt lgkmcnt(4)
    v_pk_add_f32 v[8:9], v[8:9], v[32:33]
    v_pk_add_f32 v[10:11], v[10:11], v[34:35]
    s_waitcnt lgkmcnt(3)
    v_pk_add_f32 v[12:13], v[12:13], v[36:37]
    v_pk_add_f32 v[14:15], v[14:15], v[38:39]
    s_waitcnt lgkmcnt(2)
    v_pk_add_f32 v[16:17], v[16:17], v[40:41]
    v_pk_add_f32 v[18:19], v[18:19], v[42:43]
    s_waitcnt lgkmcnt(1)
    v_pk_add_f32 v[20:21], v[20:21], v[44:45]
    v_pk_add_f32 v[22:23], v[22:23], v[46:47]
    s_waitcnt lgkmcnt(0)
    v_pk_add_f32 v[24:25], v[24:25], v[48:49]
    v_pk_add_f32 v[26:27], v[26:27], v[50:51]
    v_mov_b32 v56, 0
    v_mov_b32 v57, 0
    v_lshlrev_b32 v60, 16, v136
    v_and_b32 v61, 0xffff0000, v136
    v_lshlrev_b32 v62, 16, v137
    v_and_b32 v63, 0xffff0000, v137
    v_pk_add_f32 v[8:9], v[8:9], v[60:61]
    v_pk_add_f32 v[10:11], v[10:11], v[62:63]
    v_cvt_pk_bf16_f32 v136, v8, v9
    v_cvt_pk_bf16_f32 v137, v10, v11
    v_lshlrev_b32 v60, 16, v138
    v_and_b32 v61, 0xffff0000, v138
    v_lshlrev_b32 v62, 16, v139
    v_and_b32 v63, 0xffff0000, v139
    v_pk_add_f32 v[12:13], v[12:13], v[60:61]
    v_pk_add_f32 v[14:15], v[14:15], v[62:63]
    v_cvt_pk_bf16_f32 v138, v12, v13
    v_cvt_pk_bf16_f32 v139, v14, v15
    v_lshlrev_b32 v60, 16, v140
    v_and_b32 v61, 0xffff0000, v140
    v_lshlrev_b32 v62, 16, v141
    v_and_b32 v63, 0xffff0000, v141
    v_pk_add_f32 v[16:17], v[16:17], v[60:61]
    v_pk_add_f32 v[18:19], v[18:19], v[62:63]
    v_cvt_pk_bf16_f32 v140, v16, v17
    v_cvt_pk_bf16_f32 v141, v18, v19
    v_lshlrev_b32 v60, 16, v142
    v_and_b32 v61, 0xffff0000, v142
    v_lshlrev_b32 v62, 16, v143
    v_and_b32 v63, 0xffff0000, v143
    v_pk_add_f32 v[20:21], v[20:21], v[60:61]
    v_pk_add_f32 v[22:23], v[22:23], v[62:63]
    v_cvt_pk_bf16_f32 v142, v20, v21
    v_cvt_pk_bf16_f32 v143, v22, v23
    v_lshlrev_b32 v60, 16, v144
    v_and_b32 v61, 0xffff0000, v144
    v_lshlrev_b32 v62, 16, v145
    v_and_b32 v63, 0xffff0000, v145
    v_pk_add_f32 v[24:25], v[24:25], v[60:61]
    v_pk_add_f32 v[26:27], v[26:27], v[62:63]
    v_cvt_pk_bf16_f32 v144, v24, v25
    v_cvt_pk_bf16_f32 v145, v26, v27
    s_cmp_eq_u32 s94, 0
    s_cbranch_scc1 down_frag
    v_mul_u32_u24 v4, 1280, v5
    v_lshl_add_u32 v4, v3, 3, v4
    s_lshl_b32 s47, s45, 5
    buffer_store_dwordx2 v[136:137], v4, s[16:19], s47 offen offset:0
    buffer_store_dwordx2 v[138:139], v4, s[16:19], s47 offen offset:32
    buffer_store_dwordx2 v[140:141], v4, s[16:19], s47 offen offset:64
    buffer_store_dwordx2 v[142:143], v4, s[16:19], s47 offen offset:96
    buffer_store_dwordx2 v[144:145], v4, s[16:19], s47 offen offset:128
    s_branch fqkv_end
down_frag:
    s_bitcmp1_b32 s33, 0
    s_cbranch_scc1 po_29
    buffer_store_dwordx4 v[136:139], v4, s[16:19], s52 offen
    buffer_store_dwordx4 v[140:143], v4, s[16:19], s54 offen
    buffer_store_dwordx2 v[144:145], v4, s[16:19], s56 offen
    s_branch pz_30
po_29:
    buffer_store_dwordx2 v[136:137], v4, s[16:19], s52 offen
    buffer_store_dwordx4 v[138:141], v4, s[16:19], s53 offen
    buffer_store_dwordx4 v[142:145], v4, s[16:19], s55 offen
pz_30:
    v_mov_b32 v60, 0x3f803f80
    v_dot2_f32_bf16 v56, v136, v60, v56
    v_dot2_f32_bf16 v57, v136, v136, v57
    v_dot2_f32_bf16 v58, v137, v60, 0
    v_dot2_f32_bf16 v59, v137, v137, 0
    v_dot2_f32_bf16 v56, v138, v60, v56
    v_dot2_f32_bf16 v57, v138, v138, v57
    v_dot2_f32_bf16 v58, v139, v60, v58
    v_dot2_f32_bf16 v59, v139, v139, v59
    v_dot2_f32_bf16 v56, v140, v60, v56
    v_dot2_f32_bf16 v57, v140, v140, v57
    v_dot2_f32_bf16 v58, v141, v60, v58
    v_dot2_f32_bf16 v59, v141, v141, v59
    v_dot2_f32_bf16 v56, v142, v60, v56
    v_dot2_f32_bf16 v57, v142, v142, v57
    v_dot2_f32_bf16 v58, v143, v60, v58
    v_dot2_f32_bf16 v59, v143, v143, v59
    v_dot2_f32_bf16 v56, v144, v60, v56
    v_dot2_f32_bf16 v57, v144, v144, v57
    v_dot2_f32_bf16 v58, v145, v60, v58
    v_dot2_f32_bf16 v59, v145, v145, v59
    s_nop 2
    v_pk_add_f32 v[56:57], v[56:57], v[58:59]
    v_mov_b32 v60, v56
    v_mov_b32 v61, v57
    s_nop 0
    v_permlane16_swap_b32 v56, v60
    v_permlane16_swap_b32 v57, v61
    v_pk_add_f32 v[56:57], v[56:57], v[60:61]
    v_mov_b32 v60, v56
    v_mov_b32 v61, v57
    s_nop 0
    v_permlane32_swap_b32 v56, v60
    v_permlane32_swap_b32 v57, v61
    v_pk_add_f32 v[56:57], v[56:57], v[60:61]
    v_lshlrev_b32 v6, 6, v5
    v_cmp_eq_u32 vcc, 0, v3
    v_mov_b32 v7, 0x7ff00000
    s_nop 0
    v_cndmask_b32 v6, v7, v6, vcc
    s_lshl_b32 s47, s33, 3
    s_add_u32 s47, s47, 0
    buffer_store_dwordx2 v[56:57], v6, s[24:27], s47 offen
fdown_end:
    s_lshl_b32 s48, s42, 7
    s_add_u32 s48, s48, s68
    s_add_u32 s48, s48, 49152
    s_lshl2_add_u32 s48, s33, s48
    v_mov_b32 v8, 1
    v_mov_b32 v9, 0
    s_mov_b64 exec, 1
    s_cmp_eq_u32 s65, 0
    s_cbranch_scc1 sg_31
    s_waitcnt vmcnt(0)
    buffer_wbl2 sc1
    s_waitcnt vmcnt(0)
    buffer_store_dword v8, v9, s[24:27], s48 offen sc1
    s_branch sd_32
sg_31:
    s_waitcnt vmcnt(0)
    buffer_store_dword v8, v9, s[24:27], s48 offen
sd_32:
    s_mov_b64 exec, -1
    s_mul_i32 s44, s33, 11
    s_lshr_b32 s44, s44, 5
    s_mul_i32 s44, s44, 3
    s_sub_u32 s44, s33, s44
    s_add_u32 s4, s36, 0x800000
    s_addc_u32 s5, s37, 0
    s_mov_b32 s6, 0x280000
    s_mov_b32 s7, 0x20000
    s_mov_b32 s16, s36
    s_mov_b32 s17, s37
    s_mov_b32 s18, 0x280000
    s_mov_b32 s19, 0x20000
    s_add_u32 s28, s36, 0x2c0000
    s_addc_u32 s29, s37, 0
    s_mov_b32 s30, 0x30000
    s_mov_b32 s31, 0x20000
    v_lshlrev_b32 v4, 4, v0
    s_and_b32 s46, s40, 1
    s_lshr_b32 s57, s40, 1
    s_lshr_b32 s42, s32, 4
    s_lshl1_add_u32 s42, s46, s42
    s_mov_b32 s59, s42
    s_add_u32 s42, s42, s57
    s_xor_b32 s58, s42, 1
    s_mul_i32 s43, s42, 20480
    s_mul_i32 s58, s58, 20480
    s_lshl_b32 s46, s57, 10
    s_add_u32 s43, s43, s46
    s_add_u32 s58, s58, s46
    v_and_b32 v2, 15, v0
    v_lshrrev_b32 v3, 4, v0
    s_lshl_b32 s46, s42, 4
    v_add_u32 v5, s46, v2
    s_mul_i32 s45, s33, 5
    v_lshlrev_b32 v1, 6, v5
    v_lshl_add_u32 v1, v3, 4, v1
    v_lshlrev_b32 v6, 4, v3
    s_lshl_b32 s47, s45, 6
    s_add_u32 s47, s47, 262144
    s_add_u32 s48, s47, 0x1000
    buffer_load_dwordx4 v[148:151], v6, s[24:27], s47 offen offset:0
    buffer_load_dwordx4 v[172:175], v6, s[24:27], s48 offen offset:0
    buffer_load_dwordx4 v[152:155], v6, s[24:27], s47 offen offset:64
    buffer_load_dwordx4 v[176:179], v6, s[24:27], s48 offen offset:64
    buffer_load_dwordx4 v[156:159], v6, s[24:27], s47 offen offset:128
    buffer_load_dwordx4 v[180:183], v6, s[24:27], s48 offen offset:128
    buffer_load_dwordx4 v[160:163], v6, s[24:27], s47 offen offset:192
    buffer_load_dwordx4 v[184:187], v6, s[24:27], s48 offen offset:192
    buffer_load_dwordx4 v[164:167], v6, s[24:27], s47 offen offset:256
    buffer_load_dwordx4 v[188:191], v6, s[24:27], s48 offen offset:256
    s_lshl_b32 s47, s44, 6
    s_add_u32 s47, s47, 264704
    s_add_u32 s48, s47, 0x1000
    buffer_load_dwordx4 v[168:171], v6, s[24:27], s47 offen
    buffer_load_dwordx4 v[192:195], v6, s[24:27], s48 offen
    s_lshl_b32 s48, s59, 7
    s_add_u32 s48, s48, s68
    s_add_u32 s48, s48, 49152
    v_and_b32 v6, 7, v0
    v_lshlrev_b32 v6, 2, v6
    v_and_b32 v7, 32, v0
    v_lshl_add_u32 v6, v7, 2, v6
    s_cmp_eq_u32 s65, 0
    s_cbranch_scc1 pf_34
    s_mov_b32 s95, 0x100000
pl_36:
    buffer_load_dword v7, v6, s[24:27], s48 offen sc1
    s_sub_u32 s95, s95, 1
    s_cbranch_scc1 pe_35
    s_waitcnt vmcnt(0)
    v_cmp_eq_u32 vcc, 0, v7
    s_nop 1
    s_cmp_lg_u64 vcc, 0
    s_cbranch_scc1 pl_36
pe_35:
    buffer_inv sc1
    s_branch pd_33
pf_34:
    s_mov_b32 s95, 0x100000
pl_37:
    buffer_load_dword v7, v6, s[24:27], s48 offen sc1
    s_sub_u32 s95, s95, 1
    s_cbranch_scc1 pd_33
    s_waitcnt vmcnt(0)
    v_cmp_eq_u32 vcc, 0, v7
    s_nop 1
    s_cmp_lg_u64 vcc, 0
    s_cbranch_scc1 pl_37
pd_33:
    buffer_load_dwordx4 v[104:107], v4, s[4:7], s43 offen offset:0 sc1
    buffer_load_dwordx4 v[108:111], v4, s[4:7], s58 offen offset:0 sc1
    buffer_load_dwordx4 v[112:115], v4, s[4:7], s43 offen offset:2048 sc1
    buffer_load_dwordx4 v[116:119], v4, s[4:7], s58 offen offset:2048 sc1
    s_add_u32 s43, s43, 4096
    s_add_u32 s58, s58, 4096
    buffer_load_dwordx4 v[120:123], v4, s[4:7], s43 offen offset:0 sc1
    buffer_load_dwordx4 v[124:127], v4, s[4:7], s58 offen offset:0 sc1
    buffer_load_dwordx4 v[128:131], v4, s[4:7], s43 offen offset:2048 sc1
    buffer_load_dwordx4 v[132:135], v4, s[4:7], s58 offen offset:2048 sc1
    s_add_u32 s43, s43, 4096
    s_add_u32 s58, s58, 4096
    buffer_load_dwordx4 v[136:139], v4, s[4:7], s43 offen offset:0 sc1
    buffer_load_dwordx4 v[140:143], v4, s[4:7], s58 offen offset:0 sc1
    buffer_load_dwordx4 v[144:147], v1, s[24:27], 0 offen offset:0 sc1
    s_mul_i32 s47, s57, 5120
    s_lshl_b32 s48, s57, 10
    v_add_u32 v196, s47, v4
    s_add_u32 s47, s47, 61440
    v_add_u32 v199, s48, v4
    s_add_u32 s48, s48, 61440
    v_add_u32 v197, s47, v4
    s_add_u32 s47, s47, 61440
    v_add_u32 v200, s48, v4
    s_add_u32 s48, s48, 61440
    v_add_u32 v198, s47, v4
    s_add_u32 s47, s47, 61440
    v_add_u32 v201, s48, v4
    s_add_u32 s48, s48, 61440
    s_barrier
    ds_read_b128 v[56:59], v197 offset:20480
    ds_read_b128 v[60:63], v197 offset:21504
    ds_read_b128 v[64:67], v197 offset:22528
    ds_read_b128 v[68:71], v197 offset:23552
    ds_read_b128 v[72:75], v197 offset:24576
    ds_read_b128 v[76:79], v200 offset:30720
    s_waitcnt lgkmcnt(0)
    ds_read_b128 v[80:83], v197 offset:32768
    ds_read_b128 v[84:87], v197 offset:33792
    s_waitcnt vmcnt(9)
    v_mfma_f32_16x16x32_bf16 v[32:35], v[56:59], v[108:111], 0
    ds_read_b128 v[88:91], v197 offset:34816
    v_mfma_f32_16x16x32_bf16 v[8:11], v[56:59], v[104:107], 0
    ds_read_b128 v[92:95], v197 offset:35840
    v_mfma_f32_16x16x32_bf16 v[36:39], v[60:63], v[108:111], 0
    ds_read_b128 v[96:99], v197 offset:36864
    v_mfma_f32_16x16x32_bf16 v[12:15], v[60:63], v[104:107], 0
    ds_read_b128 v[100:103], v200 offset:43008
    v_mfma_f32_16x16x32_bf16 v[40:43], v[64:67], v[108:111], 0
    v_mfma_f32_16x16x32_bf16 v[16:19], v[64:67], v[104:107], 0
    v_mfma_f32_16x16x32_bf16 v[44:47], v[68:71], v[108:111], 0
    v_mfma_f32_16x16x32_bf16 v[20:23], v[68:71], v[104:107], 0
    v_mfma_f32_16x16x32_bf16 v[48:51], v[72:75], v[108:111], 0
    v_mfma_f32_16x16x32_bf16 v[24:27], v[72:75], v[104:107], 0
    v_mfma_f32_16x16x32_bf16 v[52:55], v[76:79], v[108:111], 0
    v_mfma_f32_16x16x32_bf16 v[28:31], v[76:79], v[104:107], 0
    s_waitcnt lgkmcnt(0)
    ds_read_b128 v[56:59], v197 offset:45056
    ds_read_b128 v[60:63], v197 offset:46080
    s_waitcnt vmcnt(7)
    v_mfma_f32_16x16x32_bf16 v[32:35], v[80:83], v[116:119], v[32:35]
    ds_read_b128 v[64:67], v197 offset:47104
    v_mfma_f32_16x16x32_bf16 v[8:11], v[80:83], v[112:115], v[8:11]
    ds_read_b128 v[68:71], v197 offset:48128
    v_mfma_f32_16x16x32_bf16 v[36:39], v[84:87], v[116:119], v[36:39]
    ds_read_b128 v[72:75], v197 offset:49152
    v_mfma_f32_16x16x32_bf16 v[12:15], v[84:87], v[112:115], v[12:15]
    ds_read_b128 v[76:79], v200 offset:55296
    v_mfma_f32_16x16x32_bf16 v[40:43], v[88:91], v[116:119], v[40:43]
    buffer_load_dwordx4 v[104:107], v4, s[4:7], s43 offen offset:2048 sc1
    v_mfma_f32_16x16x32_bf16 v[16:19], v[88:91], v[112:115], v[16:19]
    v_mfma_f32_16x16x32_bf16 v[44:47], v[92:95], v[116:119], v[44:47]
    v_mfma_f32_16x16x32_bf16 v[20:23], v[92:95], v[112:115], v[20:23]
    v_mfma_f32_16x16x32_bf16 v[48:51], v[96:99], v[116:119], v[48:51]
    buffer_load_dwordx4 v[108:111], v4, s[4:7], s58 offen offset:2048 sc1
    v_mfma_f32_16x16x32_bf16 v[24:27], v[96:99], v[112:115], v[24:27]
    v_mfma_f32_16x16x32_bf16 v[52:55], v[100:103], v[116:119], v[52:55]
    v_mfma_f32_16x16x32_bf16 v[28:31], v[100:103], v[112:115], v[28:31]
    s_waitcnt lgkmcnt(0)
    ds_read_b128 v[80:83], v197 offset:57344
    ds_read_b128 v[84:87], v197 offset:58368
    s_waitcnt vmcnt(7)
    v_mfma_f32_16x16x32_bf16 v[32:35], v[56:59], v[124:127], v[32:35]
    ds_read_b128 v[88:91], v197 offset:59392
    v_mfma_f32_16x16x32_bf16 v[8:11], v[56:59], v[120:123], v[8:11]
    ds_read_b128 v[92:95], v197 offset:60416
    v_mfma_f32_16x16x32_bf16 v[36:39], v[60:63], v[124:127], v[36:39]
    ds_read_b128 v[96:99], v198 offset:0
    v_mfma_f32_16x16x32_bf16 v[12:15], v[60:63], v[120:123], v[12:15]
    ds_read_b128 v[100:103], v201 offset:6144
    v_mfma_f32_16x16x32_bf16 v[40:43], v[64:67], v[124:127], v[40:43]
    s_add_u32 s43, s43, 4096
    s_add_u32 s58, s58, 4096
    buffer_load_dwordx4 v[112:115], v4, s[4:7], s43 offen offset:0 sc1
    v_mfma_f32_16x16x32_bf16 v[16:19], v[64:67], v[120:123], v[16:19]
    v_mfma_f32_16x16x32_bf16 v[44:47], v[68:71], v[124:127], v[44:47]
    v_mfma_f32_16x16x32_bf16 v[20:23], v[68:71], v[120:123], v[20:23]
    v_mfma_f32_16x16x32_bf16 v[48:51], v[72:75], v[124:127], v[48:51]
    buffer_load_dwordx4 v[116:119], v4, s[4:7], s58 offen offset:0 sc1
    v_mfma_f32_16x16x32_bf16 v[24:27], v[72:75], v[120:123], v[24:27]
    v_mfma_f32_16x16x32_bf16 v[52:55], v[76:79], v[124:127], v[52:55]
    v_mfma_f32_16x16x32_bf16 v[28:31], v[76:79], v[120:123], v[28:31]
    s_waitcnt lgkmcnt(0)
    ds_read_b128 v[56:59], v198 offset:8192
    ds_read_b128 v[60:63], v198 offset:9216
    s_waitcnt vmcnt(7)
    v_mfma_f32_16x16x32_bf16 v[32:35], v[80:83], v[132:135], v[32:35]
    ds_read_b128 v[64:67], v198 offset:10240
    v_mfma_f32_16x16x32_bf16 v[8:11], v[80:83], v[128:131], v[8:11]
    ds_read_b128 v[68:71], v198 offset:11264
    v_mfma_f32_16x16x32_bf16 v[36:39], v[84:87], v[132:135], v[36:39]
    ds_read_b128 v[72:75], v198 offset:12288
    v_mfma_f32_16x16x32_bf16 v[12:15], v[84:87], v[128:131], v[12:15]
    ds_read_b128 v[76:79], v201 offset:18432
    v_mfma_f32_16x16x32_bf16 v[40:43], v[88:91], v[132:135], v[40:43]
    buffer_load_dwordx4 v[120:123], v4, s[4:7], s43 offen offset:2048 sc1
    v_mfma_f32_16x16x32_bf16 v[16:19], v[88:91], v[128:131], v[16:19]
    v_mfma_f32_16x16x32_bf16 v[44:47], v[92:95], v[132:135], v[44:47]
    v_mfma_f32_16x16x32_bf16 v[20:23], v[92:95], v[128:131], v[20:23]
    v_mfma_f32_16x16x32_bf16 v[48:51], v[96:99], v[132:135], v[48:51]
    buffer_load_dwordx4 v[124:127], v4, s[4:7], s58 offen offset:2048 sc1
    v_mfma_f32_16x16x32_bf16 v[24:27], v[96:99], v[128:131], v[24:27]
    v_mfma_f32_16x16x32_bf16 v[52:55], v[100:103], v[132:135], v[52:55]
    v_mfma_f32_16x16x32_bf16 v[28:31], v[100:103], v[128:131], v[28:31]
    s_waitcnt lgkmcnt(0)
    ds_read_b128 v[80:83], v198 offset:20480
    ds_read_b128 v[84:87], v198 offset:21504
    s_waitcnt vmcnt(7)
    v_mfma_f32_16x16x32_bf16 v[32:35], v[56:59], v[140:143], v[32:35]
    ds_read_b128 v[88:91], v198 offset:22528
    v_mfma_f32_16x16x32_bf16 v[8:11], v[56:59], v[136:139], v[8:11]
    ds_read_b128 v[92:95], v198 offset:23552
    v_mfma_f32_16x16x32_bf16 v[36:39], v[60:63], v[140:143], v[36:39]
    ds_read_b128 v[96:99], v198 offset:24576
    v_mfma_f32_16x16x32_bf16 v[12:15], v[60:63], v[136:139], v[12:15]
    ds_read_b128 v[100:103], v201 offset:30720
    v_mfma_f32_16x16x32_bf16 v[40:43], v[64:67], v[140:143], v[40:43]
    s_add_u32 s43, s43, 4096
    s_add_u32 s58, s58, 4096
    buffer_load_dwordx4 v[128:131], v4, s[4:7], s43 offen offset:0 sc1
    v_mfma_f32_16x16x32_bf16 v[16:19], v[64:67], v[136:139], v[16:19]
    v_mfma_f32_16x16x32_bf16 v[44:47], v[68:71], v[140:143], v[44:47]
    v_mfma_f32_16x16x32_bf16 v[20:23], v[68:71], v[136:139], v[20:23]
    v_mfma_f32_16x16x32_bf16 v[48:51], v[72:75], v[140:143], v[48:51]
    buffer_load_dwordx4 v[132:135], v4, s[4:7], s58 offen offset:0 sc1
    v_mfma_f32_16x16x32_bf16 v[24:27], v[72:75], v[136:139], v[24:27]
    v_mfma_f32_16x16x32_bf16 v[52:55], v[76:79], v[140:143], v[52:55]
    v_mfma_f32_16x16x32_bf16 v[28:31], v[76:79], v[136:139], v[28:31]
    s_waitcnt lgkmcnt(0)
    ds_read_b128 v[56:59], v196 offset:0
    ds_read_b128 v[60:63], v196 offset:1024
    s_waitcnt vmcnt(6)
    v_mfma_f32_16x16x32_bf16 v[32:35], v[80:83], v[108:111], v[32:35]
    ds_read_b128 v[64:67], v196 offset:2048
    v_mfma_f32_16x16x32_bf16 v[8:11], v[80:83], v[104:107], v[8:11]
    ds_read_b128 v[68:71], v196 offset:3072
    v_mfma_f32_16x16x32_bf16 v[36:39], v[84:87], v[108:111], v[36:39]
    ds_read_b128 v[72:75], v196 offset:4096
    v_mfma_f32_16x16x32_bf16 v[12:15], v[84:87], v[104:107], v[12:15]
    ds_read_b128 v[76:79], v199 offset:10240
    v_mfma_f32_16x16x32_bf16 v[40:43], v[88:91], v[108:111], v[40:43]
    buffer_load_dwordx4 v[136:139], v4, s[4:7], s43 offen offset:2048 sc1
    v_mfma_f32_16x16x32_bf16 v[16:19], v[88:91], v[104:107], v[16:19]
    v_mfma_f32_16x16x32_bf16 v[44:47], v[92:95], v[108:111], v[44:47]
    v_mfma_f32_16x16x32_bf16 v[20:23], v[92:95], v[104:107], v[20:23]
    v_mfma_f32_16x16x32_bf16 v[48:51], v[96:99], v[108:111], v[48:51]
    buffer_load_dwordx4 v[140:143], v4, s[4:7], s58 offen offset:2048 sc1
    v_mfma_f32_16x16x32_bf16 v[24:27], v[96:99], v[104:107], v[24:27]
    v_mfma_f32_16x16x32_bf16 v[52:55], v[100:103], v[108:111], v[52:55]
    v_mfma_f32_16x16x32_bf16 v[28:31], v[100:103], v[104:107], v[28:31]
    s_waitcnt lgkmcnt(0)
    ds_read_b128 v[80:83], v196 offset:12288
    ds_read_b128 v[84:87], v196 offset:13312
    s_waitcnt vmcnt(6)
    v_mfma_f32_16x16x32_bf16 v[32:35], v[56:59], v[116:119], v[32:35]
    ds_read_b128 v[88:91], v196 offset:14336
    v_mfma_f32_16x16x32_bf16 v[8:11], v[56:59], v[112:115], v[8:11]
    ds_read_b128 v[92:95], v196 offset:15360
    v_mfma_f32_16x16x32_bf16 v[36:39], v[60:63], v[116:119], v[36:39]
    ds_read_b128 v[96:99], v196 offset:16384
    v_mfma_f32_16x16x32_bf16 v[12:15], v[60:63], v[112:115], v[12:15]
    ds_read_b128 v[100:103], v199 offset:22528
    v_mfma_f32_16x16x32_bf16 v[40:43], v[64:67], v[116:119], v[40:43]
    v_mfma_f32_16x16x32_bf16 v[16:19], v[64:67], v[112:115], v[16:19]
    v_mfma_f32_16x16x32_bf16 v[44:47], v[68:71], v[116:119], v[44:47]
    v_mfma_f32_16x16x32_bf16 v[20:23], v[68:71], v[112:115], v[20:23]
    v_mfma_f32_16x16x32_bf16 v[48:51], v[72:75], v[116:119], v[48:51]
    v_mfma_f32_16x16x32_bf16 v[24:27], v[72:75], v[112:115], v[24:27]
    v_mfma_f32_16x16x32_bf16 v[52:55], v[76:79], v[116:119], v[52:55]
    v_mfma_f32_16x16x32_bf16 v[28:31], v[76:79], v[112:115], v[28:31]
    s_waitcnt lgkmcnt(0)
    ds_read_b128 v[56:59], v196 offset:24576
    ds_read_b128 v[60:63], v196 offset:25600
    s_waitcnt vmcnt(4)
    v_mfma_f32_16x16x32_bf16 v[32:35], v[80:83], v[124:127], v[32:35]
    ds_read_b128 v[64:67], v196 offset:26624
    v_mfma_f32_16x16x32_bf16 v[8:11], v[80:83], v[120:123], v[8:11]
    ds_read_b128 v[68:71], v196 offset:27648
    v_mfma_f32_16x16x32_bf16 v[36:39], v[84:87], v[124:127], v[36:39]
    ds_read_b128 v[72:75], v196 offset:28672
    v_mfma_f32_16x16x32_bf16 v[12:15], v[84:87], v[120:123], v[12:15]
    ds_read_b128 v[76:79], v199 offset:34816
    v_mfma_f32_16x16x32_bf16 v[40:43], v[88:91], v[124:127], v[40:43]
    v_mfma_f32_16x16x32_bf16 v[16:19], v[88:91], v[120:123], v[16:19]
    v_mfma_f32_16x16x32_bf16 v[44:47], v[92:95], v[124:127], v[44:47]
    v_mfma_f32_16x16x32_bf16 v[20:23], v[92:95], v[120:123], v[20:23]
    v_mfma_f32_16x16x32_bf16 v[48:51], v[96:99], v[124:127], v[48:51]
    v_mfma_f32_16x16x32_bf16 v[24:27], v[96:99], v[120:123], v[24:27]
    v_mfma_f32_16x16x32_bf16 v[52:55], v[100:103], v[124:127], v[52:55]
    v_mfma_f32_16x16x32_bf16 v[28:31], v[100:103], v[120:123], v[28:31]
    s_waitcnt lgkmcnt(0)
    ds_read_b128 v[80:83], v197 offset:0
    ds_read_b128 v[84:87], v197 offset:1024
    s_waitcnt vmcnt(2)
    v_mfma_f32_16x16x32_bf16 v[32:35], v[56:59], v[132:135], v[32:35]
    ds_read_b128 v[88:91], v197 offset:2048
    v_mfma_f32_16x16x32_bf16 v[8:11], v[56:59], v[128:131], v[8:11]
    ds_read_b128 v[92:95], v197 offset:3072
    v_mfma_f32_16x16x32_bf16 v[36:39], v[60:63], v[132:135], v[36:39]
    ds_read_b128 v[96:99], v197 offset:4096
    v_mfma_f32_16x16x32_bf16 v[12:15], v[60:63], v[128:131], v[12:15]
    ds_read_b128 v[100:103], v200 offset:10240
    v_mfma_f32_16x16x32_bf16 v[40:43], v[64:67], v[132:135], v[40:43]
    v_mfma_f32_16x16x32_bf16 v[16:19], v[64:67], v[128:131], v[16:19]
    v_mfma_f32_16x16x32_bf16 v[44:47], v[68:71], v[132:135], v[44:47]
    v_mfma_f32_16x16x32_bf16 v[20:23], v[68:71], v[128:131], v[20:23]
    v_mfma_f32_16x16x32_bf16 v[48:51], v[72:75], v[132:135], v[48:51]
    v_mfma_f32_16x16x32_bf16 v[24:27], v[72:75], v[128:131], v[24:27]
    v_mfma_f32_16x16x32_bf16 v[52:55], v[76:79], v[132:135], v[52:55]
    v_mfma_f32_16x16x32_bf16 v[28:31], v[76:79], v[128:131], v[28:31]
    s_waitcnt lgkmcnt(0)
    s_waitcnt vmcnt(0)
    v_mfma_f32_16x16x32_bf16 v[32:35], v[80:83], v[140:143], v[32:35]
    v_mfma_f32_16x16x32_bf16 v[36:39], v[84:87], v[140:143], v[36:39]
    v_mfma_f32_16x16x32_bf16 v[40:43], v[88:91], v[140:143], v[40:43]
    v_mfma_f32_16x16x32_bf16 v[44:47], v[92:95], v[140:143], v[44:47]
    v_mfma_f32_16x16x32_bf16 v[48:51], v[96:99], v[140:143], v[48:51]
    v_mfma_f32_16x16x32_bf16 v[52:55], v[100:103], v[140:143], v[52:55]
    v_mfma_f32_16x16x32_bf16 v[8:11], v[80:83], v[136:139], v[8:11]
    v_mfma_f32_16x16x32_bf16 v[12:15], v[84:87], v[136:139], v[12:15]
    v_mfma_f32_16x16x32_bf16 v[16:19], v[88:91], v[136:139], v[16:19]
    v_mfma_f32_16x16x32_bf16 v[20:23], v[92:95], v[136:139], v[20:23]
    v_mfma_f32_16x16x32_bf16 v[24:27], v[96:99], v[136:139], v[24:27]
    v_mfma_f32_16x16x32_bf16 v[28:31], v[100:103], v[136:139], v[28:31]
    s_mul_i32 s47, s40, 6144
    s_add_u32 s47, s47, 36864
    v_add_u32 v6, s47, v4
    s_xor_b32 s47, s40, 2
    s_mul_i32 s47, s47, 6144
    s_add_u32 s47, s47, 36864
    v_add_u32 v7, s47, v4
    ds_write_b128 v6, v[32:35] offset:0
    ds_write_b128 v6, v[36:39] offset:1024
    ds_write_b128 v6, v[40:43] offset:2048
    ds_write_b128 v6, v[44:47] offset:3072
    ds_write_b128 v6, v[48:51] offset:4096
    ds_write_b128 v6, v[52:55] offset:5120
    s_waitcnt lgkmcnt(0)
    s_barrier
    ds_read_b128 v[32:35], v7 offset:0
    ds_read_b128 v[36:39], v7 offset:1024
    ds_read_b128 v[40:43], v7 offset:2048
    ds_read_b128 v[44:47], v7 offset:3072
    ds_read_b128 v[48:51], v7 offset:4096
    ds_read_b128 v[52:55], v7 offset:5120
    s_waitcnt lgkmcnt(5)
    v_pk_add_f32 v[8:9], v[8:9], v[32:33]
    v_pk_add_f32 v[10:11], v[10:11], v[34:35]
    s_waitcnt lgkmcnt(4)
    v_pk_add_f32 v[12:13], v[12:13], v[36:37]
    v_pk_add_f32 v[14:15], v[14:15], v[38:39]
    s_waitcnt lgkmcnt(3)
    v_pk_add_f32 v[16:17], v[16:17], v[40:41]
    v_pk_add_f32 v[18:19], v[18:19], v[42:43]
    s_waitcnt lgkmcnt(2)
    v_pk_add_f32 v[20:21], v[20:21], v[44:45]
    v_pk_add_f32 v[22:23], v[22:23], v[46:47]
    s_waitcnt lgkmcnt(1)
    v_pk_add_f32 v[24:25], v[24:25], v[48:49]
    v_pk_add_f32 v[26:27], v[26:27], v[50:51]
    s_waitcnt lgkmcnt(0)
    v_pk_add_f32 v[28:29], v[28:29], v[52:53]
    v_pk_add_f32 v[30:31], v[30:31], v[54:55]
    v_add_f32 v144, v144, v146
    v_add_f32 v145, v145, v147
    v_mov_b32 v146, v144
    s_nop 1
    v_permlane16_swap_b32 v144, v146
    v_add_f32 v144, v144, v146
    v_mov_b32 v146, v144
    s_nop 1
    v_permlane32_swap_b32 v144, v146
    v_add_f32 v144, v144, v146
    v_mov_b32 v147, v145
    s_nop 1
    v_permlane16_swap_b32 v145, v147
    v_add_f32 v145, v145, v147
    v_mov_b32 v147, v145
    s_nop 1
    v_permlane32_swap_b32 v145, v147
    v_add_f32 v145, v145, v147
    v_mul_f32 v56, 0xbacccccd, v144
    v_mul_f32 v145, 0x3acccccd, v145
    v_fma_f32 v145, -v56, v56, v145
    v_max_f32 v145, 0, v145
    v_add_f32 v145, 0x3727c5ac, v145
    v_rsq_f32 v58, v145
    v_pk_add_f32 v[148:149], v[148:149], v[172:173]
    v_pk_add_f32 v[150:151], v[150:151], v[174:175]
    v_pk_add_f32 v[152:153], v[152:153], v[176:177]
    v_pk_add_f32 v[154:155], v[154:155], v[178:179]
    v_pk_add_f32 v[156:157], v[156:157], v[180:181]
    v_pk_add_f32 v[158:159], v[158:159], v[182:183]
    v_pk_add_f32 v[160:161], v[160:161], v[184:185]
    v_pk_add_f32 v[162:163], v[162:163], v[186:187]
    v_pk_add_f32 v[164:165], v[164:165], v[188:189]
    v_pk_add_f32 v[166:167], v[166:167], v[190:191]
    v_pk_add_f32 v[168:169], v[168:169], v[192:193]
    v_pk_add_f32 v[170:171], v[170:171], v[194:195]
    v_mul_f32 v60, 0x3ea52b5c, v58
    v_mul_u32_u24 v6, 1280, v5
    v_lshl_add_u32 v6, v3, 3, v6
    s_lshl_b32 s47, s45, 5
    v_pk_fma_f32 v[8:9], v[148:149], v[56:57], v[8:9] op_sel_hi:[1,0,1]
    v_pk_fma_f32 v[10:11], v[150:151], v[56:57], v[10:11] op_sel_hi:[1,0,1]
    v_pk_mul_f32 v[8:9], v[8:9], v[60:61] op_sel_hi:[1,0]
    v_pk_mul_f32 v[10:11], v[10:11], v[60:61] op_sel_hi:[1,0]
    v_cvt_pk_bf16_f32 v8, v8, v9
    v_cvt_pk_bf16_f32 v9, v10, v11
    buffer_store_dwordx2 v[8:9], v6, s[16:19], s47 offen offset:0
    v_pk_fma_f32 v[12:13], v[152:153], v[56:57], v[12:13] op_sel_hi:[1,0,1]
    v_pk_fma_f32 v[14:15], v[154:155], v[56:57], v[14:15] op_sel_hi:[1,0,1]
    v_pk_mul_f32 v[12:13], v[12:13], v[60:61] op_sel_hi:[1,0]
    v_pk_mul_f32 v[14:15], v[14:15], v[60:61] op_sel_hi:[1,0]
    v_cvt_pk_bf16_f32 v12, v12, v13
    v_cvt_pk_bf16_f32 v13, v14, v15
    buffer_store_dwordx2 v[12:13], v6, s[16:19], s47 offen offset:32
    v_pk_fma_f32 v[16:17], v[156:157], v[56:57], v[16:17] op_sel_hi:[1,0,1]
    v_pk_fma_f32 v[18:19], v[158:159], v[56:57], v[18:19] op_sel_hi:[1,0,1]
    v_pk_mul_f32 v[16:17], v[16:17], v[60:61] op_sel_hi:[1,0]
    v_pk_mul_f32 v[18:19], v[18:19], v[60:61] op_sel_hi:[1,0]
    v_cvt_pk_bf16_f32 v16, v16, v17
    v_cvt_pk_bf16_f32 v17, v18, v19
    buffer_store_dwordx2 v[16:17], v6, s[16:19], s47 offen offset:64
    v_pk_fma_f32 v[20:21], v[160:161], v[56:57], v[20:21] op_sel_hi:[1,0,1]
    v_pk_fma_f32 v[22:23], v[162:163], v[56:57], v[22:23] op_sel_hi:[1,0,1]
    v_pk_mul_f32 v[20:21], v[20:21], v[60:61] op_sel_hi:[1,0]
    v_pk_mul_f32 v[22:23], v[22:23], v[60:61] op_sel_hi:[1,0]
    v_cvt_pk_bf16_f32 v20, v20, v21
    v_cvt_pk_bf16_f32 v21, v22, v23
    buffer_store_dwordx2 v[20:21], v6, s[16:19], s47 offen offset:96
    v_pk_fma_f32 v[24:25], v[164:165], v[56:57], v[24:25] op_sel_hi:[1,0,1]
    v_pk_fma_f32 v[26:27], v[166:167], v[56:57], v[26:27] op_sel_hi:[1,0,1]
    v_pk_mul_f32 v[24:25], v[24:25], v[60:61] op_sel_hi:[1,0]
    v_pk_mul_f32 v[26:27], v[26:27], v[60:61] op_sel_hi:[1,0]
    v_cvt_pk_bf16_f32 v24, v24, v25
    v_cvt_pk_bf16_f32 v25, v26, v27
    buffer_store_dwordx2 v[24:25], v6, s[16:19], s47 offen offset:128
    v_pk_fma_f32 v[28:29], v[168:169], v[56:57], v[28:29] op_sel_hi:[1,0,1]
    v_pk_fma_f32 v[30:31], v[170:171], v[56:57], v[30:31] op_sel_hi:[1,0,1]
    v_pk_mul_f32 v[28:29], v[28:29], v[58:59] op_sel_hi:[1,0]
    v_pk_mul_f32 v[30:31], v[30:31], v[58:59] op_sel_hi:[1,0]
    v_cvt_pk_bf16_f32 v28, v28, v29
    v_cvt_pk_bf16_f32 v29, v30, v31
    s_and_b32 s47, s40, 1
    s_mul_i32 s47, s47, 3
    s_add_u32 s47, s47, s44
    s_cmp_lg_u32 s47, s33
    s_cbranch_scc1 fqkv_end
    s_lshl_b32 s47, s44, 2
    v_add_u32 v3, s47, v3
    v_lshrrev_b32 v6, 5, v5
    v_mul_u32_u24 v6, 3072, v6
    v_mov_b32 v1, 0x7ff00000
    v_and_b32 v7, 31, v5
    v_lshl_add_u32 v62, v7, 4, v6
    v_lshrrev_b32 v63, 1, v3
    v_lshl_add_u32 v62, v63, 9, v62
    v_and_b32 v63, 1, v3
    v_lshl_add_u32 v62, v63, 3, v62
    v_lshl_add_u32 v63, v7, 3, v6
    v_add_u32 v63, 1024, v63
    v_cmp_eq_u32 vcc, 4, v3
    s_nop 1
    v_cndmask_b32 v62, v62, v63, vcc
    v_cmp_gt_u32 vcc, 5, v3
    s_nop 1
    v_cndmask_b32 v62, v1, v62, vcc
    buffer_store_dwordx2 v[28:29], v62, s[28:31], 0 offen
    v_bfe_u32 v7, v5, 4, 1
    v_mul_u32_u24 v7, 896, v7
    v_add_u32 v6, v6, v7
    v_bfe_u32 v7, v5, 2, 1
    v_mul_u32_u24 v7, 448, v7
    v_add_u32 v6, v6, v7
    v_bfe_u32 v7, v5, 3, 1
    v_lshl_add_u32 v6, v7, 3, v6
    v_and_b32 v7, 3, v5
    v_lshl_add_u32 v6, v7, 1, v6
    v_lshl_add_u32 v6, v3, 6, v6
    v_subrev_u32 v7, 5, v3
    v_cmp_gt_u32 vcc, 6, v7
    s_nop 1
    v_cndmask_b32 v6, v1, v6, vcc
    v_cmp_eq_u32 vcc, 10, v3
    v_mov_b32 v7, 0x3f80
    s_nop 0
    v_cndmask_b32 v30, v28, v7, vcc
    v_cndmask_b32 v31, v29, 0, vcc
    buffer_store_short v30, v6, s[28:31], 0 offen offset:960
    buffer_store_short_d16_hi v30, v6, s[28:31], 0 offen offset:976
    buffer_store_short v31, v6, s[28:31], 0 offen offset:992
    buffer_store_short_d16_hi v31, v6, s[28:31], 0 offen offset:1008
fqkv_end:
f_exit:
    s_endpgm
f_loader:
    v_lshlrev_b32 v4, 4, v0
    s_sub_u32 s42, s40, 4
    s_mul_i32 s52, s33, 245760
    s_mul_i32 s53, s33, 102400
    s_mul_i32 s44, s33, 11
    s_lshr_b32 s44, s44, 5
    s_mul_i32 s44, s44, 3
    s_sub_u32 s44, s33, s44
    s_mov_b32 s54, s44
    s_and_b32 s34, s2, 7
    s_lshr_b32 s35, s2, 3
    s_lshr_b32 s32, s35, 4
    s_lshl1_add_u32 s32, s34, s32
    s_and_b32 s33, s35, 15
    s_mul_i32 s45, s33, 245760
    s_mul_i32 s47, s42, 3072
    s_add_u32 s45, s45, s47
    s_add_u32 s45, s45, 3670016
    v_add_u32 v11, s47, v4
    s_add_u32 m0, s47, 61440
    s_add_u32 s46, s45, 0
    buffer_load_dwordx4 v4, s[8:11], s46 offen offset:0 lds
    buffer_load_dwordx4 v4, s[8:11], s46 offen offset:1024 lds
    buffer_load_dwordx4 v4, s[8:11], s46 offen offset:2048 lds
    s_add_u32 m0, s47, 73728
    s_add_u32 s46, s45, 12288
    buffer_load_dwordx4 v4, s[8:11], s46 offen offset:0 lds
    buffer_load_dwordx4 v4, s[8:11], s46 offen offset:1024 lds
    buffer_load_dwordx4 v4, s[8:11], s46 offen offset:2048 lds
    s_add_u32 m0, s47, 86016
    s_add_u32 s46, s45, 24576
    buffer_load_dwordx4 v4, s[8:11], s46 offen offset:0 lds
    buffer_load_dwordx4 v4, s[8:11], s46 offen offset:1024 lds
    buffer_load_dwordx4 v4, s[8:11], s46 offen offset:2048 lds
    s_add_u32 m0, s47, 98304
    s_add_u32 s46, s45, 36864
    buffer_load_dwordx4 v4, s[8:11], s46 offen offset:0 lds
    buffer_load_dwordx4 v4, s[8:11], s46 offen offset:1024 lds
    buffer_load_dwordx4 v4, s[8:11], s46 offen offset:2048 lds
    s_add_u32 m0, s47, 110592
    s_add_u32 s46, s45, 49152
    buffer_load_dwordx4 v4, s[8:11], s46 offen offset:0 lds
    buffer_load_dwordx4 v4, s[8:11], s46 offen offset:1024 lds
    buffer_load_dwordx4 v4, s[8:11], s46 offen offset:2048 lds
    s_barrier
    s_add_u32 s46, s45, 61440
    buffer_load_dwordx4 v[12:15], v4, s[8:11], s46 offen offset:0
    buffer_load_dwordx4 v[16:19], v4, s[8:11], s46 offen offset:1024
    buffer_load_dwordx4 v[20:23], v4, s[8:11], s46 offen offset:2048
    s_add_u32 s46, s45, 86016
    buffer_load_dwordx4 v[24:27], v4, s[8:11], s46 offen offset:0
    buffer_load_dwordx4 v[28:31], v4, s[8:11], s46 offen offset:1024
    buffer_load_dwordx4 v[32:35], v4, s[8:11], s46 offen offset:2048
    s_add_u32 s46, s45, 110592
    buffer_load_dwordx4 v[36:39], v4, s[8:11], s46 offen offset:0
    buffer_load_dwordx4 v[40:43], v4, s[8:11], s46 offen offset:1024
    buffer_load_dwordx4 v[44:47], v4, s[8:11], s46 offen offset:2048
    s_add_u32 s46, s45, 135168
    buffer_load_dwordx4 v[48:51], v4, s[8:11], s46 offen offset:0
    buffer_load_dwordx4 v[52:55], v4, s[8:11], s46 offen offset:1024
    buffer_load_dwordx4 v[56:59], v4, s[8:11], s46 offen offset:2048
    s_add_u32 s46, s45, 159744
    buffer_load_dwordx4 v[60:63], v4, s[8:11], s46 offen offset:0
    buffer_load_dwordx4 v[64:67], v4, s[8:11], s46 offen offset:1024
    buffer_load_dwordx4 v[68:71], v4, s[8:11], s46 offen offset:2048
    s_add_u32 s46, s45, 184320
    buffer_load_dwordx4 v[72:75], v4, s[8:11], s46 offen offset:0
    buffer_load_dwordx4 v[76:79], v4, s[8:11], s46 offen offset:1024
    buffer_load_dwordx4 v[80:83], v4, s[8:11], s46 offen offset:2048
    s_add_u32 s46, s45, 208896
    buffer_load_dwordx4 v[84:87], v4, s[8:11], s46 offen offset:0
    buffer_load_dwordx4 v[88:91], v4, s[8:11], s46 offen offset:1024
    buffer_load_dwordx4 v[92:95], v4, s[8:11], s46 offen offset:2048
    s_barrier
    s_mul_i32 s55, s42, 5120
    s_add_u32 s52, s52, s55
    s_add_u32 s52, s52, 1703936
    s_waitcnt vmcnt(0)
    s_waitcnt lgkmcnt(0)
    s_barrier
    s_add_u32 m0, s47, 135168
    s_add_u32 s46, s45, 73728
    buffer_load_dwordx4 v4, s[8:11], s46 offen offset:0 lds
    buffer_load_dwordx4 v4, s[8:11], s46 offen offset:1024 lds
    buffer_load_dwordx4 v4, s[8:11], s46 offen offset:2048 lds
    v_add_u32 v10, 122880, v11
    ds_write_b128 v10, v[12:15] offset:0
    ds_write_b128 v10, v[16:19] offset:1024
    ds_write_b128 v10, v[20:23] offset:2048
    s_waitcnt lgkmcnt(0)
    s_barrier
    s_add_u32 m0, s47, 0
    s_add_u32 s46, s45, 98304
    buffer_load_dwordx4 v4, s[8:11], s46 offen offset:0 lds
    buffer_load_dwordx4 v4, s[8:11], s46 offen offset:1024 lds
    buffer_load_dwordx4 v4, s[8:11], s46 offen offset:2048 lds
    v_add_u32 v10, 147456, v11
    ds_write_b128 v10, v[24:27] offset:0
    ds_write_b128 v10, v[28:31] offset:1024
    ds_write_b128 v10, v[32:35] offset:2048
    s_waitcnt lgkmcnt(0)
    s_barrier
    s_add_u32 m0, s47, 24576
    s_add_u32 s46, s45, 122880
    buffer_load_dwordx4 v4, s[8:11], s46 offen offset:0 lds
    buffer_load_dwordx4 v4, s[8:11], s46 offen offset:1024 lds
    buffer_load_dwordx4 v4, s[8:11], s46 offen offset:2048 lds
    v_add_u32 v10, 12288, v11
    ds_write_b128 v10, v[36:39] offset:0
    ds_write_b128 v10, v[40:43] offset:1024
    ds_write_b128 v10, v[44:47] offset:2048
    s_waitcnt vmcnt(6)
    s_waitcnt lgkmcnt(0)
    s_barrier
    s_add_u32 m0, s47, 49152
    s_add_u32 s46, s45, 147456
    buffer_load_dwordx4 v4, s[8:11], s46 offen offset:0 lds
    buffer_load_dwordx4 v4, s[8:11], s46 offen offset:1024 lds
    buffer_load_dwordx4 v4, s[8:11], s46 offen offset:2048 lds
    v_add_u32 v10, 36864, v11
    ds_write_b128 v10, v[48:51] offset:0
    ds_write_b128 v10, v[52:55] offset:1024
    ds_write_b128 v10, v[56:59] offset:2048
    s_waitcnt vmcnt(6)
    s_waitcnt lgkmcnt(0)
    s_barrier
    s_add_u32 m0, s47, 73728
    s_add_u32 s46, s45, 172032
    buffer_load_dwordx4 v4, s[8:11], s46 offen offset:0 lds
    buffer_load_dwordx4 v4, s[8:11], s46 offen offset:1024 lds
    buffer_load_dwordx4 v4, s[8:11], s46 offen offset:2048 lds
    v_add_u32 v10, 61440, v11
    ds_write_b128 v10, v[60:63] offset:0
    ds_write_b128 v10, v[64:67] offset:1024
    ds_write_b128 v10, v[68:71] offset:2048
    s_waitcnt vmcnt(6)
    s_waitcnt lgkmcnt(0)
    s_barrier
    s_add_u32 m0, s47, 98304
    s_add_u32 s46, s45, 196608
    buffer_load_dwordx4 v4, s[8:11], s46 offen offset:0 lds
    buffer_load_dwordx4 v4, s[8:11], s46 offen offset:1024 lds
    buffer_load_dwordx4 v4, s[8:11], s46 offen offset:2048 lds
    v_add_u32 v10, 86016, v11
    ds_write_b128 v10, v[72:75] offset:0
    ds_write_b128 v10, v[76:79] offset:1024
    ds_write_b128 v10, v[80:83] offset:2048
    s_waitcnt vmcnt(6)
    s_waitcnt lgkmcnt(0)
    s_barrier
    s_add_u32 m0, s47, 122880
    s_add_u32 s46, s45, 221184
    buffer_load_dwordx4 v4, s[8:11], s46 offen offset:0 lds
    buffer_load_dwordx4 v4, s[8:11], s46 offen offset:1024 lds
    buffer_load_dwordx4 v4, s[8:11], s46 offen offset:2048 lds
    v_add_u32 v10, 110592, v11
    ds_write_b128 v10, v[84:87] offset:0
    ds_write_b128 v10, v[88:91] offset:1024
    ds_write_b128 v10, v[92:95] offset:2048
    s_waitcnt vmcnt(6)
    s_waitcnt lgkmcnt(0)
    s_barrier
    s_add_u32 m0, s47, 135168
    s_add_u32 s46, s45, 233472
    buffer_load_dwordx4 v4, s[8:11], s46 offen offset:0 lds
    buffer_load_dwordx4 v4, s[8:11], s46 offen offset:1024 lds
    buffer_load_dwordx4 v4, s[8:11], s46 offen offset:2048 lds
    s_waitcnt vmcnt(6)
    s_waitcnt lgkmcnt(0)
    s_barrier
    s_add_u32 m0, s55, 0
    s_add_u32 s46, s52, 0
    buffer_load_dwordx4 v4, s[8:11], s46 offen offset:0 lds
    buffer_load_dwordx4 v4, s[8:11], s46 offen offset:1024 lds
    buffer_load_dwordx4 v4, s[8:11], s46 offen offset:2048 lds
    buffer_load_dwordx4 v4, s[8:11], s46 offen offset:3072 lds
    s_add_u32 m0, m0, 4096
    s_add_u32 s46, s46, 4096
    buffer_load_dwordx4 v4, s[8:11], s46 offen offset:0 lds
    s_add_u32 m0, m0, 1024
    s_add_u32 s46, s46, 1024
    s_add_u32 m0, s55, 20480
    s_add_u32 s46, s52, 20480
    buffer_load_dwordx4 v4, s[8:11], s46 offen offset:0 lds
    buffer_load_dwordx4 v4, s[8:11], s46 offen offset:1024 lds
    buffer_load_dwordx4 v4, s[8:11], s46 offen offset:2048 lds
    buffer_load_dwordx4 v4, s[8:11], s46 offen offset:3072 lds
    s_add_u32 m0, m0, 4096
    s_add_u32 s46, s46, 4096
    buffer_load_dwordx4 v4, s[8:11], s46 offen offset:0 lds
    s_add_u32 m0, m0, 1024
    s_add_u32 s46, s46, 1024
    s_waitcnt vmcnt(10)
    s_waitcnt lgkmcnt(0)
    s_barrier
    s_add_u32 m0, s55, 40960
    s_add_u32 s46, s52, 40960
    buffer_load_dwordx4 v4, s[8:11], s46 offen offset:0 lds
    buffer_load_dwordx4 v4, s[8:11], s46 offen offset:1024 lds
    buffer_load_dwordx4 v4, s[8:11], s46 offen offset:2048 lds
    buffer_load_dwordx4 v4, s[8:11], s46 offen offset:3072 lds
    s_add_u32 m0, m0, 4096
    s_add_u32 s46, s46, 4096
    buffer_load_dwordx4 v4, s[8:11], s46 offen offset:0 lds
    s_add_u32 m0, m0, 1024
    s_add_u32 s46, s46, 1024
    s_add_u32 m0, s55, 61440
    s_add_u32 s46, s52, 61440
    buffer_load_dwordx4 v4, s[8:11], s46 offen offset:0 lds
    buffer_load_dwordx4 v4, s[8:11], s46 offen offset:1024 lds
    buffer_load_dwordx4 v4, s[8:11], s46 offen offset:2048 lds
    buffer_load_dwordx4 v4, s[8:11], s46 offen offset:3072 lds
    s_add_u32 m0, m0, 4096
    s_add_u32 s46, s46, 4096
    buffer_load_dwordx4 v4, s[8:11], s46 offen offset:0 lds
    s_add_u32 m0, m0, 1024
    s_add_u32 s46, s46, 1024
    s_waitcnt lgkmcnt(0)
    s_barrier
    v_add_u32 v11, s55, v4
    v_add_u32 v10, 81920, v11
    ds_write_b128 v10, v[116:119] offset:0
    ds_write_b128 v10, v[120:123] offset:1024
    ds_write_b128 v10, v[124:127] offset:2048
    ds_write_b128 v10, v[128:131] offset:3072
    ds_write_b128 v10, v[132:135] offset:4096
    v_add_u32 v10, 102400, v11
    ds_write_b128 v10, v[136:139] offset:0
    ds_write_b128 v10, v[140:143] offset:1024
    ds_write_b128 v10, v[144:147] offset:2048
    ds_write_b128 v10, v[148:151] offset:3072
    ds_write_b128 v10, v[152:155] offset:4096
    v_add_u32 v10, 122880, v11
    ds_write_b128 v10, v[156:159] offset:0
    ds_write_b128 v10, v[160:163] offset:1024
    ds_write_b128 v10, v[164:167] offset:2048
    ds_write_b128 v10, v[168:171] offset:3072
    ds_write_b128 v10, v[172:175] offset:4096
    v_add_u32 v10, 143360, v11
    ds_write_b128 v10, v[176:179] offset:0
    ds_write_b128 v10, v[180:183] offset:1024
    ds_write_b128 v10, v[184:187] offset:2048
    ds_write_b128 v10, v[188:191] offset:3072
    ds_write_b128 v10, v[192:195] offset:4096
    s_waitcnt vmcnt(0)
    s_waitcnt lgkmcnt(0)
    s_barrier
    s_waitcnt lgkmcnt(0)
    s_barrier
    s_add_u32 m0, s55, 0
    s_add_u32 s46, s52, 163840
    buffer_load_dwordx4 v4, s[8:11], s46 offen offset:0 lds
    buffer_load_dwordx4 v4, s[8:11], s46 offen offset:1024 lds
    buffer_load_dwordx4 v4, s[8:11], s46 offen offset:2048 lds
    buffer_load_dwordx4 v4, s[8:11], s46 offen offset:3072 lds
    s_add_u32 m0, m0, 4096
    s_add_u32 s46, s46, 4096
    buffer_load_dwordx4 v4, s[8:11], s46 offen offset:0 lds
    s_add_u32 m0, m0, 1024
    s_add_u32 s46, s46, 1024
    s_waitcnt lgkmcnt(0)
    s_barrier
    v_add_u32 v10, 20480, v11
    ds_write_b128 v10, v[196:199] offset:0
    ds_write_b128 v10, v[200:203] offset:1024
    ds_write_b128 v10, v[204:207] offset:2048
    ds_write_b128 v10, v[208:211] offset:3072
    ds_write_b128 v10, v[212:215] offset:4096
    s_waitcnt lgkmcnt(0)
    s_barrier
    v_add_u32 v10, 40960, v11
    ds_write_b128 v10, v[216:219] offset:0
    ds_write_b128 v10, v[220:223] offset:1024
    ds_write_b128 v10, v[224:227] offset:2048
    ds_write_b128 v10, v[228:231] offset:3072
    ds_write_b128 v10, v[232:235] offset:4096
    s_waitcnt lgkmcnt(0)
    s_barrier
    v_add_u32 v10, 61440, v11
    ds_write_b128 v10, v[236:239] offset:0
    ds_write_b128 v10, v[240:243] offset:1024
    ds_write_b128 v10, v[244:247] offset:2048
    ds_write_b128 v10, v[248:251] offset:3072
    ds_write_b128 v10, v[252:255] offset:4096
    s_waitcnt lgkmcnt(0)
    s_barrier
    s_waitcnt vmcnt(0)
    s_cmp_lg_u32 s94, 0
    s_cbranch_scc1 f_exit
    s_cmp_lt_u32 s42, 2
    s_cbranch_scc1 f_exit
    s_sub_u32 s42, s42, 2
    s_mul_i32 s46, s42, 5120
    s_add_u32 s43, s53, s46
    s_add_u32 s43, s43, 0
    s_mul_i32 s45, s54, 20480
    s_add_u32 s45, s45, 1638400
    s_lshl_b32 s47, s42, 10
    s_add_u32 s45, s45, s47
    s_add_u32 s47, s47, 10240
    s_barrier
    s_add_u32 m0, s46, 81920
    s_nop 0
    buffer_load_dwordx4 v4, s[8:11], s43 offen offset:0 lds
    buffer_load_dwordx4 v4, s[8:11], s43 offen offset:1024 lds
    buffer_load_dwordx4 v4, s[8:11], s43 offen offset:2048 lds
    buffer_load_dwordx4 v4, s[8:11], s43 offen offset:3072 lds
    s_add_u32 m0, m0, 4096
    s_add_u32 s43, s43, 4096
    buffer_load_dwordx4 v4, s[8:11], s43 offen offset:0 lds
    s_add_u32 m0, m0, 1024
    s_add_u32 s43, s43, 1024
    s_add_u32 s43, s43, 5120
    s_add_u32 m0, s47, 81920
    s_nop 0
    buffer_load_dwordx4 v4, s[8:11], s45 offen lds
    s_add_u32 s45, s45, 2048
    s_barrier
    s_add_u32 m0, s46, 94208
    s_nop 0
    buffer_load_dwordx4 v4, s[8:11], s43 offen offset:0 lds
    buffer_load_dwordx4 v4, s[8:11], s43 offen offset:1024 lds
    buffer_load_dwordx4 v4, s[8:11], s43 offen offset:2048 lds
    buffer_load_dwordx4 v4, s[8:11], s43 offen offset:3072 lds
    s_add_u32 m0, m0, 4096
    s_add_u32 s43, s43, 4096
    buffer_load_dwordx4 v4, s[8:11], s43 offen offset:0 lds
    s_add_u32 m0, m0, 1024
    s_add_u32 s43, s43, 1024
    s_add_u32 s43, s43, 5120
    s_add_u32 m0, s47, 94208
    s_nop 0
    buffer_load_dwordx4 v4, s[8:11], s45 offen lds
    s_add_u32 s45, s45, 2048
    s_barrier
    s_add_u32 m0, s46, 106496
    s_nop 0
    buffer_load_dwordx4 v4, s[8:11], s43 offen offset:0 lds
    buffer_load_dwordx4 v4, s[8:11], s43 offen offset:1024 lds
    buffer_load_dwordx4 v4, s[8:11], s43 offen offset:2048 lds
    buffer_load_dwordx4 v4, s[8:11], s43 offen offset:3072 lds
    s_add_u32 m0, m0, 4096
    s_add_u32 s43, s43, 4096
    buffer_load_dwordx4 v4, s[8:11], s43 offen offset:0 lds
    s_add_u32 m0, m0, 1024
    s_add_u32 s43, s43, 1024
    s_add_u32 s43, s43, 5120
    s_add_u32 m0, s47, 106496
    s_nop 0
    buffer_load_dwordx4 v4, s[8:11], s45 offen lds
    s_add_u32 s45, s45, 2048
    s_barrier
    s_add_u32 m0, s46, 118784
    s_nop 0
    buffer_load_dwordx4 v4, s[8:11], s43 offen offset:0 lds
    buffer_load_dwordx4 v4, s[8:11], s43 offen offset:1024 lds
    buffer_load_dwordx4 v4, s[8:11], s43 offen offset:2048 lds
    buffer_load_dwordx4 v4, s[8:11], s43 offen offset:3072 lds
    s_add_u32 m0, m0, 4096
    s_add_u32 s43, s43, 4096
    buffer_load_dwordx4 v4, s[8:11], s43 offen offset:0 lds
    s_add_u32 m0, m0, 1024
    s_add_u32 s43, s43, 1024
    s_add_u32 s43, s43, 5120
    s_add_u32 m0, s47, 118784
    s_nop 0
    buffer_load_dwordx4 v4, s[8:11], s45 offen lds
    s_add_u32 s45, s45, 2048
    s_barrier
    s_add_u32 m0, s46, 131072
    s_nop 0
    buffer_load_dwordx4 v4, s[8:11], s43 offen offset:0 lds
    buffer_load_dwordx4 v4, s[8:11], s43 offen offset:1024 lds
    buffer_load_dwordx4 v4, s[8:11], s43 offen offset:2048 lds
    buffer_load_dwordx4 v4, s[8:11], s43 offen offset:3072 lds
    s_add_u32 m0, m0, 4096
    s_add_u32 s43, s43, 4096
    buffer_load_dwordx4 v4, s[8:11], s43 offen offset:0 lds
    s_add_u32 m0, m0, 1024
    s_add_u32 s43, s43, 1024
    s_add_u32 s43, s43, 5120
    s_add_u32 m0, s47, 131072
    s_nop 0
    buffer_load_dwordx4 v4, s[8:11], s45 offen lds
    s_add_u32 s45, s45, 2048
    s_barrier
    s_add_u32 m0, s46, 143360
    s_nop 0
    buffer_load_dwordx4 v4, s[8:11], s43 offen offset:0 lds
    buffer_load_dwordx4 v4, s[8:11], s43 offen offset:1024 lds
    buffer_load_dwordx4 v4, s[8:11], s43 offen offset:2048 lds
    buffer_load_dwordx4 v4, s[8:11], s43 offen offset:3072 lds
    s_add_u32 m0, m0, 4096
    s_add_u32 s43, s43, 4096
    buffer_load_dwordx4 v4, s[8:11], s43 offen offset:0 lds
    s_add_u32 m0, m0, 1024
    s_add_u32 s43, s43, 1024
    s_add_u32 s43, s43, 5120
    s_add_u32 m0, s47, 143360
    s_nop 0
    buffer_load_dwordx4 v4, s[8:11], s45 offen lds
    s_add_u32 s45, s45, 2048
    s_barrier
    s_add_u32 m0, s46, 0
    s_nop 0
    buffer_load_dwordx4 v4, s[8:11], s43 offen offset:0 lds
    buffer_load_dwordx4 v4, s[8:11], s43 offen offset:1024 lds
    buffer_load_dwordx4 v4, s[8:11], s43 offen offset:2048 lds
    buffer_load_dwordx4 v4, s[8:11], s43 offen offset:3072 lds
    s_add_u32 m0, m0, 4096
    s_add_u32 s43, s43, 4096
    buffer_load_dwordx4 v4, s[8:11], s43 offen offset:0 lds
    s_add_u32 m0, m0, 1024
    s_add_u32 s43, s43, 1024
    s_add_u32 s43, s43, 5120
    s_add_u32 m0, s47, 0
    s_nop 0
    buffer_load_dwordx4 v4, s[8:11], s45 offen lds
    s_add_u32 s45, s45, 2048
    s_add_u32 m0, s46, 12288
    s_nop 0
    buffer_load_dwordx4 v4, s[8:11], s43 offen offset:0 lds
    buffer_load_dwordx4 v4, s[8:11], s43 offen offset:1024 lds
    buffer_load_dwordx4 v4, s[8:11], s43 offen offset:2048 lds
    buffer_load_dwordx4 v4, s[8:11], s43 offen offset:3072 lds
    s_add_u32 m0, m0, 4096
    s_add_u32 s43, s43, 4096
    buffer_load_dwordx4 v4, s[8:11], s43 offen offset:0 lds
    s_add_u32 m0, m0, 1024
    s_add_u32 s43, s43, 1024
    s_add_u32 s43, s43, 5120
    s_add_u32 m0, s47, 12288
    s_nop 0
    buffer_load_dwordx4 v4, s[8:11], s45 offen lds
    s_add_u32 s45, s45, 2048
    s_add_u32 m0, s46, 24576
    s_nop 0
    buffer_load_dwordx4 v4, s[8:11], s43 offen offset:0 lds
    buffer_load_dwordx4 v4, s[8:11], s43 offen offset:1024 lds
    buffer_load_dwordx4 v4, s[8:11], s43 offen offset:2048 lds
    buffer_load_dwordx4 v4, s[8:11], s43 offen offset:3072 lds
    s_add_u32 m0, m0, 4096
    s_add_u32 s43, s43, 4096
    buffer_load_dwordx4 v4, s[8:11], s43 offen offset:0 lds
    s_add_u32 m0, m0, 1024
    s_add_u32 s43, s43, 1024
    s_add_u32 s43, s43, 5120
    s_add_u32 m0, s47, 24576
    s_nop 0
    buffer_load_dwordx4 v4, s[8:11], s45 offen lds
    s_add_u32 s45, s45, 2048
    s_add_u32 m0, s46, 61440
    s_nop 0
    buffer_load_dwordx4 v4, s[8:11], s43 offen offset:0 lds
    buffer_load_dwordx4 v4, s[8:11], s43 offen offset:1024 lds
    buffer_load_dwordx4 v4, s[8:11], s43 offen offset:2048 lds
    buffer_load_dwordx4 v4, s[8:11], s43 offen offset:3072 lds
    s_add_u32 m0, m0, 4096
    s_add_u32 s43, s43, 4096
    buffer_load_dwordx4 v4, s[8:11], s43 offen offset:0 lds
    s_add_u32 m0, m0, 1024
    s_add_u32 s43, s43, 1024
    s_add_u32 s43, s43, 5120
    s_add_u32 m0, s47, 61440
    s_nop 0
    buffer_load_dwordx4 v4, s[8:11], s45 offen lds
    s_add_u32 s45, s45, 2048
    s_waitcnt vmcnt(0)
    s_barrier
    s_endpgm
code_end:
.section .rodata,"a"
.p2align 6
.amdhsa_kernel prep_kernel
  .amdhsa_next_free_vgpr 96
  .amdhsa_next_free_sgpr 102
  .amdhsa_accum_offset 96
  .amdhsa_group_segment_fixed_size 0
  .amdhsa_kernarg_size 96
  .amdhsa_user_sgpr_count 2
  .amdhsa_user_sgpr_kernarg_segment_ptr 1
  .amdhsa_system_sgpr_workgroup_id_x 1
  .amdhsa_float_denorm_mode_32 3
.end_amdhsa_kernel
.p2align 6
.amdhsa_kernel qkv1_kernel
  .amdhsa_next_free_vgpr 194
  .amdhsa_next_free_sgpr 102
  .amdhsa_accum_offset 196
  .amdhsa_group_segment_fixed_size 0
  .amdhsa_kernarg_size 96
  .amdhsa_user_sgpr_count 2
  .amdhsa_user_sgpr_kernarg_segment_ptr 1
  .amdhsa_system_sgpr_workgroup_id_x 1
  .amdhsa_float_denorm_mode_32 3
.end_amdhsa_kernel
.p2align 6
.amdhsa_kernel f1_kernel
  .amdhsa_next_free_vgpr 256
  .amdhsa_next_free_sgpr 102
  .amdhsa_accum_offset 256
  .amdhsa_group_segment_fixed_size 0
  .amdhsa_kernarg_size 96
  .amdhsa_user_sgpr_count 2
  .amdhsa_user_sgpr_kernarg_segment_ptr 1
  .amdhsa_system_sgpr_workgroup_id_x 1
  .amdhsa_float_denorm_mode_32 3
.end_amdhsa_kernel
.p2align 6
.amdhsa_kernel f2_kernel
  .amdhsa_next_free_vgpr 256
  .amdhsa_next_free_sgpr 102
  .amdhsa_accum_offset 256
  .amdhsa_group_segment_fixed_size 0
  .amdhsa_kernarg_size 96
  .amdhsa_user_sgpr_count 2
  .amdhsa_user_sgpr_kernarg_segment_ptr 1
  .amdhsa_system_sgpr_workgroup_id_x 1
  .amdhsa_float_denorm_mode_32 3
.end_amdhsa_kernel
```
